```python
import torch

def _softmax(x, axis=-1):
    return torch.softmax(x, dim=axis)
def _gelu(x):
    return torch.nn.functional.gelu(x, approximate="tanh")
def _silu(x):
    return torch.nn.functional.silu(x)
def _sigmoid(x):
    return torch.sigmoid(x)
def _layernorm(x, axis=-1, eps=1e-5):
    m = x.mean(dim=axis, keepdim=True)
    v = x.var(dim=axis, keepdim=True, unbiased=False)
    return (x - m) / torch.sqrt(v + eps)
def _scatter_add(tgt, idx, src, axis=0):
    return tgt.clone().index_add_(axis, idx, src)
def _segment_sum(src, seg, n):
    out = torch.zeros((n,) + src.shape[1:], dtype=src.dtype)
    return out.index_add_(0, seg, src)
def _pad(x, pw):
    flat = tuple(v for pair in reversed(pw) for v in pair)
    return torch.nn.functional.pad(x, flat)

kernel_name = 'interleave_layers__linear_kernel_hedgehog__ssm_conv_h3__prompt'

def setup_inputs():

    _w = (lambda a: (lambda t: t.to(torch.bfloat16) if t.is_floating_point() else t)(torch.as_tensor(a)))
    def _A_setup():
        B, S, D, H = 1, 2048, 576, 32
        Dh = D // H
        return {
            "x": _w((lambda *s: torch.randn(*s, dtype=torch.bfloat16) * 0.05)(B, S, D)),
            "wqkv": _w((lambda *s: torch.randn(*s, dtype=torch.bfloat16) * 0.4)(D, 3 * D)),
            "w_phi": _w((lambda *s: torch.randn(*s, dtype=torch.bfloat16) * 0.4)(H, Dh, Dh) * (Dh ** -0.5)),
            "wo": _w((lambda *s: torch.randn(*s, dtype=torch.bfloat16) * 0.05)(D, D)),
        }
    _A_in = _A_setup()

    def _B_setup():
        B, S, D = 1, 2048, 576
        ks = 4
        return {
            "q": _w((lambda *s: torch.randn(*s, dtype=torch.bfloat16) * 0.05)(B, S, D)),
            "k": _w((lambda *s: torch.randn(*s, dtype=torch.bfloat16) * 0.8)(B, S, D)),
            "v": _w((lambda *s: torch.randn(*s, dtype=torch.bfloat16) * 0.8)(B, S, D)),
            "shift_k": _w((lambda *s: torch.randn(*s, dtype=torch.bfloat16) * 0.8)(D, ks) * 0.5),
            "ssm_k": _w((lambda *s: torch.randn(*s, dtype=torch.bfloat16) * 1.6)(D, S) * (1.0 / S ** 0.5)),
            "ssm_D": _w((lambda *s: torch.randn(*s, dtype=torch.bfloat16) * 0.8)(D)),
        }
    _B_in = _B_setup()

    return {
        "A_x": _A_in["x"],
        "A_wqkv": _A_in["wqkv"],
        "A_w_phi": _A_in["w_phi"],
        "A_wo": _A_in["wo"],
        "B_q": _B_in["q"],
        "B_k": _B_in["k"],
        "B_v": _B_in["v"],
        "B_shift_k": _B_in["shift_k"],
        "B_ssm_k": _B_in["ssm_k"],
        "B_ssm_D": _B_in["ssm_D"],
    }

def reference(A_x, A_wqkv, A_w_phi, A_wo, B_q, B_k, B_v, B_shift_k, B_ssm_k, B_ssm_D):
    def _A_ref(x, wqkv, w_phi, wo):
        B, S, D = x.shape
        H = 32; Dh = D // H
        qkv = (lambda x, *d: x.permute(*d))((x @ wqkv).reshape(B, S, 3, H, Dh), 2, 0, 3, 1, 4)
        q, k, v = qkv[0], qkv[1], qkv[2]
        pq = torch.einsum("bhsd,hdf->bhsf", q, w_phi)
        pk = torch.einsum("bhsd,hdf->bhsf", k, w_phi)
        phi_q = torch.concatenate([_softmax(pq, axis=-1), _softmax(-pq, axis=-1)], axis=-1)
        phi_k = torch.concatenate([_softmax(pk, axis=-1), _softmax(-pk, axis=-1)], axis=-1)
        kv = torch.einsum("bhsf,bhsd->bhfd", phi_k, v)
        z  = torch.einsum("bhsf->bhf", phi_k)
        num = torch.einsum("bhqf,bhfd->bhqd", phi_q, kv)
        den = torch.einsum("bhqf,bhf->bhq", phi_q, z)[..., None] + 1e-6
        o = num / den
        return (lambda x, *d: x.permute(*d))(o, 0, 2, 1, 3).reshape(B, S, D) @ wo

    def _B_ref(q, k, v, shift_k, ssm_k, ssm_D):
        B, S, D = q.shape
        ks = shift_k.shape[-1]
        k_pad = _pad(k, ((0, 0), (ks - 1, 0), (0, 0)))
        k_shift = torch.zeros_like(k)
        for t in range(ks):
            k_shift = k_shift + k_pad[:, t:t + S, :] * shift_k[:, ks - 1 - t][None, None, :]
        kv = k_shift * v
        L = 2 * S
        kv_pad = _pad(kv, ((0, 0), (0, S), (0, 0)))
        kf_pad = _pad(ssm_k, ((0, 0), (0, S)))
        kv_f = (lambda x, axes=(-2,-1): torch.fft.rfft2(x.float(), dim=axes))(kv_pad[:, None, :, :], axes=(1, 2))
        kf_f = (lambda x, axes=(-2,-1): torch.fft.rfft2(x.float(), dim=axes))(kf_pad[:, None, :], axes=(1, 2))
        kf_f = (lambda x, *d: x.permute(*d))(kf_f, 1, 2, 0)
        y_f = kv_f * kf_f[None, :, :, :]
        y = (lambda x, s, axes=(-2,-1): torch.fft.irfft2(x, s=s, dim=axes).to(torch.bfloat16))(y_f, (1, L), axes=(1, 2))[:, 0, :S, :]
        y = y + kv * ssm_D[None, None, :]
        return q * y

    x = A_x
    x = x + _A_ref(_layernorm(x, axis=-1), A_wqkv, A_w_phi, A_wo)
    x = x + _B_ref(_layernorm(x, axis=-1), B_k, B_v, B_shift_k, B_ssm_k, B_ssm_D)
    x = x + _A_ref(_layernorm(x, axis=-1), A_wqkv, A_w_phi, A_wo)
    x = x + _B_ref(_layernorm(x, axis=-1), B_k, B_v, B_shift_k, B_ssm_k, B_ssm_D)
    return x
```

```asm
; @launch kernel=fused_kernel grid=(256,1,1) block=(256,1,1) lds=163840
.amdgcn_target "amdgcn-amd-amdhsa--gfx950"
.text
.globl fused_kernel
.p2align 8
.type fused_kernel,@function
fused_kernel:
    s_cmp_ge_u32 s2, 256
    s_cbranch_scc1 KF_END
    s_load_dwordx8 s[56:63], s[0:1], 72
    s_load_dwordx8 s[40:47], s[0:1], 0
    s_load_dwordx8 s[48:55], s[0:1], 40
    v_and_b32 v1, 63, v0
    v_lshrrev_b32 v5, 6, v0
    v_lshlrev_b32 v2, 4, v1
    v_readfirstlane_b32 s3, v5
    v_and_b32 v3, 15, v0
    v_bfe_u32 v4, v0, 4, 2
    s_getpc_b64 s[36:37]
KF_PC:
    v_lshlrev_b32 v7, 4, v0
    s_lshr_b32 s6, s2, 3
    s_lshl_b32 s6, s6, 12
    v_add_u32 v7, s6, v7
    v_min_u32 v7, KF_END-KF_PC-16, v7
    global_load_dwordx4 a[252:255], v7, s[36:37]
    s_and_b32 s4, s2, 7
    s_lshr_b32 s5, s2, 3
    s_lshr_b32 s20, s4, 1
    s_lshl_b32 s20, s20, 2
    s_lshr_b32 s6, s5, 3
    s_add_u32 s20, s20, s6
    s_and_b32 s21, s4, 1
    s_lshl_b32 s21, s21, 3
    s_and_b32 s7, s5, 7
    s_add_u32 s21, s21, s7
    s_mul_i32 s22, s6, 3
    s_add_u32 s22, s22, s7
    s_mul_i32 s23, s6, 5
    s_add_u32 s23, s23, s7
    s_sub_u32 s23, s23, 3
    s_cmp_lt_u32 s7, 3
    s_cselect_b32 s32, 1, 0
    s_cselect_b32 s34, s22, s23
    s_cselect_b32 s23, 144, 0
    s_lshl_b32 s34, s34, 3
    s_add_u32 s34, s34, s4
    s_add_u32 s23, s23, s34
    s_mul_i32 s22, s32, 48
    s_add_u32 s22, s22, 144
    s_cmp_lt_u32 s23, s22
    s_cselect_b32 s16, 1, 0
    s_cmp_ge_u32 s3, 1
    s_cselect_b32 s71, s16, 0
    s_mul_i32 s70, s23, 3
    s_add_u32 s70, s70, s3
    s_sub_u32 s70, s70, 1
    s_cmp_eq_u32 s32, 0
    s_cbranch_scc1 KF_RN
    s_and_b32 s4, s34, 7
    s_mul_i32 s4, s4, 12
    s_lshr_b32 s5, s34, 3
    s_add_u32 s4, s4, s5
    s_and_b32 s5, s4, 15
    s_lshr_b32 s6, s4, 4
    s_mul_i32 s34, s5, 6
    s_add_u32 s34, s34, s6
    s_mov_b32 s30, 20736
    s_mov_b32 s31, 0x20000
    s_mov_b32 s26, 1990656
    s_mov_b32 s27, 0x20000
    s_mul_i32 s23, s5, 1296
    v_lshlrev_b32 v9, 1, v0
    v_mul_u32_u24 v5, 4370, v1
    v_lshrrev_b32 v5, 16, v5
    v_mul_u32_u24 v6, 15, v5
    v_sub_u32 v6, v1, v6
    v_mul_u32_u24 v7, 13108, v6
    v_lshrrev_b32 v7, 16, v7
    v_mul_u32_u24 v8, 5, v7
    v_sub_u32 v8, v6, v8
    v_mul_u32_u24 v5, 3456, v5
    v_mul_u32_u24 v7, 1152, v7
    v_lshlrev_b32 v8, 4, v8
    v_add3_u32 v5, v5, v7, v8
    s_mul_i32 s7, s6, 96
    s_mul_i32 s22, s3, 24
    s_add_u32 s7, s7, s22
    s_mul_i32 s7, s7, 3456
    s_mul_i32 s22, s5, 72
    s_add_u32 s7, s7, s22
    s_mul_i32 s22, s3, 5760
    s_add_u32 s22, s22, 86016
    s_waitcnt lgkmcnt(0)
    s_mov_b32 s28, s44
    s_mov_b32 s29, s45
    s_mov_b32 s24, s42
    s_mov_b32 s25, s43
    buffer_load_ushort v10, v9, s[28:31], s23 offen offset:0
    buffer_load_ushort v11, v9, s[28:31], s23 offen offset:512
    buffer_load_ushort v12, v9, s[28:31], s23 offen offset:1024
    s_mov_b32 exec_hi, 0x0fffffff
    s_mov_b32 m0, s22
    s_nop 0
    buffer_load_dwordx4 v5, s[24:27], s7 offen lds
    s_add_u32 s7, s7, 13824
    s_add_u32 s22, s22, 960
    s_mov_b32 m0, s22
    s_nop 0
    buffer_load_dwordx4 v5, s[24:27], s7 offen lds
    s_add_u32 s7, s7, 13824
    s_add_u32 s22, s22, 960
    s_mov_b32 m0, s22
    s_nop 0
    buffer_load_dwordx4 v5, s[24:27], s7 offen lds
    s_add_u32 s7, s7, 13824
    s_add_u32 s22, s22, 960
    s_mov_b32 m0, s22
    s_nop 0
    buffer_load_dwordx4 v5, s[24:27], s7 offen lds
    s_add_u32 s7, s7, 13824
    s_add_u32 s22, s22, 960
    s_mov_b32 m0, s22
    s_nop 0
    buffer_load_dwordx4 v5, s[24:27], s7 offen lds
    s_add_u32 s7, s7, 13824
    s_add_u32 s22, s22, 960
    s_mov_b32 m0, s22
    s_nop 0
    buffer_load_dwordx4 v5, s[24:27], s7 offen lds
    s_mov_b32 exec_hi, -1
    s_cmp_eq_u32 s71, 0
    s_cselect_b32 s70, 0, s70
    s_lshl_b32 s18, s70, 12
    s_cmp_eq_u32 s71, 0
    s_cselect_b32 s18, 0x7ff00000, s18
    s_mul_i32 s19, s3, 21504
    s_add_u32 s19, s19, 64512
    s_lshl_b32 s69, s21, 8
    s_add_u32 s69, s69, 15040512
    v_mov_b32 v250, 1
    v_mov_b32 v251, 0
    s_mul_i32 s35, s3, 2304
    s_add_u32 s35, s35, 154624
    v_lshrrev_b32 v5, 3, v1
    v_and_b32 v6, 7, v1
    v_lshlrev_b32 v6, 4, v6
    v_mul_u32_u24 v7, 1152, v5
    v_add_u32 v252, v7, v6
    v_mul_u32_u24 v7, 144, v5
    v_add3_u32 v253, v7, v6, s35
    s_lshl_b32 s33, s20, 2
    s_add_u32 s33, s33, s3
    s_mul_i32 s65, s33, 36864
    s_add_u32 s66, s65, 18432
    v_add_u32 v255, 9216, v252
    v_lshlrev_b32 v6, 4, v4
    v_mul_u32_u24 v7, 144, v3
    v_add3_u32 v254, v7, v6, s35
    s_mov_b32 s68, 0x40000
    s_lshr_b32 s7, s70, 1
    s_lshl_b32 s7, s7, 2
    s_mov_b32 s72, s40
    s_mov_b32 s73, s41
    s_mov_b32 s74, 2359296
    s_mov_b32 s75, 0x20000
    s_mov_b32 s8, s62
    s_mov_b32 s9, s63
    s_mov_b32 s10, 15056896
    s_mov_b32 s11, 0x20000
    s_mov_b32 s12, s60
    s_mov_b32 s13, s61
    s_mov_b32 s14, 256
    s_mov_b32 s15, 0x20000
    s_mov_b64 s[0:1], s[58:59]
    s_load_dword s17, s[56:57], s7
    v_mov_b32 v160, 0
    v_mov_b32 v161, 0
    v_mov_b32 v162, 0
    v_mov_b32 v163, 0
    v_lshlrev_b32 v14, 4, v0
    v_add_u32 v14, 86016, v14
    ds_write_b128 v14, v[160:163] offset:23040
    ds_write_b128 v14, v[160:163] offset:27136
    ds_write_b128 v14, v[160:163] offset:31232
    ds_write_b128 v14, v[160:163] offset:35328
    ds_write_b128 v14, v[160:163] offset:39424
    ds_write_b128 v14, v[160:163] offset:43520
    ds_write_b128 v14, v[160:163] offset:47616
    ds_write_b128 v14, v[160:163] offset:51712
    ds_write_b128 v14, v[160:163] offset:55808
    v_add_u32 v220, 0, v0
    v_cmp_le_u32 vcc, 324, v220
    s_nop 1
    v_cndmask_b32 v221, 0, 1, vcc
    v_mul_u32_u24 v222, 324, v221
    v_sub_u32 v222, v220, v222
    v_mul_u32_u24 v223, 3641, v222
    v_lshrrev_b32 v223, 16, v223
    v_mul_u32_u24 v224, 18, v223
    v_sub_u32 v224, v222, v224
    v_lshrrev_b32 v225, 2, v224
    v_lshlrev_b32 v225, 4, v225
    v_and_b32 v224, 3, v224
    v_add_u32 v225, v225, v224
    v_lshl_add_u32 v225, v221, 3, v225
    v_mul_u32_u24 v225, 272, v225
    v_add_u32 v225, 86016, v225
    v_mul_u32_u24 v221, 18, v221
    v_add_u32 v221, v221, v223
    v_lshl_add_u32 v226, v221, 1, v225
    v_add_u32 v220, 256, v0
    v_cmp_le_u32 vcc, 324, v220
    s_nop 1
    v_cndmask_b32 v221, 0, 1, vcc
    v_mul_u32_u24 v222, 324, v221
    v_sub_u32 v222, v220, v222
    v_mul_u32_u24 v223, 3641, v222
    v_lshrrev_b32 v223, 16, v223
    v_mul_u32_u24 v224, 18, v223
    v_sub_u32 v224, v222, v224
    v_lshrrev_b32 v225, 2, v224
    v_lshlrev_b32 v225, 4, v225
    v_and_b32 v224, 3, v224
    v_add_u32 v225, v225, v224
    v_lshl_add_u32 v225, v221, 3, v225
    v_mul_u32_u24 v225, 272, v225
    v_add_u32 v225, 86016, v225
    v_mul_u32_u24 v221, 18, v221
    v_add_u32 v221, v221, v223
    v_lshl_add_u32 v227, v221, 1, v225
    v_add_u32 v220, 512, v0
    v_cmp_le_u32 vcc, 324, v220
    s_nop 1
    v_cndmask_b32 v221, 0, 1, vcc
    v_mul_u32_u24 v222, 324, v221
    v_sub_u32 v222, v220, v222
    v_mul_u32_u24 v223, 3641, v222
    v_lshrrev_b32 v223, 16, v223
    v_mul_u32_u24 v224, 18, v223
    v_sub_u32 v224, v222, v224
    v_lshrrev_b32 v225, 2, v224
    v_lshlrev_b32 v225, 4, v225
    v_and_b32 v224, 3, v224
    v_add_u32 v225, v225, v224
    v_lshl_add_u32 v225, v221, 3, v225
    v_mul_u32_u24 v225, 272, v225
    v_add_u32 v225, 86016, v225
    v_mul_u32_u24 v221, 18, v221
    v_add_u32 v221, v221, v223
    v_lshl_add_u32 v228, v221, 1, v225
    v_cmp_le_u32 vcc, 18, v0
    s_nop 1
    v_cndmask_b32 v221, 0, 1, vcc
    v_mul_u32_u24 v222, 18, v221
    v_sub_u32 v222, v0, v222
    v_cmp_le_u32 vcc, 9, v222
    s_nop 1
    v_cndmask_b32 v223, 0, 1, vcc
    v_mul_u32_u24 v224, 9, v223
    v_sub_u32 v224, v222, v224
    v_add_u32 v224, 18, v224
    v_lshl_add_u32 v223, v221, 1, v223
    v_lshrrev_b32 v225, 2, v224
    v_lshlrev_b32 v225, 4, v225
    v_and_b32 v224, 3, v224
    v_add_u32 v225, v225, v224
    v_lshl_add_u32 v225, v223, 2, v225
    v_mul_u32_u24 v225, 272, v225
    v_add_u32 v225, 86016, v225
    v_lshl_add_u32 v229, v0, 1, v225
    v_mov_b32 v230, 0x3f80
    s_lshl_b32 s22, s3, 5
    v_add_u32 v14, s22, v3
    v_mul_u32_u24 v14, 272, v14
    v_lshl_add_u32 v14, v4, 4, v14
    v_add_u32 v14, 86016, v14
    v_lshrrev_b32 v15, 2, v3
    v_lshlrev_b32 v15, 3, v15
    v_and_b32 v220, 3, v3
    v_add_u32 v15, v15, v220
    v_mul_u32_u24 v15, 240, v15
    v_lshl_add_u32 v15, v4, 4, v15
    v_add_u32 v15, 86016, v15
    v_mov_b32 v232, 0x3f803f80
    v_mov_b32 v233, 0x3f803f80
    v_mov_b32 v234, 0x3f803f80
    v_mov_b32 v235, 0x3f803f80
    v_mov_b32 v236, 0
    v_mov_b32 v237, 0
    v_mov_b32 v238, 0
    v_mov_b32 v239, 0
    v_mov_b32 v240, 0
    v_mov_b32 v241, 0
    v_mov_b32 v242, 0
    v_mov_b32 v243, 0
    v_cmp_eq_u32 vcc, 3, v220
    s_cmp_eq_u32 s3, 3
    s_cselect_b64 s[48:49], vcc, 0
    s_mul_i32 s7, s5, 129024
    s_mul_i32 s22, s6, 21504
    s_add_u32 s7, s7, s22
    s_lshl_b32 s22, s3, 11
    s_add_u32 s7, s7, s22
    s_add_u32 s23, s7, 1024
    s_cmp_eq_u32 s3, 3
    s_cselect_b32 s23, 0x7ff00000, s23
    s_waitcnt lgkmcnt(0)
    s_barrier
    s_waitcnt vmcnt(8)
    ds_write_b16 v226, v10 offset:23056
    ds_write_b16 v226, v10 offset:24224
    s_waitcnt vmcnt(7)
    ds_write_b16 v227, v11 offset:23056
    ds_write_b16 v227, v11 offset:24224
    v_cmp_gt_u32 vcc, 136, v0
    s_and_saveexec_b64 s[30:31], vcc
    s_waitcnt vmcnt(6)
    ds_write_b16 v228, v12 offset:23056
    ds_write_b16 v228, v12 offset:24224
    s_mov_b64 exec, s[30:31]
    v_cmp_gt_u32 vcc, 36, v0
    s_and_saveexec_b64 s[30:31], vcc
    ds_write_b16 v229, v230 offset:23216
    s_mov_b64 exec, s[30:31]
    s_waitcnt vmcnt(0)
    s_waitcnt lgkmcnt(0)
    s_barrier
    ds_read_b128 a[32:35], v14 offset:23056
    ds_read_b128 a[64:67], v15 offset:0
    ds_read_b128 a[36:39], v14 offset:23120
    ds_read_b128 a[68:71], v15 offset:64
    ds_read_b128 a[40:43], v14 offset:23184
    ds_read_b128 a[72:75], v15 offset:128
    ds_read_b128 a[44:47], v14 offset:23248
    ds_read_b128 a[76:79], v15 offset:192
    ds_read_b128 a[48:51], v14 offset:27408
    ds_read_b128 a[52:55], v14 offset:27472
    ds_read_b128 a[56:59], v14 offset:27536
    ds_read_b128 a[60:63], v14 offset:27600
    ds_read_b128 a[80:83], v15 offset:960
    ds_read_b128 a[84:87], v15 offset:1024
    ds_read_b128 a[88:91], v15 offset:1088
    ds_read_b128 a[92:95], v15 offset:1152
    s_waitcnt lgkmcnt(14)
    v_mfma_f32_16x16x32_bf16 v[200:203], a[64:67], a[32:35], 0
    s_waitcnt lgkmcnt(7)
    v_mfma_f32_16x16x32_bf16 v[208:211], a[64:67], a[48:51], 0
    ds_read_b128 a[96:99], v15 offset:7680
    v_mfma_f32_16x16x32_bf16 v[200:203], a[68:71], a[36:39], v[200:203]
    s_waitcnt lgkmcnt(7)
    v_mfma_f32_16x16x32_bf16 v[208:211], a[68:71], a[52:55], v[208:211]
    ds_read_b128 a[100:103], v15 offset:7744
    v_mfma_f32_16x16x32_bf16 v[200:203], a[72:75], a[40:43], v[200:203]
    s_waitcnt lgkmcnt(7)
    v_mfma_f32_16x16x32_bf16 v[208:211], a[72:75], a[56:59], v[208:211]
    ds_read_b128 a[104:107], v15 offset:7808
    v_mfma_f32_16x16x32_bf16 v[200:203], a[76:79], a[44:47], v[200:203]
    s_waitcnt lgkmcnt(7)
    v_mfma_f32_16x16x32_bf16 v[208:211], a[76:79], a[60:63], v[208:211]
    ds_read_b128 a[108:111], v15 offset:7872
    s_waitcnt lgkmcnt(7)
    v_mfma_f32_16x16x32_bf16 v[204:207], a[80:83], a[32:35], 0
    v_mfma_f32_16x16x32_bf16 v[212:215], a[80:83], a[48:51], 0
    ds_read_b128 a[112:115], v15 offset:8640
    s_waitcnt lgkmcnt(7)
    v_mfma_f32_16x16x32_bf16 v[204:207], a[84:87], a[36:39], v[204:207]
    v_mfma_f32_16x16x32_bf16 v[212:215], a[84:87], a[52:55], v[212:215]
    ds_read_b128 a[116:119], v15 offset:8704
    s_waitcnt lgkmcnt(7)
    v_mfma_f32_16x16x32_bf16 v[204:207], a[88:91], a[40:43], v[204:207]
    v_mfma_f32_16x16x32_bf16 v[212:215], a[88:91], a[56:59], v[212:215]
    ds_read_b128 a[120:123], v15 offset:8768
    s_waitcnt lgkmcnt(7)
    v_mfma_f32_16x16x32_bf16 v[204:207], a[92:95], a[44:47], v[204:207]
    v_mfma_f32_16x16x32_bf16 v[212:215], a[92:95], a[60:63], v[212:215]
    ds_read_b128 a[124:127], v15 offset:8832
    v_cvt_pk_bf16_f32 v160, v200, v201
    v_cvt_pk_bf16_f32 v161, v202, v203
    s_nop 3
    v_cvt_pk_bf16_f32 v162, v204, v205
    v_cvt_pk_bf16_f32 v163, v206, v207
    v_cndmask_b32 v160, v160, v232, s[48:49]
    v_cndmask_b32 v161, v161, v232, s[48:49]
    v_cndmask_b32 v162, v162, v232, s[48:49]
    v_cndmask_b32 v163, v163, v232, s[48:49]
    buffer_store_dwordx4 v[160:163], v2, s[8:11], s7 offen sc1
    v_cvt_pk_bf16_f32 v164, v208, v209
    v_cvt_pk_bf16_f32 v165, v210, v211
    v_cvt_pk_bf16_f32 v166, v212, v213
    v_cvt_pk_bf16_f32 v167, v214, v215
    buffer_store_dwordx4 v[164:167], v2, s[8:11], s23 offen sc1
    s_add_u32 s7, s7, 7168
    s_add_u32 s23, s23, 7168
    s_waitcnt lgkmcnt(7)
    v_mfma_f32_16x16x32_bf16 v[200:203], a[96:99], a[32:35], 0
    v_mfma_f32_16x16x32_bf16 v[208:211], a[96:99], a[48:51], 0
    ds_read_b128 a[64:67], v15 offset:15360
    s_waitcnt lgkmcnt(7)
    v_mfma_f32_16x16x32_bf16 v[200:203], a[100:103], a[36:39], v[200:203]
    v_mfma_f32_16x16x32_bf16 v[208:211], a[100:103], a[52:55], v[208:211]
    ds_read_b128 a[68:71], v15 offset:15424
    s_waitcnt lgkmcnt(7)
    v_mfma_f32_16x16x32_bf16 v[200:203], a[104:107], a[40:43], v[200:203]
    v_mfma_f32_16x16x32_bf16 v[208:211], a[104:107], a[56:59], v[208:211]
    ds_read_b128 a[72:75], v15 offset:15488
    s_waitcnt lgkmcnt(7)
    v_mfma_f32_16x16x32_bf16 v[200:203], a[108:111], a[44:47], v[200:203]
    v_mfma_f32_16x16x32_bf16 v[208:211], a[108:111], a[60:63], v[208:211]
    ds_read_b128 a[76:79], v15 offset:15552
    s_waitcnt lgkmcnt(7)
    v_mfma_f32_16x16x32_bf16 v[204:207], a[112:115], a[32:35], 0
    v_mfma_f32_16x16x32_bf16 v[212:215], a[112:115], a[48:51], 0
    ds_read_b128 a[80:83], v15 offset:16320
    s_waitcnt lgkmcnt(7)
    v_mfma_f32_16x16x32_bf16 v[204:207], a[116:119], a[36:39], v[204:207]
    v_mfma_f32_16x16x32_bf16 v[212:215], a[116:119], a[52:55], v[212:215]
    ds_read_b128 a[84:87], v15 offset:16384
    s_waitcnt lgkmcnt(7)
    v_mfma_f32_16x16x32_bf16 v[204:207], a[120:123], a[40:43], v[204:207]
    v_mfma_f32_16x16x32_bf16 v[212:215], a[120:123], a[56:59], v[212:215]
    ds_read_b128 a[88:91], v15 offset:16448
    s_waitcnt lgkmcnt(7)
    v_mfma_f32_16x16x32_bf16 v[204:207], a[124:127], a[44:47], v[204:207]
    v_mfma_f32_16x16x32_bf16 v[212:215], a[124:127], a[60:63], v[212:215]
    ds_read_b128 a[92:95], v15 offset:16512
    v_cvt_pk_bf16_f32 v168, v200, v201
    v_cvt_pk_bf16_f32 v169, v202, v203
    s_nop 3
    v_cvt_pk_bf16_f32 v170, v204, v205
    v_cvt_pk_bf16_f32 v171, v206, v207
    v_cndmask_b32 v168, v168, v232, s[48:49]
    v_cndmask_b32 v169, v169, v232, s[48:49]
    v_cndmask_b32 v170, v170, v232, s[48:49]
    v_cndmask_b32 v171, v171, v232, s[48:49]
    buffer_store_dwordx4 v[168:171], v2, s[8:11], s7 offen sc1
    v_cvt_pk_bf16_f32 v172, v208, v209
    v_cvt_pk_bf16_f32 v173, v210, v211
    v_cvt_pk_bf16_f32 v174, v212, v213
    v_cvt_pk_bf16_f32 v175, v214, v215
    buffer_store_dwordx4 v[172:175], v2, s[8:11], s23 offen sc1
    s_add_u32 s7, s7, 7168
    s_add_u32 s23, s23, 7168
    s_waitcnt lgkmcnt(7)
    v_mfma_f32_16x16x32_bf16 v[200:203], a[64:67], a[32:35], 0
    v_mfma_f32_16x16x32_bf16 v[208:211], a[64:67], a[48:51], 0
    s_waitcnt lgkmcnt(6)
    v_mfma_f32_16x16x32_bf16 v[200:203], a[68:71], a[36:39], v[200:203]
    v_mfma_f32_16x16x32_bf16 v[208:211], a[68:71], a[52:55], v[208:211]
    s_waitcnt lgkmcnt(5)
    v_mfma_f32_16x16x32_bf16 v[200:203], a[72:75], a[40:43], v[200:203]
    v_mfma_f32_16x16x32_bf16 v[208:211], a[72:75], a[56:59], v[208:211]
    s_waitcnt lgkmcnt(4)
    v_mfma_f32_16x16x32_bf16 v[200:203], a[76:79], a[44:47], v[200:203]
    v_mfma_f32_16x16x32_bf16 v[208:211], a[76:79], a[60:63], v[208:211]
    s_waitcnt lgkmcnt(3)
    v_mfma_f32_16x16x32_bf16 v[204:207], a[80:83], a[32:35], 0
    v_mfma_f32_16x16x32_bf16 v[212:215], a[80:83], a[48:51], 0
    s_waitcnt lgkmcnt(2)
    v_mfma_f32_16x16x32_bf16 v[204:207], a[84:87], a[36:39], v[204:207]
    v_mfma_f32_16x16x32_bf16 v[212:215], a[84:87], a[52:55], v[212:215]
    s_waitcnt lgkmcnt(1)
    v_mfma_f32_16x16x32_bf16 v[204:207], a[88:91], a[40:43], v[204:207]
    v_mfma_f32_16x16x32_bf16 v[212:215], a[88:91], a[56:59], v[212:215]
    s_waitcnt lgkmcnt(0)
    v_mfma_f32_16x16x32_bf16 v[204:207], a[92:95], a[44:47], v[204:207]
    v_mfma_f32_16x16x32_bf16 v[212:215], a[92:95], a[60:63], v[212:215]
    v_cvt_pk_bf16_f32 v176, v200, v201
    v_cvt_pk_bf16_f32 v177, v202, v203
    s_nop 4
    v_cvt_pk_bf16_f32 v178, v204, v205
    v_cvt_pk_bf16_f32 v179, v206, v207
    v_cndmask_b32 v176, v176, v232, s[48:49]
    v_cndmask_b32 v177, v177, v232, s[48:49]
    v_cndmask_b32 v178, v178, v232, s[48:49]
    v_cndmask_b32 v179, v179, v232, s[48:49]
    buffer_store_dwordx4 v[176:179], v2, s[8:11], s7 offen sc1
    v_cvt_pk_bf16_f32 v180, v208, v209
    v_cvt_pk_bf16_f32 v181, v210, v211
    v_cvt_pk_bf16_f32 v182, v212, v213
    v_cvt_pk_bf16_f32 v183, v214, v215
    buffer_store_dwordx4 v[180:183], v2, s[8:11], s23 offen sc1
    v_mfma_f32_16x16x32_bf16 v[236:239], v[232:235], v[160:163], v[236:239]
    v_mfma_f32_16x16x32_bf16 v[240:243], v[232:235], v[164:167], v[240:243]
    v_mfma_f32_16x16x32_bf16 v[236:239], v[232:235], v[168:171], v[236:239]
    v_mfma_f32_16x16x32_bf16 v[240:243], v[232:235], v[172:175], v[240:243]
    v_mfma_f32_16x16x32_bf16 v[236:239], v[232:235], v[176:179], v[236:239]
    v_mfma_f32_16x16x32_bf16 v[240:243], v[232:235], v[180:183], v[240:243]
    s_mul_i32 s7, s34, 448
    s_lshl_b32 s22, s3, 7
    s_add_u32 s7, s7, s22
    s_add_u32 s7, s7, 2064384
    s_add_u32 s23, s7, 64
    s_cmp_eq_u32 s3, 3
    s_cselect_b32 s23, 0x7ff00000, s23
    v_lshlrev_b32 v221, 2, v1
    s_mov_b64 exec, 0xffff
    buffer_store_dword v236, v221, s[8:11], s7 offen sc1
    buffer_store_dword v240, v221, s[8:11], s23 offen sc1
    s_mov_b64 exec, -1
    buffer_load_dword v190, v251, s[12:15], 0 offen sc1
    s_lshl_b32 s5, s5, 8
    s_add_u32 s5, s5, 15040512
    s_waitcnt vmcnt(0)
    s_barrier
    s_cmp_eq_u32 s3, 0
    s_nop 0
    s_cbranch_scc0 KF_C1
    v_cmp_ne_u32 vcc, 1, v190
    s_cmp_eq_u64 vcc, 0
    s_cbranch_scc1 KF_RP_GO
KF_RP:
    buffer_load_dword v190, v251, s[12:15], 0 offen sc1
    s_waitcnt vmcnt(0)
    v_cmp_ne_u32 vcc, 1, v190
    s_sub_u32 s68, s68, 1
    s_cselect_b64 s[30:31], 0, vcc
    s_cselect_b32 s68, 0, s68
    s_cmp_eq_u64 s[30:31], 0
    s_cbranch_scc1 KF_RP_GO
    s_sleep 4
    s_branch KF_RP
KF_RP_GO:
    s_mov_b64 exec, 1
    buffer_atomic_add v250, v251, s[8:11], s5 offen sc1
    s_mov_b64 exec, -1
    s_nop 0
KF_C1:
    s_barrier
    buffer_load_dword a250, v251, s[12:15], 0 offen sc1
    buffer_load_dwordx4 v[16:19], v252, s[72:75], s65 offen offset:0
    buffer_load_dwordx4 v[24:27], v255, s[72:75], s65 offen offset:0
    buffer_load_dwordx4 v[20:23], v252, s[72:75], s66 offen offset:0
    buffer_load_dwordx4 v[28:31], v255, s[72:75], s66 offen offset:0
    buffer_load_dwordx4 v[32:35], v252, s[72:75], s65 offen offset:128
    buffer_load_dwordx4 v[40:43], v255, s[72:75], s65 offen offset:128
    buffer_load_dwordx4 v[36:39], v252, s[72:75], s66 offen offset:128
    buffer_load_dwordx4 v[44:47], v255, s[72:75], s66 offen offset:128
    buffer_load_dwordx4 v[48:51], v252, s[72:75], s65 offen offset:256
    buffer_load_dwordx4 v[56:59], v255, s[72:75], s65 offen offset:256
    buffer_load_dwordx4 v[52:55], v252, s[72:75], s66 offen offset:256
    buffer_load_dwordx4 v[60:63], v255, s[72:75], s66 offen offset:256
    s_branch KF_P4
KF_RN:
    s_cmp_eq_u32 s71, 0
    s_cselect_b32 s70, 0, s70
    s_lshl_b32 s18, s70, 12
    s_cmp_eq_u32 s71, 0
    s_cselect_b32 s18, 0x7ff00000, s18
    s_mul_i32 s19, s3, 21504
    s_add_u32 s19, s19, 64512
    s_lshl_b32 s69, s21, 8
    s_add_u32 s69, s69, 15040512
    v_mov_b32 v250, 1
    v_mov_b32 v251, 0
    s_mul_i32 s35, s3, 2304
    s_add_u32 s35, s35, 154624
    v_lshrrev_b32 v5, 3, v1
    v_and_b32 v6, 7, v1
    v_lshlrev_b32 v6, 4, v6
    v_mul_u32_u24 v7, 1152, v5
    v_add_u32 v252, v7, v6
    v_mul_u32_u24 v7, 144, v5
    v_add3_u32 v253, v7, v6, s35
    s_lshl_b32 s6, s20, 2
    s_add_u32 s6, s6, s3
    s_mul_i32 s65, s6, 36864
    s_add_u32 s66, s65, 18432
    v_add_u32 v255, 9216, v252
    v_lshlrev_b32 v6, 4, v4
    v_mul_u32_u24 v7, 144, v3
    v_add3_u32 v254, v7, v6, s35
    s_mov_b32 s68, 0x40000
    s_lshr_b32 s7, s70, 1
    s_lshl_b32 s7, s7, 2
    s_waitcnt lgkmcnt(0)
    s_mov_b32 s72, s40
    s_mov_b32 s73, s41
    s_mov_b32 s74, 2359296
    s_mov_b32 s75, 0x20000
    s_mov_b32 s8, s62
    s_mov_b32 s9, s63
    s_mov_b32 s10, 15056896
    s_mov_b32 s11, 0x20000
    s_mov_b32 s12, s60
    s_mov_b32 s13, s61
    s_mov_b32 s14, 256
    s_mov_b32 s15, 0x20000
    s_mov_b64 s[0:1], s[58:59]
    s_load_dword s17, s[56:57], s7
    s_cmp_ge_u32 s34, 144
    s_cbranch_scc1 KF_RI
    s_mov_b32 s5, 0x1c71c71d
    s_mul_hi_u32 s5, s34, s5
    s_mul_i32 s6, s5, 9
    s_sub_u32 s6, s34, s6
    v_and_b32 v5, 7, v1
    v_lshrrev_b32 v6, 3, v0
    s_lshl_b32 s7, s5, 7
    v_lshlrev_b32 v7, 2, v6
    v_add_u32 v7, s7, v7
    v_mul_u32_u24 v7, 1152, v7
    s_lshl_b32 s22, s6, 7
    v_lshlrev_b32 v8, 4, v5
    v_add3_u32 v7, v7, v8, s22
    v_subrev_u32 v9, 3456, v7
    s_mov_b32 s24, s48
    s_mov_b32 s25, s49
    s_mov_b32 s26, 2359296
    s_mov_b32 s27, 0x20000
    s_mov_b32 s28, s50
    s_mov_b32 s29, s51
    s_mov_b32 s30, 2359296
    s_mov_b32 s31, 0x20000
    s_mov_b32 s56, s52
    s_mov_b32 s57, s53
    s_mov_b32 s58, 4608
    s_mov_b32 s59, 0x20000
    s_mov_b32 s36, s42
    s_mov_b32 s37, s43
    s_mov_b32 s38, 1990656
    s_mov_b32 s39, 0x20000
    s_lshl_b32 s4, s34, 2
    s_add_u32 s4, s4, s3
    s_mul_i32 s4, s4, 3456
    v_lshlrev_b32 v11, 7, v1
    s_mov_b64 exec, 0x7ffffff
    buffer_load_dword a248, v11, s[36:39], s4 offen
    s_mov_b64 exec, -1
    buffer_load_dwordx4 v[160:163], v9, s[24:27], 0 offen offset:0
    buffer_load_dwordx4 v[164:167], v9, s[24:27], 0 offen offset:1152
    buffer_load_dwordx4 v[168:171], v9, s[24:27], 0 offen offset:2304
    buffer_load_dwordx4 v[172:175], v7, s[24:27], 0 offen offset:0
    buffer_load_dwordx4 v[176:179], v7, s[24:27], 0 offen offset:1152
    buffer_load_dwordx4 v[180:183], v7, s[24:27], 0 offen offset:2304
    buffer_load_dwordx4 v[184:187], v7, s[24:27], 0 offen offset:3456
    s_lshl_b32 s22, s6, 9
    v_lshlrev_b32 v10, 6, v5
    buffer_load_dwordx4 v[204:207], v10, s[56:59], s22 offen offset:0
    buffer_load_dwordx4 v[208:211], v10, s[56:59], s22 offen offset:16
    buffer_load_dwordx4 v[212:215], v10, s[56:59], s22 offen offset:32
    buffer_load_dwordx4 v[216:219], v10, s[56:59], s22 offen offset:48
    buffer_load_dwordx4 v[188:191], v7, s[28:31], 0 offen offset:0
    buffer_load_dwordx4 v[192:195], v7, s[28:31], 0 offen offset:1152
    buffer_load_dwordx4 v[196:199], v7, s[28:31], 0 offen offset:2304
    buffer_load_dwordx4 v[200:203], v7, s[28:31], 0 offen offset:3456
    s_and_b32 s4, s21, 7
    s_sub_u32 s4, s4, 3
    s_mul_i32 s4, s4, 7424
    v_lshlrev_b32 v11, 7, v1
    v_add_u32 v11, s4, v11
    v_cmp_gt_u32 vcc, 36864, v11
    s_and_b32 exec_hi, vcc_hi, 0x3ffffff
    buffer_load_dword a246, v11, s[72:75], s65 offen offset:0
    s_mov_b32 exec_hi, -1
    s_mul_i32 s22, s3, 4608
    s_add_u32 s22, s22, 86016
    v_lshrrev_b32 v11, 3, v1
    v_sub_u32 v11, 7, v11
    v_lshlrev_b32 v11, 3, v11
    v_mul_u32_u24 v12, 576, v5
    v_add3_u32 v12, v12, v11, s22
    s_mov_b32 s23, 0xffff0000
    v_lshrrev_b32 v13, 5, v1
    v_lshlrev_b32 v13, 6, v13
    v_add3_u32 v13, v13, v2, s22
    s_lshl_b32 s4, s5, 2
    s_add_u32 s4, s4, s3
    s_sub_u32 s4, 63, s4
    s_mul_i32 s22, s4, 36864
    s_lshl_b32 s4, s6, 12
    s_add_u32 s22, s22, s4
    s_add_u32 s22, s22, 2785280
    s_waitcnt vmcnt(15)
    v_lshlrev_b32 v220, 16, v160
    v_and_b32 v221, s23, v160
    s_waitcnt vmcnt(14)
    v_lshlrev_b32 v222, 16, v164
    v_and_b32 v223, s23, v164
    s_waitcnt vmcnt(13)
    v_lshlrev_b32 v224, 16, v168
    v_and_b32 v225, s23, v168
    s_waitcnt vmcnt(12)
    v_lshlrev_b32 v226, 16, v172
    v_and_b32 v227, s23, v172
    s_waitcnt vmcnt(11)
    v_lshlrev_b32 v228, 16, v176
    v_and_b32 v229, s23, v176
    s_waitcnt vmcnt(10)
    v_lshlrev_b32 v230, 16, v180
    v_and_b32 v231, s23, v180
    s_waitcnt vmcnt(9)
    v_lshlrev_b32 v232, 16, v184
    v_and_b32 v233, s23, v184
    s_waitcnt vmcnt(8)
    v_lshlrev_b32 v234, 16, v204
    v_and_b32 v236, s23, v204
    v_lshlrev_b32 v238, 16, v205
    v_and_b32 v240, s23, v205
    v_lshlrev_b32 v235, 16, v206
    v_and_b32 v237, s23, v206
    v_lshlrev_b32 v239, 16, v207
    v_and_b32 v241, s23, v207
    v_pk_mul_f32 v[242:243], v[220:221], v[240:241]
    v_pk_mul_f32 v[244:245], v[222:223], v[240:241]
    buffer_load_dwordx4 v[16:19], v252, s[72:75], s65 offen offset:0
    v_pk_mul_f32 v[246:247], v[224:225], v[240:241]
    v_pk_mul_f32 v[248:249], v[226:227], v[240:241]
    v_pk_fma_f32 v[242:243], v[222:223], v[238:239], v[242:243]
    v_pk_fma_f32 v[244:245], v[224:225], v[238:239], v[244:245]
    v_pk_fma_f32 v[246:247], v[226:227], v[238:239], v[246:247]
    v_pk_fma_f32 v[248:249], v[228:229], v[238:239], v[248:249]
    v_pk_fma_f32 v[242:243], v[224:225], v[236:237], v[242:243]
    v_pk_fma_f32 v[244:245], v[226:227], v[236:237], v[244:245]
    v_pk_fma_f32 v[246:247], v[228:229], v[236:237], v[246:247]
    v_pk_fma_f32 v[248:249], v[230:231], v[236:237], v[248:249]
    v_pk_fma_f32 v[242:243], v[226:227], v[234:235], v[242:243]
    v_pk_fma_f32 v[244:245], v[228:229], v[234:235], v[244:245]
    buffer_load_dwordx4 v[24:27], v255, s[72:75], s65 offen offset:0
    v_pk_fma_f32 v[246:247], v[230:231], v[234:235], v[246:247]
    v_pk_fma_f32 v[248:249], v[232:233], v[234:235], v[248:249]
    s_waitcnt vmcnt(6)
    v_lshlrev_b32 v220, 16, v188
    v_and_b32 v221, s23, v188
    s_waitcnt vmcnt(5)
    v_lshlrev_b32 v222, 16, v192
    v_and_b32 v223, s23, v192
    s_waitcnt vmcnt(4)
    v_lshlrev_b32 v224, 16, v196
    v_and_b32 v225, s23, v196
    s_waitcnt vmcnt(3)
    v_lshlrev_b32 v226, 16, v200
    v_and_b32 v227, s23, v200
    v_pk_mul_f32 v[242:243], v[242:243], v[220:221]
    v_pk_mul_f32 v[244:245], v[244:245], v[222:223]
    v_pk_mul_f32 v[246:247], v[246:247], v[224:225]
    v_pk_mul_f32 v[248:249], v[248:249], v[226:227]
    v_cvt_pk_bf16_f32 v228, v248, v246
    v_cvt_pk_bf16_f32 v229, v244, v242
    ds_write_b64 v12, v[228:229] offset:0
    buffer_load_dwordx4 v[20:23], v252, s[72:75], s66 offen offset:0
    v_cvt_pk_bf16_f32 v230, v249, v247
    v_cvt_pk_bf16_f32 v231, v245, v243
    ds_write_b64 v12, v[230:231] offset:64
    v_lshlrev_b32 v220, 16, v161
    v_and_b32 v221, s23, v161
    v_lshlrev_b32 v222, 16, v165
    v_and_b32 v223, s23, v165
    v_lshlrev_b32 v224, 16, v169
    v_and_b32 v225, s23, v169
    v_lshlrev_b32 v226, 16, v173
    v_and_b32 v227, s23, v173
    v_lshlrev_b32 v228, 16, v177
    v_and_b32 v229, s23, v177
    v_lshlrev_b32 v230, 16, v181
    v_and_b32 v231, s23, v181
    v_lshlrev_b32 v232, 16, v185
    v_and_b32 v233, s23, v185
    v_lshlrev_b32 v234, 16, v208
    v_and_b32 v236, s23, v208
    v_lshlrev_b32 v238, 16, v209
    v_and_b32 v240, s23, v209
    v_lshlrev_b32 v235, 16, v210
    v_and_b32 v237, s23, v210
    v_lshlrev_b32 v239, 16, v211
    v_and_b32 v241, s23, v211
    v_pk_mul_f32 v[242:243], v[220:221], v[240:241]
    buffer_load_dwordx4 v[28:31], v255, s[72:75], s66 offen offset:0
    v_pk_mul_f32 v[244:245], v[222:223], v[240:241]
    v_pk_mul_f32 v[246:247], v[224:225], v[240:241]
    v_pk_mul_f32 v[248:249], v[226:227], v[240:241]
    v_pk_fma_f32 v[242:243], v[222:223], v[238:239], v[242:243]
    v_pk_fma_f32 v[244:245], v[224:225], v[238:239], v[244:245]
    v_pk_fma_f32 v[246:247], v[226:227], v[238:239], v[246:247]
    v_pk_fma_f32 v[248:249], v[228:229], v[238:239], v[248:249]
    v_pk_fma_f32 v[242:243], v[224:225], v[236:237], v[242:243]
    v_pk_fma_f32 v[244:245], v[226:227], v[236:237], v[244:245]
    v_pk_fma_f32 v[246:247], v[228:229], v[236:237], v[246:247]
    v_pk_fma_f32 v[248:249], v[230:231], v[236:237], v[248:249]
    v_pk_fma_f32 v[242:243], v[226:227], v[234:235], v[242:243]
    buffer_load_dwordx4 v[32:35], v252, s[72:75], s65 offen offset:128
    v_pk_fma_f32 v[244:245], v[228:229], v[234:235], v[244:245]
    v_pk_fma_f32 v[246:247], v[230:231], v[234:235], v[246:247]
    v_pk_fma_f32 v[248:249], v[232:233], v[234:235], v[248:249]
    v_lshlrev_b32 v220, 16, v189
    v_and_b32 v221, s23, v189
    v_lshlrev_b32 v222, 16, v193
    v_and_b32 v223, s23, v193
    v_lshlrev_b32 v224, 16, v197
    v_and_b32 v225, s23, v197
    v_lshlrev_b32 v226, 16, v201
    v_and_b32 v227, s23, v201
    v_pk_mul_f32 v[242:243], v[242:243], v[220:221]
    v_pk_mul_f32 v[244:245], v[244:245], v[222:223]
    v_pk_mul_f32 v[246:247], v[246:247], v[224:225]
    v_pk_mul_f32 v[248:249], v[248:249], v[226:227]
    v_cvt_pk_bf16_f32 v228, v248, v246
    v_cvt_pk_bf16_f32 v229, v244, v242
    buffer_load_dwordx4 v[40:43], v255, s[72:75], s65 offen offset:128
    ds_write_b64 v12, v[228:229] offset:128
    v_cvt_pk_bf16_f32 v230, v249, v247
    v_cvt_pk_bf16_f32 v231, v245, v243
    ds_write_b64 v12, v[230:231] offset:192
    v_lshlrev_b32 v220, 16, v162
    v_and_b32 v221, s23, v162
    v_lshlrev_b32 v222, 16, v166
    v_and_b32 v223, s23, v166
    v_lshlrev_b32 v224, 16, v170
    v_and_b32 v225, s23, v170
    v_lshlrev_b32 v226, 16, v174
    v_and_b32 v227, s23, v174
    v_lshlrev_b32 v228, 16, v178
    v_and_b32 v229, s23, v178
    v_lshlrev_b32 v230, 16, v182
    v_and_b32 v231, s23, v182
    v_lshlrev_b32 v232, 16, v186
    v_and_b32 v233, s23, v186
    v_lshlrev_b32 v234, 16, v212
    v_and_b32 v236, s23, v212
    v_lshlrev_b32 v238, 16, v213
    v_and_b32 v240, s23, v213
    v_lshlrev_b32 v235, 16, v214
    v_and_b32 v237, s23, v214
    v_lshlrev_b32 v239, 16, v215
    v_and_b32 v241, s23, v215
    buffer_load_dwordx4 v[36:39], v252, s[72:75], s66 offen offset:128
    v_pk_mul_f32 v[242:243], v[220:221], v[240:241]
    v_pk_mul_f32 v[244:245], v[222:223], v[240:241]
    v_pk_mul_f32 v[246:247], v[224:225], v[240:241]
    v_pk_mul_f32 v[248:249], v[226:227], v[240:241]
    v_pk_fma_f32 v[242:243], v[222:223], v[238:239], v[242:243]
    v_pk_fma_f32 v[244:245], v[224:225], v[238:239], v[244:245]
    v_pk_fma_f32 v[246:247], v[226:227], v[238:239], v[246:247]
    v_pk_fma_f32 v[248:249], v[228:229], v[238:239], v[248:249]
    v_pk_fma_f32 v[242:243], v[224:225], v[236:237], v[242:243]
    v_pk_fma_f32 v[244:245], v[226:227], v[236:237], v[244:245]
    v_pk_fma_f32 v[246:247], v[228:229], v[236:237], v[246:247]
    v_pk_fma_f32 v[248:249], v[230:231], v[236:237], v[248:249]
    buffer_load_dwordx4 v[44:47], v255, s[72:75], s66 offen offset:128
    v_pk_fma_f32 v[242:243], v[226:227], v[234:235], v[242:243]
    v_pk_fma_f32 v[244:245], v[228:229], v[234:235], v[244:245]
    v_pk_fma_f32 v[246:247], v[230:231], v[234:235], v[246:247]
    v_pk_fma_f32 v[248:249], v[232:233], v[234:235], v[248:249]
    v_lshlrev_b32 v220, 16, v190
    v_and_b32 v221, s23, v190
    v_lshlrev_b32 v222, 16, v194
    v_and_b32 v223, s23, v194
    v_lshlrev_b32 v224, 16, v198
    v_and_b32 v225, s23, v198
    v_lshlrev_b32 v226, 16, v202
    v_and_b32 v227, s23, v202
    v_pk_mul_f32 v[242:243], v[242:243], v[220:221]
    v_pk_mul_f32 v[244:245], v[244:245], v[222:223]
    v_pk_mul_f32 v[246:247], v[246:247], v[224:225]
    v_pk_mul_f32 v[248:249], v[248:249], v[226:227]
    v_cvt_pk_bf16_f32 v228, v248, v246
    v_cvt_pk_bf16_f32 v229, v244, v242
    ds_write_b64 v12, v[228:229] offset:256
    v_cvt_pk_bf16_f32 v230, v249, v247
    v_cvt_pk_bf16_f32 v231, v245, v243
    ds_write_b64 v12, v[230:231] offset:320
    v_lshlrev_b32 v220, 16, v163
    v_and_b32 v221, s23, v163
    v_lshlrev_b32 v222, 16, v167
    v_and_b32 v223, s23, v167
    v_lshlrev_b32 v224, 16, v171
    v_and_b32 v225, s23, v171
    v_lshlrev_b32 v226, 16, v175
    v_and_b32 v227, s23, v175
    v_lshlrev_b32 v228, 16, v179
    v_and_b32 v229, s23, v179
    v_lshlrev_b32 v230, 16, v183
    v_and_b32 v231, s23, v183
    v_lshlrev_b32 v232, 16, v187
    v_and_b32 v233, s23, v187
    v_lshlrev_b32 v234, 16, v216
    v_and_b32 v236, s23, v216
    v_lshlrev_b32 v238, 16, v217
    v_and_b32 v240, s23, v217
    v_lshlrev_b32 v235, 16, v218
    v_and_b32 v237, s23, v218
    v_lshlrev_b32 v239, 16, v219
    v_and_b32 v241, s23, v219
    v_pk_mul_f32 v[242:243], v[220:221], v[240:241]
    v_pk_mul_f32 v[244:245], v[222:223], v[240:241]
    v_pk_mul_f32 v[246:247], v[224:225], v[240:241]
    v_pk_mul_f32 v[248:249], v[226:227], v[240:241]
    v_pk_fma_f32 v[242:243], v[222:223], v[238:239], v[242:243]
    v_pk_fma_f32 v[244:245], v[224:225], v[238:239], v[244:245]
    v_pk_fma_f32 v[246:247], v[226:227], v[238:239], v[246:247]
    v_pk_fma_f32 v[248:249], v[228:229], v[238:239], v[248:249]
    v_pk_fma_f32 v[242:243], v[224:225], v[236:237], v[242:243]
    v_pk_fma_f32 v[244:245], v[226:227], v[236:237], v[244:245]
    v_pk_fma_f32 v[246:247], v[228:229], v[236:237], v[246:247]
    v_pk_fma_f32 v[248:249], v[230:231], v[236:237], v[248:249]
    v_pk_fma_f32 v[242:243], v[226:227], v[234:235], v[242:243]
    v_pk_fma_f32 v[244:245], v[228:229], v[234:235], v[244:245]
    v_pk_fma_f32 v[246:247], v[230:231], v[234:235], v[246:247]
    v_pk_fma_f32 v[248:249], v[232:233], v[234:235], v[248:249]
    v_lshlrev_b32 v220, 16, v191
    v_and_b32 v221, s23, v191
    v_lshlrev_b32 v222, 16, v195
    v_and_b32 v223, s23, v195
    v_lshlrev_b32 v224, 16, v199
    v_and_b32 v225, s23, v199
    v_lshlrev_b32 v226, 16, v203
    v_and_b32 v227, s23, v203
    v_pk_mul_f32 v[242:243], v[242:243], v[220:221]
    v_pk_mul_f32 v[244:245], v[244:245], v[222:223]
    v_pk_mul_f32 v[246:247], v[246:247], v[224:225]
    v_pk_mul_f32 v[248:249], v[248:249], v[226:227]
    v_cvt_pk_bf16_f32 v228, v248, v246
    v_cvt_pk_bf16_f32 v229, v244, v242
    ds_write_b64 v12, v[228:229] offset:384
    v_cvt_pk_bf16_f32 v230, v249, v247
    v_cvt_pk_bf16_f32 v231, v245, v243
    ds_write_b64 v12, v[230:231] offset:448
    buffer_load_dword a250, v251, s[12:15], 0 offen sc1
    ds_read_b128 v[160:163], v13 offset:0
    ds_read_b128 v[164:167], v13 offset:1152
    ds_read_b128 v[168:171], v13 offset:2304
    ds_read_b128 v[172:175], v13 offset:3456
    s_waitcnt lgkmcnt(0)
    buffer_store_dwordx4 v[160:163], v2, s[8:11], s22 offen offset:0 sc1
    buffer_store_dwordx4 v[164:167], v2, s[8:11], s22 offen offset:1024 sc1
    buffer_store_dwordx4 v[168:171], v2, s[8:11], s22 offen offset:2048 sc1
    buffer_store_dwordx4 v[172:175], v2, s[8:11], s22 offen offset:3072 sc1
    buffer_load_dwordx4 v[48:51], v252, s[72:75], s65 offen offset:256
    buffer_load_dwordx4 v[56:59], v255, s[72:75], s65 offen offset:256
    buffer_load_dwordx4 v[52:55], v252, s[72:75], s66 offen offset:256
    buffer_load_dwordx4 v[60:63], v255, s[72:75], s66 offen offset:256
    s_branch KF_P4
KF_RI:
    s_lshl_b32 s50, s34, 2
    s_add_u32 s50, s50, s3
    s_sub_u32 s50, s50, 576
    s_cmp_eq_u32 s50, 63
    s_nop 0
    s_cbranch_scc0 KF_C2
    v_lshlrev_b32 v5, 8, v1
    s_mov_b32 s4, 15040512
    buffer_store_dword v251, v5, s[8:11], s4 offen sc1
    s_waitcnt vmcnt(0)
    s_mov_b64 exec, 1
    buffer_store_dword v250, v251, s[12:15], 0 offen sc1
    s_mov_b64 exec, -1
    s_nop 0
KF_C2:
    s_mov_b32 s28, s46
    s_mov_b32 s29, s47
    s_mov_b32 s30, 663552
    s_mov_b32 s31, 0x20000
    s_mov_b32 s4, 0x55555556
    s_mul_hi_u32 s52, s50, s4
    s_mul_i32 s53, s52, 3
    s_sub_u32 s53, s50, s53
    v_lshrrev_b32 v5, 3, v1
    v_and_b32 v6, 7, v1
    v_lshlrev_b32 v6, 4, v6
    v_lshrrev_b32 v7, 1, v5
    v_mul_u32_u24 v7, 18, v7
    v_and_b32 v8, 1, v5
    v_add3_u32 v7, v7, v8, 16
    s_cmp_lt_u32 s52, 16
    s_cselect_b64 vcc, -1, 0
    v_cndmask_b32 v7, v7, v5, vcc
    v_mul_u32_u24 v7, 1152, v7
    v_add_u32 v7, v7, v6
    s_mul_i32 s4, s52, 36
    s_mul_i32 s5, s52, 288
    s_sub_u32 s5, s5, 4608
    s_mul_i32 s6, s53, 384
    s_add_u32 s22, s4, 0
    s_add_u32 s23, s5, 0
    s_cmp_lt_u32 s52, 16
    s_cselect_b32 s22, s22, s23
    s_mul_i32 s22, s22, 1152
    s_add_u32 s22, s22, s6
    s_cmp_lt_u32 s50, 54
    s_cselect_b32 s22, s22, 0x7ff00000
    buffer_load_dwordx4 v[160:163], v7, s[28:31], s22 offen offset:0
    buffer_load_dwordx4 v[164:167], v7, s[28:31], s22 offen offset:128
    buffer_load_dwordx4 v[168:171], v7, s[28:31], s22 offen offset:256
    s_add_u32 s22, s4, 8
    s_add_u32 s23, s5, 72
    s_cmp_lt_u32 s52, 16
    s_cselect_b32 s22, s22, s23
    s_mul_i32 s22, s22, 1152
    s_add_u32 s22, s22, s6
    s_cmp_lt_u32 s50, 54
    s_cselect_b32 s22, s22, 0x7ff00000
    buffer_load_dwordx4 v[172:175], v7, s[28:31], s22 offen offset:0
    buffer_load_dwordx4 v[176:179], v7, s[28:31], s22 offen offset:128
    buffer_load_dwordx4 v[180:183], v7, s[28:31], s22 offen offset:256
    s_add_u32 s22, s4, 18
    s_add_u32 s23, s5, 144
    s_cmp_lt_u32 s52, 16
    s_cselect_b32 s22, s22, s23
    s_mul_i32 s22, s22, 1152
    s_add_u32 s22, s22, s6
    s_cmp_lt_u32 s50, 54
    s_cselect_b32 s22, s22, 0x7ff00000
    buffer_load_dwordx4 v[184:187], v7, s[28:31], s22 offen offset:0
    buffer_load_dwordx4 v[188:191], v7, s[28:31], s22 offen offset:128
    buffer_load_dwordx4 v[192:195], v7, s[28:31], s22 offen offset:256
    s_add_u32 s22, s4, 26
    s_add_u32 s23, s5, 216
    s_cmp_lt_u32 s52, 16
    s_cselect_b32 s22, s22, s23
    s_mul_i32 s22, s22, 1152
    s_add_u32 s22, s22, s6
    s_cmp_lt_u32 s50, 54
    s_cselect_b32 s22, s22, 0x7ff00000
    buffer_load_dwordx4 v[196:199], v7, s[28:31], s22 offen offset:0
    buffer_load_dwordx4 v[200:203], v7, s[28:31], s22 offen offset:128
    buffer_load_dwordx4 v[204:207], v7, s[28:31], s22 offen offset:256
    s_mul_i32 s4, s3, 12800
    s_add_u32 s4, s4, 86016
    v_mul_u32_u24 v8, 400, v5
    v_add3_u32 v8, v8, v6, s4
    v_lshrrev_b32 v9, 2, v3
    v_lshl_add_u32 v9, v4, 3, v9
    v_mul_u32_u24 v9, 400, v9
    v_and_b32 v10, 3, v3
    v_lshlrev_b32 v10, 3, v10
    v_add3_u32 v9, v9, v10, s4
    s_mul_i32 s22, s53, 216
    s_add_u32 s22, s22, s52
    s_lshl_b32 s22, s22, 10
    s_add_u32 s22, s22, 2113536
    s_cmp_lt_u32 s50, 54
    s_cselect_b32 s22, s22, 0x7ff00000
    s_and_b32 s4, s21, 7
    s_sub_u32 s4, s4, 3
    s_mul_i32 s4, s4, 7424
    v_lshlrev_b32 v11, 7, v1
    v_add_u32 v11, s4, v11
    v_cmp_gt_u32 vcc, 36864, v11
    s_and_b32 exec_hi, vcc_hi, 0x3ffffff
    buffer_load_dword a246, v11, s[72:75], s65 offen offset:0
    s_mov_b32 exec_hi, -1
    s_waitcnt vmcnt(12)
    ds_write_b128 v8, v[160:163] offset:0
    s_waitcnt vmcnt(11)
    ds_write_b128 v8, v[164:167] offset:128
    s_waitcnt vmcnt(10)
    ds_write_b128 v8, v[168:171] offset:256
    s_waitcnt vmcnt(9)
    ds_write_b128 v8, v[172:175] offset:3200
    s_waitcnt vmcnt(8)
    ds_write_b128 v8, v[176:179] offset:3328
    s_waitcnt vmcnt(7)
    ds_write_b128 v8, v[180:183] offset:3456
    s_waitcnt vmcnt(6)
    ds_write_b128 v8, v[184:187] offset:6400
    s_waitcnt vmcnt(5)
    ds_write_b128 v8, v[188:191] offset:6528
    s_waitcnt vmcnt(4)
    ds_write_b128 v8, v[192:195] offset:6656
    s_waitcnt vmcnt(3)
    ds_write_b128 v8, v[196:199] offset:9600
    s_waitcnt vmcnt(2)
    ds_write_b128 v8, v[200:203] offset:9728
    s_waitcnt vmcnt(1)
    ds_write_b128 v8, v[204:207] offset:9856
    ds_read_b64_tr_b16 v[160:161], v9 offset:0
    ds_read_b64_tr_b16 v[162:163], v9 offset:1600
    ds_read_b64_tr_b16 v[164:165], v9 offset:32
    ds_read_b64_tr_b16 v[166:167], v9 offset:1632
    ds_read_b64_tr_b16 v[168:169], v9 offset:64
    ds_read_b64_tr_b16 v[170:171], v9 offset:1664
    ds_read_b64_tr_b16 v[172:173], v9 offset:96
    ds_read_b64_tr_b16 v[174:175], v9 offset:1696
    ds_read_b64_tr_b16 v[176:177], v9 offset:128
    ds_read_b64_tr_b16 v[178:179], v9 offset:1728
    ds_read_b64_tr_b16 v[180:181], v9 offset:160
    ds_read_b64_tr_b16 v[182:183], v9 offset:1760
    ds_read_b64_tr_b16 v[184:185], v9 offset:192
    ds_read_b64_tr_b16 v[186:187], v9 offset:1792
    ds_read_b64_tr_b16 v[188:189], v9 offset:224
    ds_read_b64_tr_b16 v[190:191], v9 offset:1824
    ds_read_b64_tr_b16 v[192:193], v9 offset:256
    ds_read_b64_tr_b16 v[194:195], v9 offset:1856
    ds_read_b64_tr_b16 v[196:197], v9 offset:288
    ds_read_b64_tr_b16 v[198:199], v9 offset:1888
    ds_read_b64_tr_b16 v[200:201], v9 offset:320
    ds_read_b64_tr_b16 v[202:203], v9 offset:1920
    ds_read_b64_tr_b16 v[204:205], v9 offset:352
    ds_read_b64_tr_b16 v[206:207], v9 offset:1952
    s_waitcnt lgkmcnt(0)
    buffer_store_dwordx4 v[160:163], v2, s[8:11], s22 offen sc1
    s_add_u32 s22, s22, 18432
    buffer_store_dwordx4 v[164:167], v2, s[8:11], s22 offen sc1
    s_add_u32 s22, s22, 18432
    buffer_store_dwordx4 v[168:171], v2, s[8:11], s22 offen sc1
    s_add_u32 s22, s22, 18432
    buffer_store_dwordx4 v[172:175], v2, s[8:11], s22 offen sc1
    s_add_u32 s22, s22, 18432
    buffer_store_dwordx4 v[176:179], v2, s[8:11], s22 offen sc1
    s_add_u32 s22, s22, 18432
    buffer_store_dwordx4 v[180:183], v2, s[8:11], s22 offen sc1
    s_add_u32 s22, s22, 18432
    buffer_store_dwordx4 v[184:187], v2, s[8:11], s22 offen sc1
    s_add_u32 s22, s22, 18432
    buffer_store_dwordx4 v[188:191], v2, s[8:11], s22 offen sc1
    s_add_u32 s22, s22, 18432
    buffer_store_dwordx4 v[192:195], v2, s[8:11], s22 offen sc1
    s_add_u32 s22, s22, 18432
    buffer_store_dwordx4 v[196:199], v2, s[8:11], s22 offen sc1
    s_add_u32 s22, s22, 18432
    buffer_store_dwordx4 v[200:203], v2, s[8:11], s22 offen sc1
    s_add_u32 s22, s22, 18432
    buffer_store_dwordx4 v[204:207], v2, s[8:11], s22 offen sc1
    v_mov_b32 v208, -1
    v_mov_b32 v212, 0
    v_mov_b32 v209, -1
    v_mov_b32 v213, 0
    v_mov_b32 v210, -1
    v_mov_b32 v214, 0
    v_mov_b32 v211, -1
    v_mov_b32 v215, 0
    s_mul_i32 s4, s50, 3072
    s_add_u32 s4, s4, 14581760
    s_lshl_b32 s5, s50, 12
    s_add_u32 s5, s5, 14778368
    buffer_store_dwordx4 v[208:211], v2, s[8:11], s4 offen offset:0 sc1
    buffer_store_dwordx4 v[208:211], v2, s[8:11], s4 offen offset:1024 sc1
    buffer_store_dwordx4 v[208:211], v2, s[8:11], s4 offen offset:2048 sc1
    buffer_store_dwordx4 v[212:215], v2, s[8:11], s5 offen offset:0 sc1
    buffer_store_dwordx4 v[212:215], v2, s[8:11], s5 offen offset:1024 sc1
    buffer_store_dwordx4 v[212:215], v2, s[8:11], s5 offen offset:2048 sc1
    buffer_store_dwordx4 v[212:215], v2, s[8:11], s5 offen offset:3072 sc1
    buffer_load_dword a250, v251, s[12:15], 0 offen sc1
    buffer_load_dwordx4 v[16:19], v252, s[72:75], s65 offen offset:0
    buffer_load_dwordx4 v[24:27], v255, s[72:75], s65 offen offset:0
    buffer_load_dwordx4 v[20:23], v252, s[72:75], s66 offen offset:0
    buffer_load_dwordx4 v[28:31], v255, s[72:75], s66 offen offset:0
    buffer_load_dwordx4 v[32:35], v252, s[72:75], s65 offen offset:128
    buffer_load_dwordx4 v[40:43], v255, s[72:75], s65 offen offset:128
    buffer_load_dwordx4 v[36:39], v252, s[72:75], s66 offen offset:128
    buffer_load_dwordx4 v[44:47], v255, s[72:75], s66 offen offset:128
    buffer_load_dwordx4 v[48:51], v252, s[72:75], s65 offen offset:256
    buffer_load_dwordx4 v[56:59], v255, s[72:75], s65 offen offset:256
    buffer_load_dwordx4 v[52:55], v252, s[72:75], s66 offen offset:256
    buffer_load_dwordx4 v[60:63], v255, s[72:75], s66 offen offset:256
KF_P4:
    s_and_b32 s23, s34, 15
    s_lshl_b32 s23, s23, 8
    s_mov_b32 s24, 15044608
    s_add_u32 s23, s23, s24
    s_cmp_eq_u32 s3, 0
    s_cselect_b32 s24, s24, 0x7ff00000
    s_or_b32 s4, s3, s32
    s_cmp_eq_u32 s4, 0
    s_cselect_b32 s23, s23, 0x7ff00000
    v_mov_b32 v230, 1
    v_mov_b32 v231, 0
    s_mul_i32 s29, s3, 5376
    s_mul_i32 s28, s21, 129024
    s_add_u32 s28, s28, s29
    s_mov_b32 s16, s69
    s_mov_b64 s[30:31], s[54:55]
    v_mov_b32 v224, -1
    v_mov_b32 v225, -1
    v_mov_b32 v226, -1
    v_mov_b32 v227, -1
    s_lshl_b32 s4, s2, 2
    s_add_u32 s4, s4, s3
    s_mul_i32 s25, s4, 2304
    s_add_u32 s25, s25, 12222464
    s_mov_b32 s32, 0x3ae38e39
    s_mov_b32 s33, 0x3727c5ac
    s_mov_b32 s34, 1069066811
    s_mov_b32 s69, 0xffff0000
    s_lshl_b32 s6, s20, 2
    s_add_u32 s6, s6, s3
    s_mul_i32 s22, s6, 36864
    s_add_u32 s22, s22, 7503872
    s_lshl_b32 s60, s20, 2
    s_lshr_b32 s6, s21, 2
    s_add_u32 s60, s60, s6
    s_and_b32 s61, s21, 3
    s_lshl_b32 s6, s3, 1
    s_add_u32 s6, s6, 1
    s_cmp_eq_u32 s3, 0
    s_cselect_b32 s62, 0, s6
    s_mul_i32 s63, s61, 9
    s_add_u32 s63, s63, s62
    s_mul_i32 s64, s63, 18432
    s_add_u32 s64, s64, 2113536
    v_mov_b32 v232, 0
    v_mov_b32 v233, 0
    v_lshlrev_b32 v234, 3, v0
    v_add_u32 v234, 151552, v234
    ds_write_b64 v234, v[232:233]
    v_lshrrev_b32 v8, 1, v4
    v_and_b32 v9, 1, v4
    v_lshlrev_b32 v7, 5, v8
    v_add_u32 v7, 150528, v7
    s_lshl_b32 s6, s3, 5
    v_lshl_add_u32 v10, v9, 4, v3
    v_add_u32 v15, s6, v10
    v_mul_u32_u24 v237, 1152, v10
    v_lshl_add_u32 v237, v8, 4, v237
    v_mul_u32_u24 v11, 10240, v8
    v_mul_u32_u24 v12, 80, v15
    v_add_u32 v11, v11, v12
    v_mul_u32_u24 v12, 6144, v8
    v_mul_u32_u24 v13, 48, v15
    v_add_u32 v12, v12, v13
    v_add_u32 v12, 20480, v12
    v_mul_u32_u24 v13, 18432, v9
    v_lshl_add_u32 v13, v3, 4, v13
    v_lshl_add_u32 v14, v8, 2, v13
    v_lshl_add_u32 v9, v8, 8, v13
    v_lshl_add_u32 v13, v8, 9, v13
    s_add_u32 s50, s22, 4718592
    s_lshr_b32 s6, s21, 1
    s_lshl_b32 s6, s6, 8
    s_and_b32 s7, s21, 1
    s_lshl_b32 s7, s7, 3
    s_add_u32 s6, s6, s7
    s_add_u32 s6, s6, 16384
    s_add_u32 s38, s50, s6
    s_lshl_b32 s6, s21, 10
    s_add_u32 s50, s50, s6
    s_mov_b32 s52, 0x100001
    s_mov_b32 s53, 0x10000100
    s_mov_b32 s54, 0x200002
    s_mov_b32 s55, 0x20000200
    s_mov_b32 s56, 0x400004
    s_mov_b32 s57, 0x40000400
    s_mov_b32 s58, 0x800008
    s_mov_b32 s59, 0x80000800
    s_lshr_b32 s6, s3, 1
    s_and_b32 s49, s3, 1
    v_lshrrev_b32 v238, 2, v3
    v_and_b32 v239, 3, v3
    v_lshl_add_u32 v240, v4, 3, v238
    s_mul_i32 s35, s6, 6144
    s_lshl_b32 s7, s49, 5
    s_add_u32 s35, s35, s7
    s_add_u32 s35, s35, 20480
    v_mul_u32_u24 v238, 48, v240
    v_lshl_add_u32 v238, v239, 3, v238
    v_add_u32 v238, s35, v238
    s_mul_i32 s35, s6, 10240
    v_mul_u32_u24 v240, 80, v240
    v_lshl_add_u32 v239, v239, 3, v240
    v_add_u32 v239, s35, v239
    v_mul_u32_u24 v240, 768, v4
    v_lshl_add_u32 v240, v3, 2, v240
    s_mul_i32 s39, s21, 7680
    s_add_u32 s39, s39, 14778368
    s_mul_i32 s35, s6, 3840
    s_add_u32 s51, s39, s35
    s_mul_i32 s35, s49, 3072
    s_add_u32 s51, s51, s35
    s_mul_i32 s35, s3, 1920
    s_add_u32 s39, s39, s35
    s_mul_i32 s35, s3, 960
    s_add_u32 s35, s35, 36864
    v_lshlrev_b32 v241, 3, v1
    v_add_u32 v241, s35, v241
    v_lshrrev_b32 v242, 1, v4
    v_mul_u32_u24 v242, 1920, v242
    v_and_b32 v243, 3, v3
    v_mul_u32_u24 v243, 96, v243
    v_add_u32 v242, v242, v243
    v_add_u32 v242, 36864, v242
    v_mov_b32 v243, 151552
    s_mov_b32 s36, 0x00f0000f
    s_mov_b32 s37, 0xf0000f00
    v_cndmask_b32 v242, v243, v242, s[36:37]
    s_mul_i32 s48, s60, 36864
    s_lshl_b32 s4, s63, 5
    s_add_u32 s40, s48, s4
    s_mul_i32 s6, s3, 9216
    s_add_u32 s45, s48, s6
    s_add_u32 s45, s45, 12222464
    s_add_u32 s46, s45, 4096
    s_add_u32 s47, s45, 8192
    v_add_u32 v236, s6, v2
    s_lshl_b32 s26, s60, 10
    s_add_u32 s26, s26, 14647296
    s_lshl_b32 s27, s61, 8
    s_add_u32 s27, s26, s27
    s_lshl_b32 s4, s63, 9
    s_add_u32 s48, s48, s4
    s_add_u32 s48, s48, 7503872
    s_lshl_b32 s42, s63, 16
    s_lshl_b32 s4, s60, 6
    s_add_u32 s42, s42, s4
    s_add_u32 s42, s42, 5144576
    s_add_u32 s43, s42, 65536
    s_add_u32 s44, s42, 131072
    s_cmp_eq_u32 s3, 0
    s_cselect_b32 s41, s40, 0x7ff00000
    s_cselect_b32 s44, s44, 0x7ff00000
    v_lshrrev_b32 v10, 2, v1
    v_lshlrev_b32 v10, 12, v10
    v_and_b32 v235, 3, v1
    v_lshl_add_u32 v10, v235, 4, v10
    s_mul_i32 s35, s21, 2688
    s_add_u32 s35, s35, 2064384
    v_lshlrev_b32 v5, 2, v0
    v_add_u32 v6, 43008, v2
    s_waitcnt vmcnt(8)
    v_accvgpr_read_b32 v249, a250
    v_cmp_ne_u32 vcc, 1, v249
    s_cmp_eq_u64 vcc, 0
    s_cbranch_scc1 KF_IP_GO
KF_IP:
    buffer_load_dword v249, v251, s[12:15], 0 offen sc1
    s_waitcnt vmcnt(0)
    v_cmp_ne_u32 vcc, 1, v249
    s_sub_u32 s68, s68, 1
    s_cselect_b64 s[36:37], 0, vcc
    s_cselect_b32 s68, 0, s68
    s_cmp_eq_u64 s[36:37], 0
    s_cbranch_scc1 KF_IP_GO
    s_sleep 4
    s_branch KF_IP
KF_IP_GO:
    buffer_load_dword v160, v251, s[8:11], s16 offen sc1
    buffer_load_dwordx4 v[64:67], v252, s[72:75], s65 offen offset:384
    buffer_load_dwordx4 v[72:75], v255, s[72:75], s65 offen offset:384
    buffer_load_dwordx4 v[68:71], v252, s[72:75], s66 offen offset:384
    buffer_load_dwordx4 v[76:79], v255, s[72:75], s66 offen offset:384
    buffer_load_dwordx4 v[80:83], v252, s[72:75], s65 offen offset:512
    buffer_load_dwordx4 v[88:91], v255, s[72:75], s65 offen offset:512
    buffer_load_dwordx4 v[84:87], v252, s[72:75], s66 offen offset:512
    buffer_load_dwordx4 v[92:95], v255, s[72:75], s66 offen offset:512
    s_waitcnt vmcnt(20)
    ds_write_b128 v253, v[16:19] offset:0
    s_waitcnt vmcnt(19)
    ds_write_b128 v253, v[24:27] offset:1152
    ds_read_b128 v[16:19], v254 offset:0
    ds_read_b128 v[24:27], v254 offset:64
    s_waitcnt vmcnt(18)
    ds_write_b128 v253, v[20:23] offset:0
    s_waitcnt vmcnt(17)
    ds_write_b128 v253, v[28:31] offset:1152
    ds_read_b128 v[20:23], v254 offset:0
    ds_read_b128 v[28:31], v254 offset:64
    s_waitcnt vmcnt(16)
    ds_write_b128 v253, v[32:35] offset:0
    s_waitcnt vmcnt(15)
    ds_write_b128 v253, v[40:43] offset:1152
    ds_read_b128 v[32:35], v254 offset:0
    ds_read_b128 v[40:43], v254 offset:64
    s_waitcnt vmcnt(14)
    ds_write_b128 v253, v[36:39] offset:0
    s_waitcnt vmcnt(13)
    ds_write_b128 v253, v[44:47] offset:1152
    ds_read_b128 v[36:39], v254 offset:0
    ds_read_b128 v[44:47], v254 offset:64
    s_waitcnt vmcnt(12)
    ds_write_b128 v253, v[48:51] offset:0
    s_waitcnt vmcnt(11)
    ds_write_b128 v253, v[56:59] offset:1152
    ds_read_b128 v[48:51], v254 offset:0
    ds_read_b128 v[56:59], v254 offset:64
    s_waitcnt vmcnt(10)
    ds_write_b128 v253, v[52:55] offset:0
    s_waitcnt vmcnt(9)
    ds_write_b128 v253, v[60:63] offset:1152
    ds_read_b128 v[52:55], v254 offset:0
    ds_read_b128 v[60:63], v254 offset:64
    s_waitcnt vmcnt(8)
    v_cmp_ne_u32 vcc, 6, v160
    s_cmp_eq_u64 vcc, 0
    s_cbranch_scc1 KF_FP_GO
KF_FP:
    buffer_load_dword v160, v251, s[8:11], s16 offen sc1
    s_waitcnt vmcnt(0)
    v_cmp_ne_u32 vcc, 6, v160
    s_sub_u32 s68, s68, 1
    s_cselect_b64 s[36:37], 0, vcc
    s_cselect_b32 s68, 0, s68
    s_cmp_eq_u64 s[36:37], 0
    s_cbranch_scc1 KF_FP_GO
    s_sleep 3
    s_branch KF_FP
KF_FP_GO:
    s_mov_b32 s12, s30
    s_mov_b32 s13, s31
    s_mov_b32 s14, 2359296
    s_mov_b32 s15, 0x20000
    s_add_u32 s30, s29, 0
    s_add_u32 s31, s28, 0
    s_mov_b32 m0, s30
    s_nop 0
    buffer_load_dwordx4 v2, s[8:11], s31 offen offset:0 lds
    buffer_load_dwordx4 v2, s[8:11], s31 offen offset:1024 lds
    buffer_load_dwordx4 v2, s[8:11], s31 offen offset:2048 lds
    buffer_load_dwordx4 v2, s[8:11], s31 offen offset:3072 lds
    s_add_u32 s30, s30, 4096
    s_add_u32 s31, s31, 4096
    s_mov_b32 m0, s30
    s_nop 0
    buffer_load_dwordx4 v2, s[8:11], s31 offen offset:0 lds
    s_mov_b64 exec, 0xffff
    buffer_load_dwordx4 v2, s[8:11], s31 offen offset:1024 lds
    s_mov_b64 exec, -1
    buffer_load_dword v216, v5, s[8:11], s35 offen offset:0
    buffer_load_dword v217, v5, s[8:11], s35 offen offset:448
    buffer_load_dword v218, v5, s[8:11], s35 offen offset:896
    buffer_load_dword v219, v5, s[8:11], s35 offen offset:1344
    buffer_load_dword v220, v5, s[8:11], s35 offen offset:1792
    buffer_load_dword v221, v5, s[8:11], s35 offen offset:2240
    s_add_u32 s30, s29, 21504
    s_add_u32 s31, s28, 21504
    s_mov_b32 m0, s30
    s_nop 0
    buffer_load_dwordx4 v2, s[8:11], s31 offen offset:0 lds
    buffer_load_dwordx4 v2, s[8:11], s31 offen offset:1024 lds
    buffer_load_dwordx4 v2, s[8:11], s31 offen offset:2048 lds
    buffer_load_dwordx4 v2, s[8:11], s31 offen offset:3072 lds
    s_add_u32 s30, s30, 4096
    s_add_u32 s31, s31, 4096
    s_mov_b32 m0, s30
    s_nop 0
    buffer_load_dwordx4 v2, s[8:11], s31 offen offset:0 lds
    s_mov_b64 exec, 0xffff
    buffer_load_dwordx4 v2, s[8:11], s31 offen offset:1024 lds
    s_mov_b64 exec, -1
    s_waitcnt vmcnt(25)
    ds_write_b128 v253, v[64:67] offset:0
    s_waitcnt vmcnt(24)
    ds_write_b128 v253, v[72:75] offset:1152
    ds_read_b128 v[64:67], v254 offset:0
    ds_read_b128 v[72:75], v254 offset:64
    s_waitcnt vmcnt(23)
    ds_write_b128 v253, v[68:71] offset:0
    s_waitcnt vmcnt(22)
    ds_write_b128 v253, v[76:79] offset:1152
    ds_read_b128 v[68:71], v254 offset:0
    ds_read_b128 v[76:79], v254 offset:64
    s_waitcnt vmcnt(21)
    ds_write_b128 v253, v[80:83] offset:0
    s_waitcnt vmcnt(20)
    ds_write_b128 v253, v[88:91] offset:1152
    ds_read_b128 v[80:83], v254 offset:0
    ds_read_b128 v[88:91], v254 offset:64
    s_waitcnt vmcnt(19)
    ds_write_b128 v253, v[84:87] offset:0
    s_waitcnt vmcnt(18)
    ds_write_b128 v253, v[92:95] offset:1152
    ds_read_b128 v[84:87], v254 offset:0
    ds_read_b128 v[92:95], v254 offset:64
    s_waitcnt vmcnt(12)
    s_barrier
    s_mov_b64 exec, 1
    buffer_atomic_add v230, v231, s[8:11], s23 offen sc1
    s_mov_b64 exec, -1
    ds_read_b128 a[0:3], v2 offset:0
    ds_read_b128 a[4:7], v2 offset:1024
    ds_read_b128 a[8:11], v2 offset:2048
    ds_read_b128 a[12:15], v2 offset:3072
    ds_read_b128 a[16:19], v2 offset:4096
    ds_read_b128 a[20:23], v2 offset:5120
    ds_read_b128 a[24:27], v2 offset:6144
    v_mfma_f32_16x16x32_bf16 v[244:247], v[16:19], v[16:19], 0
    v_mfma_f32_16x16x32_bf16 v[248:251], v[20:23], v[20:23], 0
    s_waitcnt lgkmcnt(6)
    v_mfma_f32_16x16x32_bf16 v[160:163], a[0:3], v[16:19], 0
    ds_read_b128 a[28:31], v2 offset:7168
    v_mfma_f32_16x16x32_bf16 v[188:191], a[0:3], v[20:23], 0
    s_add_u32 s30, s29, 43008
    s_add_u32 s31, s28, 43008
    s_mov_b32 m0, s30
    s_nop 0
    buffer_load_dwordx4 v2, s[8:11], s31 offen offset:0 lds
    s_waitcnt lgkmcnt(6)
    v_mfma_f32_16x16x32_bf16 v[164:167], a[4:7], v[16:19], 0
    ds_read_b128 a[32:35], v2 offset:8192
    v_mfma_f32_16x16x32_bf16 v[192:195], a[4:7], v[20:23], 0
    buffer_load_dwordx4 v2, s[8:11], s31 offen offset:1024 lds
    s_waitcnt lgkmcnt(6)
    v_mfma_f32_16x16x32_bf16 v[168:171], a[8:11], v[16:19], 0
    ds_read_b128 a[36:39], v2 offset:9216
    v_mfma_f32_16x16x32_bf16 v[196:199], a[8:11], v[20:23], 0
    buffer_load_dwordx4 v[96:99], v252, s[72:75], s65 offen offset:640
    s_waitcnt lgkmcnt(6)
    v_mfma_f32_16x16x32_bf16 v[172:175], a[12:15], v[16:19], 0
    ds_read_b128 a[40:43], v2 offset:10240
    v_mfma_f32_16x16x32_bf16 v[200:203], a[12:15], v[20:23], 0
    buffer_load_dwordx4 v2, s[8:11], s31 offen offset:2048 lds
    s_waitcnt lgkmcnt(6)
    v_mfma_f32_16x16x32_bf16 v[176:179], a[16:19], v[16:19], 0
    ds_read_b128 a[44:47], v2 offset:11264
    v_mfma_f32_16x16x32_bf16 v[204:207], a[16:19], v[20:23], 0
    buffer_load_dwordx4 v2, s[8:11], s31 offen offset:3072 lds
    s_waitcnt lgkmcnt(6)
    v_mfma_f32_16x16x32_bf16 v[180:183], a[20:23], v[16:19], 0
    ds_read_b128 a[48:51], v2 offset:12288
    v_mfma_f32_16x16x32_bf16 v[208:211], a[20:23], v[20:23], 0
    buffer_load_dwordx4 v[104:107], v255, s[72:75], s65 offen offset:640
    s_waitcnt lgkmcnt(6)
    v_mfma_f32_16x16x32_bf16 v[184:187], a[24:27], v[16:19], 0
    ds_read_b128 a[52:55], v2 offset:13312
    v_mfma_f32_16x16x32_bf16 v[212:215], a[24:27], v[20:23], 0
    v_mfma_f32_16x16x32_bf16 v[244:247], v[24:27], v[24:27], v[244:247]
    v_mfma_f32_16x16x32_bf16 v[248:251], v[28:31], v[28:31], v[248:251]
    s_waitcnt lgkmcnt(6)
    v_mfma_f32_16x16x32_bf16 v[160:163], a[28:31], v[24:27], v[160:163]
    ds_read_b128 a[0:3], v2 offset:14336
    v_mfma_f32_16x16x32_bf16 v[188:191], a[28:31], v[28:31], v[188:191]
    s_add_u32 s30, s30, 4096
    s_add_u32 s31, s31, 4096
    s_mov_b32 m0, s30
    s_nop 0
    buffer_load_dwordx4 v2, s[8:11], s31 offen offset:0 lds
    s_waitcnt lgkmcnt(6)
    v_mfma_f32_16x16x32_bf16 v[164:167], a[32:35], v[24:27], v[164:167]
    ds_read_b128 a[4:7], v2 offset:15360
    v_mfma_f32_16x16x32_bf16 v[192:195], a[32:35], v[28:31], v[192:195]
    s_mov_b64 exec, 0xffff
    buffer_load_dwordx4 v2, s[8:11], s31 offen offset:1024 lds
    s_mov_b64 exec, -1
    s_waitcnt lgkmcnt(6)
    v_mfma_f32_16x16x32_bf16 v[168:171], a[36:39], v[24:27], v[168:171]
    ds_read_b128 a[8:11], v2 offset:16384
    v_mfma_f32_16x16x32_bf16 v[196:199], a[36:39], v[28:31], v[196:199]
    buffer_load_dwordx4 v[100:103], v252, s[72:75], s66 offen offset:640
    s_waitcnt lgkmcnt(6)
    v_mfma_f32_16x16x32_bf16 v[172:175], a[40:43], v[24:27], v[172:175]
    ds_read_b128 a[12:15], v2 offset:17408
    v_mfma_f32_16x16x32_bf16 v[200:203], a[40:43], v[28:31], v[200:203]
    s_add_u32 s30, s29, 64512
    s_add_u32 s31, s28, 64512
    s_mov_b32 m0, s30
    s_nop 0
    buffer_load_dwordx4 v2, s[8:11], s31 offen offset:0 lds
    s_waitcnt lgkmcnt(6)
    v_mfma_f32_16x16x32_bf16 v[176:179], a[44:47], v[24:27], v[176:179]
    ds_read_b128 a[16:19], v2 offset:18432
    v_mfma_f32_16x16x32_bf16 v[204:207], a[44:47], v[28:31], v[204:207]
    buffer_load_dwordx4 v2, s[8:11], s31 offen offset:1024 lds
    s_waitcnt lgkmcnt(6)
    v_mfma_f32_16x16x32_bf16 v[180:183], a[48:51], v[24:27], v[180:183]
    ds_read_b128 a[20:23], v2 offset:19456
    v_mfma_f32_16x16x32_bf16 v[208:211], a[48:51], v[28:31], v[208:211]
    buffer_load_dwordx4 v[108:111], v255, s[72:75], s66 offen offset:640
    s_waitcnt lgkmcnt(6)
    v_mfma_f32_16x16x32_bf16 v[184:187], a[52:55], v[24:27], v[184:187]
    ds_read_b128 a[24:27], v2 offset:20480
    v_mfma_f32_16x16x32_bf16 v[212:215], a[52:55], v[28:31], v[212:215]
    s_waitcnt vmcnt(13)
    s_barrier
    v_mfma_f32_16x16x32_bf16 v[244:247], v[32:35], v[32:35], v[244:247]
    v_mfma_f32_16x16x32_bf16 v[248:251], v[36:39], v[36:39], v[248:251]
    s_waitcnt lgkmcnt(6)
    v_mfma_f32_16x16x32_bf16 v[160:163], a[0:3], v[32:35], v[160:163]
    ds_read_b128 a[28:31], v2 offset:21504
    v_mfma_f32_16x16x32_bf16 v[188:191], a[0:3], v[36:39], v[188:191]
    buffer_load_dwordx4 v2, s[8:11], s31 offen offset:2048 lds
    s_waitcnt lgkmcnt(6)
    v_mfma_f32_16x16x32_bf16 v[164:167], a[4:7], v[32:35], v[164:167]
    ds_read_b128 a[32:35], v2 offset:22528
    v_mfma_f32_16x16x32_bf16 v[192:195], a[4:7], v[36:39], v[192:195]
    buffer_load_dwordx4 v2, s[8:11], s31 offen offset:3072 lds
    s_waitcnt lgkmcnt(6)
    v_mfma_f32_16x16x32_bf16 v[168:171], a[8:11], v[32:35], v[168:171]
    ds_read_b128 a[36:39], v2 offset:23552
    v_mfma_f32_16x16x32_bf16 v[196:199], a[8:11], v[36:39], v[196:199]
    buffer_load_dwordx4 v[112:115], v252, s[72:75], s65 offen offset:768
    s_waitcnt lgkmcnt(6)
    v_mfma_f32_16x16x32_bf16 v[172:175], a[12:15], v[32:35], v[172:175]
    ds_read_b128 a[40:43], v2 offset:24576
    v_mfma_f32_16x16x32_bf16 v[200:203], a[12:15], v[36:39], v[200:203]
    s_add_u32 s30, s30, 4096
    s_add_u32 s31, s31, 4096
    s_mov_b32 m0, s30
    s_nop 0
    buffer_load_dwordx4 v2, s[8:11], s31 offen offset:0 lds
    s_waitcnt lgkmcnt(6)
    v_mfma_f32_16x16x32_bf16 v[176:179], a[16:19], v[32:35], v[176:179]
    ds_read_b128 a[44:47], v2 offset:25600
    v_mfma_f32_16x16x32_bf16 v[204:207], a[16:19], v[36:39], v[204:207]
    s_mov_b64 exec, 0xffff
    buffer_load_dwordx4 v2, s[8:11], s31 offen offset:1024 lds
    s_mov_b64 exec, -1
    s_waitcnt lgkmcnt(6)
    v_mfma_f32_16x16x32_bf16 v[180:183], a[20:23], v[32:35], v[180:183]
    ds_read_b128 a[48:51], v2 offset:26624
    v_mfma_f32_16x16x32_bf16 v[208:211], a[20:23], v[36:39], v[208:211]
    buffer_load_dwordx4 v[120:123], v255, s[72:75], s65 offen offset:768
    s_waitcnt lgkmcnt(6)
    v_mfma_f32_16x16x32_bf16 v[184:187], a[24:27], v[32:35], v[184:187]
    ds_read_b128 a[52:55], v2 offset:27648
    v_mfma_f32_16x16x32_bf16 v[212:215], a[24:27], v[36:39], v[212:215]
    v_mfma_f32_16x16x32_bf16 v[244:247], v[40:43], v[40:43], v[244:247]
    v_add_f32 v216, v216, v217
    v_mfma_f32_16x16x32_bf16 v[248:251], v[44:47], v[44:47], v[248:251]
    s_waitcnt lgkmcnt(6)
    v_mfma_f32_16x16x32_bf16 v[160:163], a[28:31], v[40:43], v[160:163]
    ds_read_b128 a[0:3], v2 offset:28672
    v_add_f32 v218, v218, v219
    v_mfma_f32_16x16x32_bf16 v[188:191], a[28:31], v[44:47], v[188:191]
    s_add_u32 s30, s29, 0
    s_add_u32 s31, s28, 86016
    s_mov_b32 m0, s30
    s_nop 0
    buffer_load_dwordx4 v2, s[8:11], s31 offen offset:0 lds
    s_waitcnt lgkmcnt(6)
    v_mfma_f32_16x16x32_bf16 v[164:167], a[32:35], v[40:43], v[164:167]
    ds_read_b128 a[4:7], v2 offset:29696
    v_add_f32 v220, v220, v221
    v_mfma_f32_16x16x32_bf16 v[192:195], a[32:35], v[44:47], v[192:195]
    buffer_load_dwordx4 v[116:119], v252, s[72:75], s66 offen offset:768
    s_waitcnt lgkmcnt(6)
    v_mfma_f32_16x16x32_bf16 v[168:171], a[36:39], v[40:43], v[168:171]
    ds_read_b128 a[8:11], v2 offset:30720
    v_add_f32 v216, v216, v218
    v_mfma_f32_16x16x32_bf16 v[196:199], a[36:39], v[44:47], v[196:199]
    buffer_load_dwordx4 v2, s[8:11], s31 offen offset:1024 lds
    s_waitcnt lgkmcnt(6)
    v_mfma_f32_16x16x32_bf16 v[172:175], a[40:43], v[40:43], v[172:175]
    ds_read_b128 a[12:15], v2 offset:31744
    v_mfma_f32_16x16x32_bf16 v[200:203], a[40:43], v[44:47], v[200:203]
    buffer_load_dwordx4 v[124:127], v255, s[72:75], s66 offen offset:768
    v_add_f32 v232, v216, v220
    s_waitcnt lgkmcnt(6)
    v_mfma_f32_16x16x32_bf16 v[176:179], a[44:47], v[40:43], v[176:179]
    ds_read_b128 a[16:19], v2 offset:32768
    v_mfma_f32_16x16x32_bf16 v[204:207], a[44:47], v[44:47], v[204:207]
    v_add_u32 v5, 150528, v5
    s_waitcnt lgkmcnt(6)
    v_mfma_f32_16x16x32_bf16 v[180:183], a[48:51], v[40:43], v[180:183]
    ds_read_b128 a[20:23], v2 offset:33792
    v_mfma_f32_16x16x32_bf16 v[208:211], a[48:51], v[44:47], v[208:211]
    ds_write_b32 v5, v232
    s_waitcnt lgkmcnt(7)
    v_mfma_f32_16x16x32_bf16 v[184:187], a[52:55], v[40:43], v[184:187]
    ds_read_b128 a[24:27], v2 offset:34816
    v_mfma_f32_16x16x32_bf16 v[212:215], a[52:55], v[44:47], v[212:215]
    v_mfma_f32_16x16x32_bf16 v[244:247], v[48:51], v[48:51], v[244:247]
    v_mfma_f32_16x16x32_bf16 v[248:251], v[52:55], v[52:55], v[248:251]
    s_waitcnt lgkmcnt(7)
    v_mfma_f32_16x16x32_bf16 v[160:163], a[0:3], v[48:51], v[160:163]
    ds_read_b128 a[28:31], v2 offset:35840
    v_mfma_f32_16x16x32_bf16 v[188:191], a[0:3], v[52:55], v[188:191]
    buffer_load_dwordx4 v2, s[8:11], s31 offen offset:2048 lds
    s_waitcnt lgkmcnt(7)
    v_mfma_f32_16x16x32_bf16 v[164:167], a[4:7], v[48:51], v[164:167]
    ds_read_b128 a[32:35], v2 offset:36864
    v_mfma_f32_16x16x32_bf16 v[192:195], a[4:7], v[52:55], v[192:195]
    buffer_load_dwordx4 v[128:131], v252, s[72:75], s65 offen offset:896
    s_waitcnt lgkmcnt(7)
    v_mfma_f32_16x16x32_bf16 v[168:171], a[8:11], v[48:51], v[168:171]
    ds_read_b128 a[36:39], v2 offset:37888
    v_mfma_f32_16x16x32_bf16 v[196:199], a[8:11], v[52:55], v[196:199]
    buffer_load_dwordx4 v2, s[8:11], s31 offen offset:3072 lds
    s_waitcnt lgkmcnt(7)
    v_mfma_f32_16x16x32_bf16 v[172:175], a[12:15], v[48:51], v[172:175]
    ds_read_b128 a[40:43], v2 offset:38912
    v_mfma_f32_16x16x32_bf16 v[200:203], a[12:15], v[52:55], v[200:203]
    buffer_load_dwordx4 v[136:139], v255, s[72:75], s65 offen offset:896
    s_waitcnt lgkmcnt(7)
    v_mfma_f32_16x16x32_bf16 v[176:179], a[16:19], v[48:51], v[176:179]
    ds_read_b128 a[44:47], v2 offset:39936
    v_mfma_f32_16x16x32_bf16 v[204:207], a[16:19], v[52:55], v[204:207]
    s_waitcnt lgkmcnt(7)
    v_mfma_f32_16x16x32_bf16 v[180:183], a[20:23], v[48:51], v[180:183]
    ds_read_b128 a[48:51], v2 offset:40960
    v_mfma_f32_16x16x32_bf16 v[208:211], a[20:23], v[52:55], v[208:211]
    s_waitcnt lgkmcnt(6)
    v_mfma_f32_16x16x32_bf16 v[184:187], a[24:27], v[48:51], v[184:187]
    ds_read_b128 a[52:55], v2 offset:41984
    v_mfma_f32_16x16x32_bf16 v[212:215], a[24:27], v[52:55], v[212:215]
    s_waitcnt vmcnt(18)
    s_barrier
    v_mfma_f32_16x16x32_bf16 v[244:247], v[56:59], v[56:59], v[244:247]
    v_mfma_f32_16x16x32_bf16 v[248:251], v[60:63], v[60:63], v[248:251]
    s_waitcnt lgkmcnt(6)
    v_mfma_f32_16x16x32_bf16 v[160:163], a[28:31], v[56:59], v[160:163]
    ds_read_b128 a[0:3], v6 offset:0
    v_mfma_f32_16x16x32_bf16 v[188:191], a[28:31], v[60:63], v[188:191]
    s_add_u32 s30, s30, 4096
    s_add_u32 s31, s31, 4096
    s_mov_b32 m0, s30
    s_nop 0
    buffer_load_dwordx4 v2, s[8:11], s31 offen offset:0 lds
    s_waitcnt lgkmcnt(6)
    v_mfma_f32_16x16x32_bf16 v[164:167], a[32:35], v[56:59], v[164:167]
    ds_read_b128 a[4:7], v6 offset:1024
    v_mfma_f32_16x16x32_bf16 v[192:195], a[32:35], v[60:63], v[192:195]
    buffer_load_dwordx4 v[132:135], v252, s[72:75], s66 offen offset:896
    s_waitcnt lgkmcnt(6)
    v_mfma_f32_16x16x32_bf16 v[168:171], a[36:39], v[56:59], v[168:171]
    ds_read_b128 a[8:11], v6 offset:2048
    v_mfma_f32_16x16x32_bf16 v[196:199], a[36:39], v[60:63], v[196:199]
    s_mov_b64 exec, 0xffff
    buffer_load_dwordx4 v2, s[8:11], s31 offen offset:1024 lds
    s_mov_b64 exec, -1
    s_waitcnt lgkmcnt(6)
    v_mfma_f32_16x16x32_bf16 v[172:175], a[40:43], v[56:59], v[172:175]
    ds_read_b128 a[12:15], v6 offset:3072
    v_mfma_f32_16x16x32_bf16 v[200:203], a[40:43], v[60:63], v[200:203]
    buffer_load_dwordx4 v[140:143], v255, s[72:75], s66 offen offset:896
    s_waitcnt lgkmcnt(6)
    v_mfma_f32_16x16x32_bf16 v[176:179], a[44:47], v[56:59], v[176:179]
    ds_read_b128 a[16:19], v6 offset:4096
    v_mfma_f32_16x16x32_bf16 v[204:207], a[44:47], v[60:63], v[204:207]
    s_waitcnt lgkmcnt(6)
    v_mfma_f32_16x16x32_bf16 v[180:183], a[48:51], v[56:59], v[180:183]
    ds_read_b128 a[20:23], v6 offset:5120
    v_mfma_f32_16x16x32_bf16 v[208:211], a[48:51], v[60:63], v[208:211]
    s_waitcnt lgkmcnt(6)
    v_mfma_f32_16x16x32_bf16 v[184:187], a[52:55], v[56:59], v[184:187]
    ds_read_b128 a[24:27], v6 offset:6144
    v_mfma_f32_16x16x32_bf16 v[212:215], a[52:55], v[60:63], v[212:215]
    v_mfma_f32_16x16x32_bf16 v[244:247], v[64:67], v[64:67], v[244:247]
    v_mfma_f32_16x16x32_bf16 v[248:251], v[68:71], v[68:71], v[248:251]
    s_waitcnt lgkmcnt(6)
    v_mfma_f32_16x16x32_bf16 v[160:163], a[0:3], v[64:67], v[160:163]
    ds_read_b128 a[28:31], v6 offset:7168
    v_mfma_f32_16x16x32_bf16 v[188:191], a[0:3], v[68:71], v[188:191]
    s_add_u32 s30, s29, 21504
    s_add_u32 s31, s28, 107520
    s_mov_b32 m0, s30
    s_nop 0
    buffer_load_dwordx4 v2, s[8:11], s31 offen offset:0 lds
    s_waitcnt lgkmcnt(6)
    v_mfma_f32_16x16x32_bf16 v[164:167], a[4:7], v[64:67], v[164:167]
    ds_read_b128 a[32:35], v6 offset:8192
    v_mfma_f32_16x16x32_bf16 v[192:195], a[4:7], v[68:71], v[192:195]
    buffer_load_dwordx4 v[144:147], v252, s[72:75], s65 offen offset:1024
    s_waitcnt lgkmcnt(6)
    v_mfma_f32_16x16x32_bf16 v[168:171], a[8:11], v[64:67], v[168:171]
    ds_read_b128 a[36:39], v6 offset:9216
    v_mfma_f32_16x16x32_bf16 v[196:199], a[8:11], v[68:71], v[196:199]
    buffer_load_dwordx4 v2, s[8:11], s31 offen offset:1024 lds
    s_waitcnt lgkmcnt(6)
    v_mfma_f32_16x16x32_bf16 v[172:175], a[12:15], v[64:67], v[172:175]
    ds_read_b128 a[40:43], v6 offset:10240
    v_mfma_f32_16x16x32_bf16 v[200:203], a[12:15], v[68:71], v[200:203]
    buffer_load_dwordx4 v[152:155], v255, s[72:75], s65 offen offset:1024
    s_waitcnt lgkmcnt(6)
    v_mfma_f32_16x16x32_bf16 v[176:179], a[16:19], v[64:67], v[176:179]
    ds_read_b128 a[44:47], v6 offset:11264
    v_mfma_f32_16x16x32_bf16 v[204:207], a[16:19], v[68:71], v[204:207]
    s_waitcnt lgkmcnt(6)
    v_mfma_f32_16x16x32_bf16 v[180:183], a[20:23], v[64:67], v[180:183]
    ds_read_b128 a[48:51], v6 offset:12288
    v_mfma_f32_16x16x32_bf16 v[208:211], a[20:23], v[68:71], v[208:211]
    s_waitcnt lgkmcnt(6)
    v_mfma_f32_16x16x32_bf16 v[184:187], a[24:27], v[64:67], v[184:187]
    ds_read_b128 a[52:55], v6 offset:13312
    v_mfma_f32_16x16x32_bf16 v[212:215], a[24:27], v[68:71], v[212:215]
    v_mfma_f32_16x16x32_bf16 v[244:247], v[72:75], v[72:75], v[244:247]
    v_mfma_f32_16x16x32_bf16 v[248:251], v[76:79], v[76:79], v[248:251]
    s_waitcnt lgkmcnt(6)
    v_mfma_f32_16x16x32_bf16 v[160:163], a[28:31], v[72:75], v[160:163]
    ds_read_b128 a[0:3], v6 offset:14336
    v_mfma_f32_16x16x32_bf16 v[188:191], a[28:31], v[76:79], v[188:191]
    buffer_load_dwordx4 v2, s[8:11], s31 offen offset:2048 lds
    s_waitcnt lgkmcnt(6)
    v_mfma_f32_16x16x32_bf16 v[164:167], a[32:35], v[72:75], v[164:167]
    ds_read_b128 a[4:7], v6 offset:15360
    v_mfma_f32_16x16x32_bf16 v[192:195], a[32:35], v[76:79], v[192:195]
    buffer_load_dwordx4 v[148:151], v252, s[72:75], s66 offen offset:1024
    s_waitcnt lgkmcnt(6)
    v_mfma_f32_16x16x32_bf16 v[168:171], a[36:39], v[72:75], v[168:171]
    ds_read_b128 a[8:11], v6 offset:16384
    v_mfma_f32_16x16x32_bf16 v[196:199], a[36:39], v[76:79], v[196:199]
    buffer_load_dwordx4 v2, s[8:11], s31 offen offset:3072 lds
    s_waitcnt lgkmcnt(6)
    v_mfma_f32_16x16x32_bf16 v[172:175], a[40:43], v[72:75], v[172:175]
    ds_read_b128 a[12:15], v6 offset:17408
    v_mfma_f32_16x16x32_bf16 v[200:203], a[40:43], v[76:79], v[200:203]
    buffer_load_dwordx4 v[156:159], v255, s[72:75], s66 offen offset:1024
    s_waitcnt lgkmcnt(6)
    v_mfma_f32_16x16x32_bf16 v[176:179], a[44:47], v[72:75], v[176:179]
    ds_read_b128 a[16:19], v6 offset:18432
    v_mfma_f32_16x16x32_bf16 v[204:207], a[44:47], v[76:79], v[204:207]
    s_waitcnt lgkmcnt(6)
    v_mfma_f32_16x16x32_bf16 v[180:183], a[48:51], v[72:75], v[180:183]
    ds_read_b128 a[20:23], v6 offset:19456
    v_mfma_f32_16x16x32_bf16 v[208:211], a[48:51], v[76:79], v[208:211]
    s_waitcnt lgkmcnt(6)
    v_mfma_f32_16x16x32_bf16 v[184:187], a[52:55], v[72:75], v[184:187]
    ds_read_b128 a[24:27], v6 offset:20480
    v_mfma_f32_16x16x32_bf16 v[212:215], a[52:55], v[76:79], v[212:215]
    s_waitcnt vmcnt(21)
    s_barrier
    v_mfma_f32_16x16x32_bf16 v[244:247], v[80:83], v[80:83], v[244:247]
    ds_write_b128 v253, v[96:99] offset:0
    v_mfma_f32_16x16x32_bf16 v[248:251], v[84:87], v[84:87], v[248:251]
    s_waitcnt lgkmcnt(7)
    v_mfma_f32_16x16x32_bf16 v[160:163], a[0:3], v[80:83], v[160:163]
    ds_read_b128 a[28:31], v6 offset:21504
    ds_write_b128 v253, v[104:107] offset:1152
    v_mfma_f32_16x16x32_bf16 v[188:191], a[0:3], v[84:87], v[188:191]
    s_add_u32 s30, s30, 4096
    s_add_u32 s31, s31, 4096
    s_mov_b32 m0, s30
    s_nop 0
    buffer_load_dwordx4 v2, s[8:11], s31 offen offset:0 lds
    s_waitcnt lgkmcnt(8)
    v_mfma_f32_16x16x32_bf16 v[164:167], a[4:7], v[80:83], v[164:167]
    ds_read_b128 a[32:35], v6 offset:22528
    ds_read_b128 v[96:99], v254 offset:0
    v_mfma_f32_16x16x32_bf16 v[192:195], a[4:7], v[84:87], v[192:195]
    s_mov_b64 exec, 0xffff
    buffer_load_dwordx4 v2, s[8:11], s31 offen offset:1024 lds
    s_mov_b64 exec, -1
    s_waitcnt lgkmcnt(9)
    v_mfma_f32_16x16x32_bf16 v[168:171], a[8:11], v[80:83], v[168:171]
    ds_read_b128 a[36:39], v6 offset:23552
    ds_read_b128 v[104:107], v254 offset:64
    v_mfma_f32_16x16x32_bf16 v[196:199], a[8:11], v[84:87], v[196:199]
    buffer_load_dwordx4 v[16:19], v2, s[12:15], s18 offen offset:0
    s_waitcnt lgkmcnt(10)
    v_mfma_f32_16x16x32_bf16 v[172:175], a[12:15], v[80:83], v[172:175]
    ds_read_b128 a[40:43], v6 offset:24576
    ds_write_b128 v253, v[100:103] offset:0
    v_mfma_f32_16x16x32_bf16 v[200:203], a[12:15], v[84:87], v[200:203]
    buffer_load_dwordx2 v[20:21], v2, s[12:15], s18 offen offset:16
    s_waitcnt lgkmcnt(11)
    v_mfma_f32_16x16x32_bf16 v[176:179], a[16:19], v[80:83], v[176:179]
    ds_read_b128 a[44:47], v6 offset:25600
    ds_write_b128 v253, v[108:111] offset:1152
    v_mfma_f32_16x16x32_bf16 v[204:207], a[16:19], v[84:87], v[204:207]
    buffer_load_dwordx4 v[22:25], v2, s[12:15], s18 offen offset:1024
    s_waitcnt lgkmcnt(12)
    v_mfma_f32_16x16x32_bf16 v[180:183], a[20:23], v[80:83], v[180:183]
    ds_read_b128 a[48:51], v6 offset:26624
    ds_read_b128 v[100:103], v254 offset:0
    v_mfma_f32_16x16x32_bf16 v[208:211], a[20:23], v[84:87], v[208:211]
    s_waitcnt lgkmcnt(13)
    v_mfma_f32_16x16x32_bf16 v[184:187], a[24:27], v[80:83], v[184:187]
    ds_read_b128 a[52:55], v6 offset:27648
    ds_read_b128 v[108:111], v254 offset:64
    v_mfma_f32_16x16x32_bf16 v[212:215], a[24:27], v[84:87], v[212:215]
    v_mfma_f32_16x16x32_bf16 v[244:247], v[88:91], v[88:91], v[244:247]
    v_mfma_f32_16x16x32_bf16 v[248:251], v[92:95], v[92:95], v[248:251]
    s_waitcnt lgkmcnt(13)
    v_mfma_f32_16x16x32_bf16 v[160:163], a[28:31], v[88:91], v[160:163]
    ds_read_b128 a[0:3], v6 offset:28672
    v_mfma_f32_16x16x32_bf16 v[188:191], a[28:31], v[92:95], v[188:191]
    buffer_load_dwordx2 v[26:27], v2, s[12:15], s18 offen offset:1040
    s_waitcnt lgkmcnt(12)
    v_mfma_f32_16x16x32_bf16 v[164:167], a[32:35], v[88:91], v[164:167]
    ds_read_b128 a[4:7], v6 offset:29696
    v_mfma_f32_16x16x32_bf16 v[192:195], a[32:35], v[92:95], v[192:195]
    buffer_load_dwordx4 v[28:31], v2, s[12:15], s18 offen offset:2048
    s_waitcnt lgkmcnt(11)
    v_mfma_f32_16x16x32_bf16 v[168:171], a[36:39], v[88:91], v[168:171]
    ds_read_b128 a[8:11], v6 offset:30720
    v_mfma_f32_16x16x32_bf16 v[196:199], a[36:39], v[92:95], v[196:199]
    buffer_load_dwordx2 v[32:33], v2, s[12:15], s18 offen offset:2064
    s_waitcnt lgkmcnt(10)
    v_mfma_f32_16x16x32_bf16 v[172:175], a[40:43], v[88:91], v[172:175]
    ds_read_b128 a[12:15], v6 offset:31744
    v_mfma_f32_16x16x32_bf16 v[200:203], a[40:43], v[92:95], v[200:203]
    s_waitcnt lgkmcnt(9)
    v_mfma_f32_16x16x32_bf16 v[176:179], a[44:47], v[88:91], v[176:179]
    ds_read_b128 a[16:19], v6 offset:32768
    v_mfma_f32_16x16x32_bf16 v[204:207], a[44:47], v[92:95], v[204:207]
    s_waitcnt lgkmcnt(8)
    v_mfma_f32_16x16x32_bf16 v[180:183], a[48:51], v[88:91], v[180:183]
    ds_read_b128 a[20:23], v6 offset:33792
    v_mfma_f32_16x16x32_bf16 v[208:211], a[48:51], v[92:95], v[208:211]
    s_waitcnt lgkmcnt(7)
    v_mfma_f32_16x16x32_bf16 v[184:187], a[52:55], v[88:91], v[184:187]
    ds_read_b128 a[24:27], v6 offset:34816
    v_mfma_f32_16x16x32_bf16 v[212:215], a[52:55], v[92:95], v[212:215]
    v_mfma_f32_16x16x32_bf16 v[244:247], v[96:99], v[96:99], v[244:247]
    ds_write_b128 v253, v[112:115] offset:0
    v_mfma_f32_16x16x32_bf16 v[248:251], v[100:103], v[100:103], v[248:251]
    s_waitcnt lgkmcnt(7)
    v_mfma_f32_16x16x32_bf16 v[160:163], a[0:3], v[96:99], v[160:163]
    ds_read_b128 a[28:31], v6 offset:35840
    s_waitcnt vmcnt(28)
    ds_write_b128 v253, v[120:123] offset:1152
    v_mfma_f32_16x16x32_bf16 v[188:191], a[0:3], v[100:103], v[188:191]
    buffer_load_dwordx4 v[34:37], v2, s[12:15], s18 offen offset:3072
    s_waitcnt lgkmcnt(8)
    v_mfma_f32_16x16x32_bf16 v[164:167], a[4:7], v[96:99], v[164:167]
    ds_read_b128 a[32:35], v6 offset:36864
    ds_read_b128 v[112:115], v254 offset:0
    v_mfma_f32_16x16x32_bf16 v[192:195], a[4:7], v[100:103], v[192:195]
    buffer_load_dwordx2 v[38:39], v2, s[12:15], s18 offen offset:3088
    s_waitcnt lgkmcnt(9)
    v_mfma_f32_16x16x32_bf16 v[168:171], a[8:11], v[96:99], v[168:171]
    ds_read_b128 a[36:39], v6 offset:37888
    ds_read_b128 v[120:123], v254 offset:64
    v_mfma_f32_16x16x32_bf16 v[196:199], a[8:11], v[100:103], v[196:199]
    s_waitcnt lgkmcnt(10)
    v_mfma_f32_16x16x32_bf16 v[172:175], a[12:15], v[96:99], v[172:175]
    ds_read_b128 a[40:43], v6 offset:38912
    s_waitcnt vmcnt(28)
    ds_write_b128 v253, v[116:119] offset:0
    v_mfma_f32_16x16x32_bf16 v[200:203], a[12:15], v[100:103], v[200:203]
    s_waitcnt lgkmcnt(11)
    v_mfma_f32_16x16x32_bf16 v[176:179], a[16:19], v[96:99], v[176:179]
    ds_read_b128 a[44:47], v6 offset:39936
    s_waitcnt vmcnt(26)
    ds_write_b128 v253, v[124:127] offset:1152
    v_mfma_f32_16x16x32_bf16 v[204:207], a[16:19], v[100:103], v[204:207]
    s_waitcnt lgkmcnt(12)
    v_mfma_f32_16x16x32_bf16 v[180:183], a[20:23], v[96:99], v[180:183]
    ds_read_b128 a[48:51], v6 offset:40960
    ds_read_b128 v[116:119], v254 offset:0
    v_mfma_f32_16x16x32_bf16 v[208:211], a[20:23], v[100:103], v[208:211]
    s_waitcnt lgkmcnt(13)
    v_mfma_f32_16x16x32_bf16 v[184:187], a[24:27], v[96:99], v[184:187]
    ds_read_b128 a[52:55], v6 offset:41984
    ds_read_b128 v[124:127], v254 offset:64
    v_mfma_f32_16x16x32_bf16 v[212:215], a[24:27], v[100:103], v[212:215]
    s_cmp_eq_u32 s71, 0
    s_nop 6
    s_cbranch_scc1 KF_GC
    s_waitcnt vmcnt(19)
    s_barrier
    v_mfma_f32_16x16x32_bf16 v[244:247], v[104:107], v[104:107], v[244:247]
    v_mfma_f32_16x16x32_bf16 v[248:251], v[108:111], v[108:111], v[248:251]
    s_waitcnt lgkmcnt(13)
    v_mfma_f32_16x16x32_bf16 v[160:163], a[28:31], v[104:107], v[160:163]
    ds_read_b128 a[0:3], v2 offset:0
    v_mfma_f32_16x16x32_bf16 v[188:191], a[28:31], v[108:111], v[188:191]
    s_waitcnt lgkmcnt(12)
    v_mfma_f32_16x16x32_bf16 v[164:167], a[32:35], v[104:107], v[164:167]
    ds_read_b128 a[4:7], v2 offset:1024
    v_mfma_f32_16x16x32_bf16 v[192:195], a[32:35], v[108:111], v[192:195]
    s_waitcnt lgkmcnt(11)
    v_mfma_f32_16x16x32_bf16 v[168:171], a[36:39], v[104:107], v[168:171]
    ds_read_b128 a[8:11], v2 offset:2048
    v_mfma_f32_16x16x32_bf16 v[196:199], a[36:39], v[108:111], v[196:199]
    s_waitcnt lgkmcnt(10)
    v_mfma_f32_16x16x32_bf16 v[172:175], a[40:43], v[104:107], v[172:175]
    ds_read_b128 a[12:15], v2 offset:3072
    v_mfma_f32_16x16x32_bf16 v[200:203], a[40:43], v[108:111], v[200:203]
    s_waitcnt lgkmcnt(9)
    v_mfma_f32_16x16x32_bf16 v[176:179], a[44:47], v[104:107], v[176:179]
    ds_read_b128 a[16:19], v2 offset:4096
    v_mfma_f32_16x16x32_bf16 v[204:207], a[44:47], v[108:111], v[204:207]
    s_waitcnt lgkmcnt(8)
    v_mfma_f32_16x16x32_bf16 v[180:183], a[48:51], v[104:107], v[180:183]
    ds_read_b128 a[20:23], v2 offset:5120
    v_mfma_f32_16x16x32_bf16 v[208:211], a[48:51], v[108:111], v[208:211]
    s_waitcnt lgkmcnt(7)
    v_mfma_f32_16x16x32_bf16 v[184:187], a[52:55], v[104:107], v[184:187]
    ds_read_b128 a[24:27], v2 offset:6144
    v_mfma_f32_16x16x32_bf16 v[212:215], a[52:55], v[108:111], v[212:215]
    v_mfma_f32_16x16x32_bf16 v[244:247], v[112:115], v[112:115], v[244:247]
    ds_write_b128 v253, v[128:131] offset:0
    ds_write_b128 v253, v[136:139] offset:1152
    v_mfma_f32_16x16x32_bf16 v[248:251], v[116:119], v[116:119], v[248:251]
    ds_read_b128 v[128:131], v254 offset:0
    s_waitcnt lgkmcnt(9)
    v_mfma_f32_16x16x32_bf16 v[160:163], a[0:3], v[112:115], v[160:163]
    ds_read_b128 a[28:31], v2 offset:7168
    ds_read_b128 v[136:139], v254 offset:64
    ds_write_b128 v253, v[132:135] offset:0
    v_mfma_f32_16x16x32_bf16 v[188:191], a[0:3], v[116:119], v[188:191]
    s_add_u32 s5, s18, 5144576
    buffer_store_dwordx4 v[224:227], v2, s[8:11], s5 offen offset:0 sc1
    s_waitcnt vmcnt(19)
    ds_write_b128 v253, v[140:143] offset:1152
    s_waitcnt lgkmcnt(12)
    v_mfma_f32_16x16x32_bf16 v[164:167], a[4:7], v[112:115], v[164:167]
    ds_read_b128 a[32:35], v2 offset:8192
    ds_read_b128 v[132:135], v254 offset:0
    v_mfma_f32_16x16x32_bf16 v[192:195], a[4:7], v[116:119], v[192:195]
    buffer_store_dwordx4 v[224:227], v2, s[8:11], s5 offen offset:1024 sc1
    ds_read_b128 v[140:143], v254 offset:64
    s_add_u32 s4, s19, 16640
    s_waitcnt lgkmcnt(14)
    v_mfma_f32_16x16x32_bf16 v[168:171], a[8:11], v[112:115], v[168:171]
    ds_read_b128 a[36:39], v2 offset:9216
    v_add_u32 v228, s19, v2
    v_mfma_f32_16x16x32_bf16 v[196:199], a[8:11], v[116:119], v[196:199]
    buffer_store_dwordx4 v[224:227], v2, s[8:11], s5 offen offset:2048 sc1
    v_lshlrev_b32 v229, 3, v1
    s_waitcnt lgkmcnt(14)
    v_mfma_f32_16x16x32_bf16 v[172:175], a[12:15], v[112:115], v[172:175]
    ds_read_b128 a[40:43], v2 offset:10240
    v_add_u32 v229, s4, v229
    v_mov_b32 v52, 0
    v_mfma_f32_16x16x32_bf16 v[200:203], a[12:15], v[116:119], v[200:203]
    buffer_store_dwordx4 v[224:227], v2, s[8:11], s5 offen offset:3072 sc1
    v_mov_b32 v53, 0
    s_waitcnt lgkmcnt(14)
    v_mfma_f32_16x16x32_bf16 v[176:179], a[16:19], v[112:115], v[176:179]
    ds_read_b128 a[44:47], v2 offset:11264
    v_mov_b32 v54, 0
    v_mov_b32 v55, 0
    v_mfma_f32_16x16x32_bf16 v[204:207], a[16:19], v[116:119], v[204:207]
    ds_write_b64 v229, v[52:53] offset:4096
    v_mfma_f32_16x16x32_bf16 v[180:183], a[20:23], v[112:115], v[180:183]
    ds_read_b128 a[48:51], v2 offset:12288
    s_waitcnt vmcnt(11)
    ds_write_b128 v228, v[16:19] offset:32
    v_mfma_f32_16x16x32_bf16 v[208:211], a[20:23], v[116:119], v[208:211]
    v_alignbit_b32 v40, v17, v16, 16
    v_alignbit_b32 v41, v18, v17, 16
    v_mfma_f32_16x16x32_bf16 v[184:187], a[24:27], v[112:115], v[184:187]
    ds_read_b128 a[52:55], v2 offset:13312
    v_alignbit_b32 v42, v19, v18, 16
    v_mfma_f32_16x16x32_bf16 v[212:215], a[24:27], v[116:119], v[212:215]
    s_waitcnt vmcnt(10)
    v_alignbit_b32 v43, v20, v19, 16
    v_mfma_f32_16x16x32_bf16 v[244:247], v[120:123], v[120:123], v[244:247]
    ds_write_b128 v228, v[40:43] offset:4192
    v_mfma_f32_16x16x32_bf16 v[248:251], v[124:127], v[124:127], v[248:251]
    v_mov_b32 v44, v17
    s_waitcnt lgkmcnt(14)
    v_mfma_f32_16x16x32_bf16 v[160:163], a[28:31], v[120:123], v[160:163]
    ds_read_b128 a[0:3], v2 offset:14336
    v_mov_b32 v45, v18
    v_mfma_f32_16x16x32_bf16 v[188:191], a[28:31], v[124:127], v[188:191]
    v_mov_b32 v46, v19
    s_waitcnt lgkmcnt(11)
    v_mfma_f32_16x16x32_bf16 v[164:167], a[32:35], v[120:123], v[164:167]
    ds_read_b128 a[4:7], v2 offset:15360
    v_mov_b32 v47, v20
    v_mfma_f32_16x16x32_bf16 v[192:195], a[32:35], v[124:127], v[192:195]
    ds_write_b128 v228, v[44:47] offset:8352
    s_waitcnt lgkmcnt(10)
    v_mfma_f32_16x16x32_bf16 v[168:171], a[36:39], v[120:123], v[168:171]
    ds_read_b128 a[8:11], v2 offset:16384
    v_alignbit_b32 v48, v18, v17, 16
    v_mfma_f32_16x16x32_bf16 v[196:199], a[36:39], v[124:127], v[196:199]
    s_waitcnt lgkmcnt(10)
    v_mfma_f32_16x16x32_bf16 v[172:175], a[40:43], v[120:123], v[172:175]
    ds_read_b128 a[12:15], v2 offset:17408
    v_alignbit_b32 v49, v19, v18, 16
    v_mfma_f32_16x16x32_bf16 v[200:203], a[40:43], v[124:127], v[200:203]
    v_alignbit_b32 v50, v20, v19, 16
    s_waitcnt lgkmcnt(10)
    v_mfma_f32_16x16x32_bf16 v[176:179], a[44:47], v[120:123], v[176:179]
    ds_read_b128 a[16:19], v2 offset:18432
    v_alignbit_b32 v51, v21, v20, 16
    v_mfma_f32_16x16x32_bf16 v[204:207], a[44:47], v[124:127], v[204:207]
    ds_write_b128 v228, v[48:51] offset:12512
    s_waitcnt lgkmcnt(10)
    v_mfma_f32_16x16x32_bf16 v[180:183], a[48:51], v[120:123], v[180:183]
    ds_read_b128 a[20:23], v2 offset:19456
    s_mov_b64 exec, 1
    ds_write_b128 v228, v[52:55] offset:0
    ds_write_b128 v228, v[52:55] offset:4160
    ds_write_b128 v228, v[52:55] offset:8320
    ds_write_b128 v228, v[52:55] offset:12480
    ds_write_b128 v228, v[52:55] offset:16
    s_mov_b64 exec, -1
    v_mfma_f32_16x16x32_bf16 v[208:211], a[48:51], v[124:127], v[208:211]
    v_mov_b32 v56, 0
    s_waitcnt lgkmcnt(14)
    v_mfma_f32_16x16x32_bf16 v[184:187], a[52:55], v[120:123], v[184:187]
    ds_read_b128 a[24:27], v2 offset:20480
    v_mov_b32 v57, 0
    v_mfma_f32_16x16x32_bf16 v[212:215], a[52:55], v[124:127], v[212:215]
    s_barrier
    v_mfma_f32_16x16x32_bf16 v[244:247], v[128:131], v[128:131], v[244:247]
    ds_write_b128 v253, v[144:147] offset:0
    ds_write_b128 v253, v[152:155] offset:1152
    v_mfma_f32_16x16x32_bf16 v[248:251], v[132:135], v[132:135], v[248:251]
    ds_read_b128 v[144:147], v254 offset:0
    v_mfma_f32_16x16x32_bf16 v[160:163], a[0:3], v[128:131], v[160:163]
    ds_read_b128 a[28:31], v2 offset:21504
    ds_read_b128 v[152:155], v254 offset:64
    ds_write_b128 v253, v[148:151] offset:0
    v_mfma_f32_16x16x32_bf16 v[188:191], a[0:3], v[132:135], v[188:191]
    buffer_store_dwordx4 v[224:227], v2, s[8:11], s25 offen offset:0 sc1
    ds_write_b128 v253, v[156:159] offset:1152
    v_mfma_f32_16x16x32_bf16 v[164:167], a[4:7], v[128:131], v[164:167]
    ds_read_b128 a[32:35], v2 offset:22528
    ds_read_b128 v[148:151], v254 offset:0
    v_mfma_f32_16x16x32_bf16 v[192:195], a[4:7], v[132:135], v[192:195]
    ds_read_b128 v[156:159], v254 offset:64
    v_mov_b32 v58, 0
    v_mfma_f32_16x16x32_bf16 v[168:171], a[8:11], v[128:131], v[168:171]
    ds_read_b128 a[36:39], v2 offset:23552
    v_lshlrev_b32 v59, 16, v16
    v_mfma_f32_16x16x32_bf16 v[196:199], a[8:11], v[132:135], v[196:199]
    v_mov_b32 v60, 0
    v_mfma_f32_16x16x32_bf16 v[172:175], a[12:15], v[128:131], v[172:175]
    ds_read_b128 a[40:43], v2 offset:24576
    v_mov_b32 v61, 0
    v_mov_b32 v62, 0
    v_mfma_f32_16x16x32_bf16 v[200:203], a[12:15], v[132:135], v[200:203]
    v_mov_b32 v63, v16
    v_mfma_f32_16x16x32_bf16 v[176:179], a[16:19], v[128:131], v[176:179]
    ds_read_b128 a[44:47], v2 offset:25600
    v_mov_b32 v54, v59
    v_mov_b32 v55, v40
    s_mov_b64 exec, 1
    ds_write_b128 v228, v[56:59] offset:4176
    ds_write_b128 v228, v[60:63] offset:8336
    ds_write_b128 v228, v[52:55] offset:12496
    s_mov_b64 exec, -1
    s_waitcnt vmcnt(10)
    ds_write_b128 v228, v[22:25] offset:1056
    v_mfma_f32_16x16x32_bf16 v[204:207], a[16:19], v[132:135], v[204:207]
    v_alignbit_b32 v40, v23, v22, 16
    v_mfma_f32_16x16x32_bf16 v[180:183], a[20:23], v[128:131], v[180:183]
    ds_read_b128 a[48:51], v2 offset:26624
    v_alignbit_b32 v41, v24, v23, 16
    v_mfma_f32_16x16x32_bf16 v[208:211], a[20:23], v[132:135], v[208:211]
    v_alignbit_b32 v42, v25, v24, 16
    s_waitcnt vmcnt(9)
    v_alignbit_b32 v43, v26, v25, 16
    v_mfma_f32_16x16x32_bf16 v[184:187], a[24:27], v[128:131], v[184:187]
    ds_read_b128 a[52:55], v2 offset:27648
    ds_write_b128 v228, v[40:43] offset:5216
    v_mfma_f32_16x16x32_bf16 v[212:215], a[24:27], v[132:135], v[212:215]
    v_mov_b32 v44, v23
    v_mfma_f32_16x16x32_bf16 v[244:247], v[136:139], v[136:139], v[244:247]
    v_mov_b32 v45, v24
    v_mfma_f32_16x16x32_bf16 v[248:251], v[140:143], v[140:143], v[248:251]
    v_mov_b32 v46, v25
    v_mfma_f32_16x16x32_bf16 v[160:163], a[28:31], v[136:139], v[160:163]
    ds_read_b128 a[0:3], v2 offset:28672
    v_mov_b32 v47, v26
    v_mfma_f32_16x16x32_bf16 v[188:191], a[28:31], v[140:143], v[188:191]
    ds_read_b128 a[4:7], v2 offset:29696
    buffer_store_dwordx4 v[224:227], v2, s[8:11], s25 offen offset:1024 sc1
    ds_write_b128 v228, v[44:47] offset:9376
    v_mfma_f32_16x16x32_bf16 v[164:167], a[32:35], v[136:139], v[164:167]
    ds_read_b128 a[8:11], v2 offset:30720
    v_alignbit_b32 v48, v24, v23, 16
    v_mfma_f32_16x16x32_bf16 v[192:195], a[32:35], v[140:143], v[192:195]
    ds_read_b128 a[12:15], v2 offset:31744
    v_alignbit_b32 v49, v25, v24, 16
    s_waitcnt lgkmcnt(14)
    v_mfma_f32_16x16x32_bf16 v[168:171], a[36:39], v[136:139], v[168:171]
    ds_read_b128 a[16:19], v2 offset:32768
    v_alignbit_b32 v50, v26, v25, 16
    v_mfma_f32_16x16x32_bf16 v[196:199], a[36:39], v[140:143], v[196:199]
    ds_read_b128 a[20:23], v2 offset:33792
    v_mfma_f32_16x16x32_bf16 v[172:175], a[40:43], v[136:139], v[172:175]
    ds_read_b128 a[24:27], v2 offset:34816
    v_alignbit_b32 v51, v27, v26, 16
    v_mfma_f32_16x16x32_bf16 v[200:203], a[40:43], v[140:143], v[200:203]
    ds_read_b128 v[64:67], v7 offset:0
    ds_write_b128 v228, v[48:51] offset:13536
    v_mfma_f32_16x16x32_bf16 v[176:179], a[44:47], v[136:139], v[176:179]
    ds_read_b128 v[92:95], v7 offset:16
    s_waitcnt vmcnt(9)
    ds_write_b128 v228, v[28:31] offset:2080
    v_mfma_f32_16x16x32_bf16 v[204:207], a[44:47], v[140:143], v[204:207]
    ds_read_b128 v[68:71], v7 offset:64
    v_alignbit_b32 v40, v29, v28, 16
    v_mfma_f32_16x16x32_bf16 v[180:183], a[48:51], v[136:139], v[180:183]
    ds_read_b128 v[96:99], v7 offset:80
    v_alignbit_b32 v41, v30, v29, 16
    v_mfma_f32_16x16x32_bf16 v[208:211], a[48:51], v[140:143], v[208:211]
    ds_read_b128 v[72:75], v7 offset:128
    v_alignbit_b32 v42, v31, v30, 16
    v_mfma_f32_16x16x32_bf16 v[184:187], a[52:55], v[136:139], v[184:187]
    ds_read_b128 v[100:103], v7 offset:144
    s_waitcnt vmcnt(8)
    v_alignbit_b32 v43, v32, v31, 16
    v_mfma_f32_16x16x32_bf16 v[212:215], a[52:55], v[140:143], v[212:215]
    ds_read_b128 v[76:79], v7 offset:192
    ds_read_b128 v[104:107], v7 offset:208
    ds_read_b128 v[80:83], v7 offset:256
    ds_read_b128 v[108:111], v7 offset:272
    ds_read_b128 v[84:87], v7 offset:320
    ds_read_b128 v[112:115], v7 offset:336
    ds_read_b128 v[88:91], v7 offset:384
    ds_read_b128 v[116:119], v7 offset:400
    v_mfma_f32_16x16x32_bf16 v[244:247], v[144:147], v[144:147], v[244:247]
    ds_write_b128 v228, v[40:43] offset:6240
    v_mfma_f32_16x16x32_bf16 v[248:251], v[148:151], v[148:151], v[248:251]
    v_mov_b32 v44, v29
    v_mfma_f32_16x16x32_bf16 v[160:163], a[0:3], v[144:147], v[160:163]
    ds_read_b128 a[28:31], v2 offset:35840
    v_mov_b32 v45, v30
    v_mfma_f32_16x16x32_bf16 v[188:191], a[0:3], v[148:151], v[188:191]
    s_mov_b64 exec, 0xffff
    buffer_store_dwordx4 v[224:227], v2, s[8:11], s25 offen offset:2048 sc1
    s_mov_b64 exec, -1
    s_mov_b32 s25, 0
    v_mov_b32 v46, v31
    v_mfma_f32_16x16x32_bf16 v[164:167], a[4:7], v[144:147], v[164:167]
    ds_read_b128 a[32:35], v2 offset:36864
    v_mov_b32 v47, v32
    v_mfma_f32_16x16x32_bf16 v[192:195], a[4:7], v[148:151], v[192:195]
    ds_write_b128 v228, v[44:47] offset:10400
    v_mfma_f32_16x16x32_bf16 v[168:171], a[8:11], v[144:147], v[168:171]
    ds_read_b128 a[36:39], v2 offset:37888
    v_alignbit_b32 v48, v30, v29, 16
    v_mfma_f32_16x16x32_bf16 v[196:199], a[8:11], v[148:151], v[196:199]
    v_mfma_f32_16x16x32_bf16 v[172:175], a[12:15], v[144:147], v[172:175]
    ds_read_b128 a[40:43], v2 offset:38912
    v_alignbit_b32 v49, v31, v30, 16
    v_mfma_f32_16x16x32_bf16 v[200:203], a[12:15], v[148:151], v[200:203]
    v_alignbit_b32 v50, v32, v31, 16
    v_mfma_f32_16x16x32_bf16 v[176:179], a[16:19], v[144:147], v[176:179]
    ds_read_b128 a[44:47], v2 offset:39936
    v_alignbit_b32 v51, v33, v32, 16
    v_mfma_f32_16x16x32_bf16 v[204:207], a[16:19], v[148:151], v[204:207]
    ds_write_b128 v228, v[48:51] offset:14560
    v_mfma_f32_16x16x32_bf16 v[180:183], a[20:23], v[144:147], v[180:183]
    ds_read_b128 a[48:51], v2 offset:40960
    s_waitcnt vmcnt(8)
    ds_write_b128 v228, v[34:37] offset:3104
    v_mfma_f32_16x16x32_bf16 v[208:211], a[20:23], v[148:151], v[208:211]
    v_alignbit_b32 v40, v35, v34, 16
    v_mfma_f32_16x16x32_bf16 v[184:187], a[24:27], v[144:147], v[184:187]
    ds_read_b128 a[52:55], v2 offset:41984
    v_alignbit_b32 v41, v36, v35, 16
    v_mfma_f32_16x16x32_bf16 v[212:215], a[24:27], v[148:151], v[212:215]
    v_mfma_f32_16x16x32_bf16 v[244:247], v[152:155], v[152:155], v[244:247]
    v_alignbit_b32 v42, v37, v36, 16
    v_mfma_f32_16x16x32_bf16 v[248:251], v[156:159], v[156:159], v[248:251]
    s_waitcnt vmcnt(7)
    v_alignbit_b32 v43, v38, v37, 16
    s_waitcnt lgkmcnt(9)
    v_mfma_f32_16x16x32_bf16 v[160:163], a[28:31], v[152:155], v[160:163]
    ds_write_b128 v228, v[40:43] offset:7264
    v_mfma_f32_16x16x32_bf16 v[188:191], a[28:31], v[156:159], v[188:191]
    v_mov_b32 v44, v35
    s_waitcnt lgkmcnt(9)
    v_mfma_f32_16x16x32_bf16 v[164:167], a[32:35], v[152:155], v[164:167]
    v_mov_b32 v45, v36
    v_mfma_f32_16x16x32_bf16 v[192:195], a[32:35], v[156:159], v[192:195]
    v_mov_b32 v46, v37
    s_waitcnt lgkmcnt(7)
    v_mfma_f32_16x16x32_bf16 v[168:171], a[36:39], v[152:155], v[168:171]
    v_mov_b32 v47, v38
    v_mfma_f32_16x16x32_bf16 v[196:199], a[36:39], v[156:159], v[196:199]
    s_waitcnt lgkmcnt(6)
    v_mfma_f32_16x16x32_bf16 v[172:175], a[40:43], v[152:155], v[172:175]
    ds_write_b128 v228, v[44:47] offset:11424
    v_mfma_f32_16x16x32_bf16 v[200:203], a[40:43], v[156:159], v[200:203]
    v_alignbit_b32 v48, v36, v35, 16
    s_waitcnt lgkmcnt(6)
    v_mfma_f32_16x16x32_bf16 v[176:179], a[44:47], v[152:155], v[176:179]
    v_alignbit_b32 v49, v37, v36, 16
    v_mfma_f32_16x16x32_bf16 v[204:207], a[44:47], v[156:159], v[204:207]
    v_alignbit_b32 v50, v38, v37, 16
    s_waitcnt lgkmcnt(4)
    v_mfma_f32_16x16x32_bf16 v[180:183], a[48:51], v[152:155], v[180:183]
    v_alignbit_b32 v51, v39, v38, 16
    v_mfma_f32_16x16x32_bf16 v[208:211], a[48:51], v[156:159], v[208:211]
    ds_write_b128 v228, v[48:51] offset:15584
    s_waitcnt lgkmcnt(3)
    v_mfma_f32_16x16x32_bf16 v[184:187], a[52:55], v[152:155], v[184:187]
    s_and_b32 s7, s70, 1
    s_cmp_eq_u32 s7, 0
    s_cselect_b32 s7, 16, 0
    s_lshl_b32 s17, s17, s7
    s_and_b32 s17, s17, 0xffff0000
    v_mfma_f32_16x16x32_bf16 v[212:215], a[52:55], v[156:159], v[212:215]
    s_nop 7
    s_branch KF_POST
KF_GC:
    s_waitcnt vmcnt(19)
    s_barrier
    v_mfma_f32_16x16x32_bf16 v[244:247], v[104:107], v[104:107], v[244:247]
    v_mfma_f32_16x16x32_bf16 v[248:251], v[108:111], v[108:111], v[248:251]
    s_waitcnt lgkmcnt(13)
    v_mfma_f32_16x16x32_bf16 v[160:163], a[28:31], v[104:107], v[160:163]
    ds_read_b128 a[0:3], v2 offset:0
    v_mfma_f32_16x16x32_bf16 v[188:191], a[28:31], v[108:111], v[188:191]
    s_waitcnt lgkmcnt(12)
    v_mfma_f32_16x16x32_bf16 v[164:167], a[32:35], v[104:107], v[164:167]
    ds_read_b128 a[4:7], v2 offset:1024
    v_mfma_f32_16x16x32_bf16 v[192:195], a[32:35], v[108:111], v[192:195]
    s_waitcnt lgkmcnt(11)
    v_mfma_f32_16x16x32_bf16 v[168:171], a[36:39], v[104:107], v[168:171]
    ds_read_b128 a[8:11], v2 offset:2048
    v_mfma_f32_16x16x32_bf16 v[196:199], a[36:39], v[108:111], v[196:199]
    s_waitcnt lgkmcnt(10)
    v_mfma_f32_16x16x32_bf16 v[172:175], a[40:43], v[104:107], v[172:175]
    ds_read_b128 a[12:15], v2 offset:3072
    v_mfma_f32_16x16x32_bf16 v[200:203], a[40:43], v[108:111], v[200:203]
    s_waitcnt lgkmcnt(9)
    v_mfma_f32_16x16x32_bf16 v[176:179], a[44:47], v[104:107], v[176:179]
    ds_read_b128 a[16:19], v2 offset:4096
    v_mfma_f32_16x16x32_bf16 v[204:207], a[44:47], v[108:111], v[204:207]
    s_waitcnt lgkmcnt(8)
    v_mfma_f32_16x16x32_bf16 v[180:183], a[48:51], v[104:107], v[180:183]
    ds_read_b128 a[20:23], v2 offset:5120
    v_mfma_f32_16x16x32_bf16 v[208:211], a[48:51], v[108:111], v[208:211]
    s_waitcnt lgkmcnt(7)
    v_mfma_f32_16x16x32_bf16 v[184:187], a[52:55], v[104:107], v[184:187]
    ds_read_b128 a[24:27], v2 offset:6144
    v_mfma_f32_16x16x32_bf16 v[212:215], a[52:55], v[108:111], v[212:215]
    v_mfma_f32_16x16x32_bf16 v[244:247], v[112:115], v[112:115], v[244:247]
    ds_write_b128 v253, v[128:131] offset:0
    v_mfma_f32_16x16x32_bf16 v[248:251], v[116:119], v[116:119], v[248:251]
    s_waitcnt lgkmcnt(7)
    v_mfma_f32_16x16x32_bf16 v[160:163], a[0:3], v[112:115], v[160:163]
    ds_read_b128 a[28:31], v2 offset:7168
    ds_write_b128 v253, v[136:139] offset:1152
    v_mfma_f32_16x16x32_bf16 v[188:191], a[0:3], v[116:119], v[188:191]
    s_waitcnt lgkmcnt(8)
    v_mfma_f32_16x16x32_bf16 v[164:167], a[4:7], v[112:115], v[164:167]
    ds_read_b128 a[32:35], v2 offset:8192
    ds_read_b128 v[128:131], v254 offset:0
    v_mfma_f32_16x16x32_bf16 v[192:195], a[4:7], v[116:119], v[192:195]
    s_waitcnt lgkmcnt(9)
    v_mfma_f32_16x16x32_bf16 v[168:171], a[8:11], v[112:115], v[168:171]
    ds_read_b128 a[36:39], v2 offset:9216
    ds_read_b128 v[136:139], v254 offset:64
    v_mfma_f32_16x16x32_bf16 v[196:199], a[8:11], v[116:119], v[196:199]
    s_waitcnt lgkmcnt(10)
    v_mfma_f32_16x16x32_bf16 v[172:175], a[12:15], v[112:115], v[172:175]
    ds_read_b128 a[40:43], v2 offset:10240
    ds_write_b128 v253, v[132:135] offset:0
    v_mfma_f32_16x16x32_bf16 v[200:203], a[12:15], v[116:119], v[200:203]
    s_waitcnt lgkmcnt(11)
    v_mfma_f32_16x16x32_bf16 v[176:179], a[16:19], v[112:115], v[176:179]
    ds_read_b128 a[44:47], v2 offset:11264
    s_waitcnt vmcnt(18)
    ds_write_b128 v253, v[140:143] offset:1152
    v_mfma_f32_16x16x32_bf16 v[204:207], a[16:19], v[116:119], v[204:207]
    s_waitcnt lgkmcnt(12)
    v_mfma_f32_16x16x32_bf16 v[180:183], a[20:23], v[112:115], v[180:183]
    ds_read_b128 a[48:51], v2 offset:12288
    ds_read_b128 v[132:135], v254 offset:0
    v_mfma_f32_16x16x32_bf16 v[208:211], a[20:23], v[116:119], v[208:211]
    s_waitcnt lgkmcnt(13)
    v_mfma_f32_16x16x32_bf16 v[184:187], a[24:27], v[112:115], v[184:187]
    ds_read_b128 a[52:55], v2 offset:13312
    ds_read_b128 v[140:143], v254 offset:64
    v_mfma_f32_16x16x32_bf16 v[212:215], a[24:27], v[116:119], v[212:215]
    v_mfma_f32_16x16x32_bf16 v[244:247], v[120:123], v[120:123], v[244:247]
    v_mfma_f32_16x16x32_bf16 v[248:251], v[124:127], v[124:127], v[248:251]
    s_waitcnt lgkmcnt(13)
    v_mfma_f32_16x16x32_bf16 v[160:163], a[28:31], v[120:123], v[160:163]
    ds_read_b128 a[0:3], v2 offset:14336
    v_mfma_f32_16x16x32_bf16 v[188:191], a[28:31], v[124:127], v[188:191]
    s_waitcnt lgkmcnt(12)
    v_mfma_f32_16x16x32_bf16 v[164:167], a[32:35], v[120:123], v[164:167]
    ds_read_b128 a[4:7], v2 offset:15360
    v_mfma_f32_16x16x32_bf16 v[192:195], a[32:35], v[124:127], v[192:195]
    s_waitcnt lgkmcnt(11)
    v_mfma_f32_16x16x32_bf16 v[168:171], a[36:39], v[120:123], v[168:171]
    ds_read_b128 a[8:11], v2 offset:16384
    v_mfma_f32_16x16x32_bf16 v[196:199], a[36:39], v[124:127], v[196:199]
    s_waitcnt lgkmcnt(10)
    v_mfma_f32_16x16x32_bf16 v[172:175], a[40:43], v[120:123], v[172:175]
    ds_read_b128 a[12:15], v2 offset:17408
    v_mfma_f32_16x16x32_bf16 v[200:203], a[40:43], v[124:127], v[200:203]
    s_waitcnt lgkmcnt(9)
    v_mfma_f32_16x16x32_bf16 v[176:179], a[44:47], v[120:123], v[176:179]
    ds_read_b128 a[16:19], v2 offset:18432
    v_mfma_f32_16x16x32_bf16 v[204:207], a[44:47], v[124:127], v[204:207]
    s_waitcnt lgkmcnt(8)
    v_mfma_f32_16x16x32_bf16 v[180:183], a[48:51], v[120:123], v[180:183]
    ds_read_b128 a[20:23], v2 offset:19456
    v_mfma_f32_16x16x32_bf16 v[208:211], a[48:51], v[124:127], v[208:211]
    s_waitcnt lgkmcnt(7)
    v_mfma_f32_16x16x32_bf16 v[184:187], a[52:55], v[120:123], v[184:187]
    ds_read_b128 a[24:27], v2 offset:20480
    v_mfma_f32_16x16x32_bf16 v[212:215], a[52:55], v[124:127], v[212:215]
    s_waitcnt vmcnt(8)
    s_barrier
    v_mfma_f32_16x16x32_bf16 v[244:247], v[128:131], v[128:131], v[244:247]
    ds_write_b128 v253, v[144:147] offset:0
    v_mfma_f32_16x16x32_bf16 v[248:251], v[132:135], v[132:135], v[248:251]
    s_waitcnt lgkmcnt(7)
    v_mfma_f32_16x16x32_bf16 v[160:163], a[0:3], v[128:131], v[160:163]
    ds_read_b128 a[28:31], v2 offset:21504
    ds_write_b128 v253, v[152:155] offset:1152
    v_mfma_f32_16x16x32_bf16 v[188:191], a[0:3], v[132:135], v[188:191]
    buffer_store_dwordx4 v[224:227], v2, s[8:11], s25 offen offset:0 sc1
    s_waitcnt lgkmcnt(8)
    v_mfma_f32_16x16x32_bf16 v[164:167], a[4:7], v[128:131], v[164:167]
    ds_read_b128 a[32:35], v2 offset:22528
    ds_read_b128 v[144:147], v254 offset:0
    v_mfma_f32_16x16x32_bf16 v[192:195], a[4:7], v[132:135], v[192:195]
    s_waitcnt lgkmcnt(9)
    v_mfma_f32_16x16x32_bf16 v[168:171], a[8:11], v[128:131], v[168:171]
    ds_read_b128 a[36:39], v2 offset:23552
    ds_read_b128 v[152:155], v254 offset:64
    v_mfma_f32_16x16x32_bf16 v[196:199], a[8:11], v[132:135], v[196:199]
    s_waitcnt lgkmcnt(10)
    v_mfma_f32_16x16x32_bf16 v[172:175], a[12:15], v[128:131], v[172:175]
    ds_read_b128 a[40:43], v2 offset:24576
    ds_write_b128 v253, v[148:151] offset:0
    v_mfma_f32_16x16x32_bf16 v[200:203], a[12:15], v[132:135], v[200:203]
    s_waitcnt lgkmcnt(11)
    v_mfma_f32_16x16x32_bf16 v[176:179], a[16:19], v[128:131], v[176:179]
    ds_read_b128 a[44:47], v2 offset:25600
    ds_write_b128 v253, v[156:159] offset:1152
    v_mfma_f32_16x16x32_bf16 v[204:207], a[16:19], v[132:135], v[204:207]
    s_waitcnt lgkmcnt(12)
    v_mfma_f32_16x16x32_bf16 v[180:183], a[20:23], v[128:131], v[180:183]
    ds_read_b128 a[48:51], v2 offset:26624
    ds_read_b128 v[148:151], v254 offset:0
    v_mfma_f32_16x16x32_bf16 v[208:211], a[20:23], v[132:135], v[208:211]
    s_waitcnt lgkmcnt(13)
    v_mfma_f32_16x16x32_bf16 v[184:187], a[24:27], v[128:131], v[184:187]
    ds_read_b128 a[52:55], v2 offset:27648
    ds_read_b128 v[156:159], v254 offset:64
    v_mfma_f32_16x16x32_bf16 v[212:215], a[24:27], v[132:135], v[212:215]
    v_mfma_f32_16x16x32_bf16 v[244:247], v[136:139], v[136:139], v[244:247]
    v_mfma_f32_16x16x32_bf16 v[248:251], v[140:143], v[140:143], v[248:251]
    s_waitcnt lgkmcnt(13)
    v_mfma_f32_16x16x32_bf16 v[160:163], a[28:31], v[136:139], v[160:163]
    ds_read_b128 a[0:3], v2 offset:28672
    v_mfma_f32_16x16x32_bf16 v[188:191], a[28:31], v[140:143], v[188:191]
    ds_read_b128 a[4:7], v2 offset:29696
    buffer_store_dwordx4 v[224:227], v2, s[8:11], s25 offen offset:1024 sc1
    s_waitcnt lgkmcnt(13)
    v_mfma_f32_16x16x32_bf16 v[164:167], a[32:35], v[136:139], v[164:167]
    ds_read_b128 a[8:11], v2 offset:30720
    v_mfma_f32_16x16x32_bf16 v[192:195], a[32:35], v[140:143], v[192:195]
    ds_read_b128 a[12:15], v2 offset:31744
    s_waitcnt lgkmcnt(13)
    v_mfma_f32_16x16x32_bf16 v[168:171], a[36:39], v[136:139], v[168:171]
    ds_read_b128 a[16:19], v2 offset:32768
    v_mfma_f32_16x16x32_bf16 v[196:199], a[36:39], v[140:143], v[196:199]
    ds_read_b128 a[20:23], v2 offset:33792
    s_waitcnt lgkmcnt(13)
    v_mfma_f32_16x16x32_bf16 v[172:175], a[40:43], v[136:139], v[172:175]
    ds_read_b128 a[24:27], v2 offset:34816
    v_mfma_f32_16x16x32_bf16 v[200:203], a[40:43], v[140:143], v[200:203]
    ds_read_b128 v[64:67], v7 offset:0
    s_waitcnt lgkmcnt(13)
    v_mfma_f32_16x16x32_bf16 v[176:179], a[44:47], v[136:139], v[176:179]
    ds_read_b128 v[92:95], v7 offset:16
    v_mfma_f32_16x16x32_bf16 v[204:207], a[44:47], v[140:143], v[204:207]
    ds_read_b128 v[68:71], v7 offset:64
    s_waitcnt lgkmcnt(13)
    v_mfma_f32_16x16x32_bf16 v[180:183], a[48:51], v[136:139], v[180:183]
    ds_read_b128 v[96:99], v7 offset:80
    v_mfma_f32_16x16x32_bf16 v[208:211], a[48:51], v[140:143], v[208:211]
    ds_read_b128 v[72:75], v7 offset:128
    s_waitcnt lgkmcnt(13)
    v_mfma_f32_16x16x32_bf16 v[184:187], a[52:55], v[136:139], v[184:187]
    ds_read_b128 v[100:103], v7 offset:144
    v_mfma_f32_16x16x32_bf16 v[212:215], a[52:55], v[140:143], v[212:215]
    ds_read_b128 v[76:79], v7 offset:192
    ds_read_b128 v[104:107], v7 offset:208
    ds_read_b128 v[80:83], v7 offset:256
    ds_read_b128 v[108:111], v7 offset:272
    ds_read_b128 v[84:87], v7 offset:320
    ds_read_b128 v[112:115], v7 offset:336
    ds_read_b128 v[88:91], v7 offset:384
    ds_read_b128 v[116:119], v7 offset:400
    v_mfma_f32_16x16x32_bf16 v[244:247], v[144:147], v[144:147], v[244:247]
    v_mfma_f32_16x16x32_bf16 v[248:251], v[148:151], v[148:151], v[248:251]
    v_mfma_f32_16x16x32_bf16 v[160:163], a[0:3], v[144:147], v[160:163]
    ds_read_b128 a[28:31], v2 offset:35840
    v_mfma_f32_16x16x32_bf16 v[188:191], a[0:3], v[148:151], v[188:191]
    s_mov_b64 exec, 0xffff
    buffer_store_dwordx4 v[224:227], v2, s[8:11], s25 offen offset:2048 sc1
    s_mov_b64 exec, -1
    s_mov_b32 s25, 0
    v_mfma_f32_16x16x32_bf16 v[164:167], a[4:7], v[144:147], v[164:167]
    ds_read_b128 a[32:35], v2 offset:36864
    v_mfma_f32_16x16x32_bf16 v[192:195], a[4:7], v[148:151], v[192:195]
    v_mfma_f32_16x16x32_bf16 v[168:171], a[8:11], v[144:147], v[168:171]
    ds_read_b128 a[36:39], v2 offset:37888
    v_mfma_f32_16x16x32_bf16 v[196:199], a[8:11], v[148:151], v[196:199]
    v_mfma_f32_16x16x32_bf16 v[172:175], a[12:15], v[144:147], v[172:175]
    ds_read_b128 a[40:43], v2 offset:38912
    v_mfma_f32_16x16x32_bf16 v[200:203], a[12:15], v[148:151], v[200:203]
    v_mfma_f32_16x16x32_bf16 v[176:179], a[16:19], v[144:147], v[176:179]
    ds_read_b128 a[44:47], v2 offset:39936
    v_mfma_f32_16x16x32_bf16 v[204:207], a[16:19], v[148:151], v[204:207]
    v_mfma_f32_16x16x32_bf16 v[180:183], a[20:23], v[144:147], v[180:183]
    ds_read_b128 a[48:51], v2 offset:40960
    v_mfma_f32_16x16x32_bf16 v[208:211], a[20:23], v[148:151], v[208:211]
    v_mfma_f32_16x16x32_bf16 v[184:187], a[24:27], v[144:147], v[184:187]
    ds_read_b128 a[52:55], v2 offset:41984
    v_mfma_f32_16x16x32_bf16 v[212:215], a[24:27], v[148:151], v[212:215]
    v_mfma_f32_16x16x32_bf16 v[244:247], v[152:155], v[152:155], v[244:247]
    v_mfma_f32_16x16x32_bf16 v[248:251], v[156:159], v[156:159], v[248:251]
    s_waitcnt lgkmcnt(6)
    v_mfma_f32_16x16x32_bf16 v[160:163], a[28:31], v[152:155], v[160:163]
    v_mfma_f32_16x16x32_bf16 v[188:191], a[28:31], v[156:159], v[188:191]
    s_waitcnt lgkmcnt(5)
    v_mfma_f32_16x16x32_bf16 v[164:167], a[32:35], v[152:155], v[164:167]
    v_mfma_f32_16x16x32_bf16 v[192:195], a[32:35], v[156:159], v[192:195]
    s_waitcnt lgkmcnt(4)
    v_mfma_f32_16x16x32_bf16 v[168:171], a[36:39], v[152:155], v[168:171]
    v_mfma_f32_16x16x32_bf16 v[196:199], a[36:39], v[156:159], v[196:199]
    s_waitcnt lgkmcnt(3)
    v_mfma_f32_16x16x32_bf16 v[172:175], a[40:43], v[152:155], v[172:175]
    v_mfma_f32_16x16x32_bf16 v[200:203], a[40:43], v[156:159], v[200:203]
    s_waitcnt lgkmcnt(2)
    v_mfma_f32_16x16x32_bf16 v[176:179], a[44:47], v[152:155], v[176:179]
    v_mfma_f32_16x16x32_bf16 v[204:207], a[44:47], v[156:159], v[204:207]
    s_waitcnt lgkmcnt(1)
    v_mfma_f32_16x16x32_bf16 v[180:183], a[48:51], v[152:155], v[180:183]
    v_mfma_f32_16x16x32_bf16 v[208:211], a[48:51], v[156:159], v[208:211]
    s_waitcnt lgkmcnt(0)
    v_mfma_f32_16x16x32_bf16 v[184:187], a[52:55], v[152:155], v[184:187]
    v_mfma_f32_16x16x32_bf16 v[212:215], a[52:55], v[156:159], v[212:215]
    s_nop 7
KF_POST:
    v_lshlrev_b32 v41, 8, v1
    s_cmp_eq_u32 s3, 0
    s_nop 3
    s_cbranch_scc0 KF_C3
    s_mov_b64 exec, 0xffff
    buffer_load_dword v40, v41, s[8:11], s24 offen sc1
    s_mov_b64 exec, -1
    s_cmp_eq_u32 s25, 0
    s_nop 0
    s_cbranch_scc1 KF_C4
    s_add_u32 s67, s64, 36864
    buffer_load_dwordx4 a[200:203], v2, s[8:11], s67 offen offset:0
    buffer_load_dwordx4 a[204:207], v2, s[8:11], s67 offen offset:1024
    buffer_load_dwordx4 a[208:211], v2, s[8:11], s67 offen offset:2048
    buffer_load_dwordx4 a[212:215], v2, s[8:11], s67 offen offset:3072
    s_add_u32 s67, s64, 40960
    buffer_load_dwordx4 a[216:219], v2, s[8:11], s67 offen offset:0
    buffer_load_dwordx4 a[220:223], v2, s[8:11], s67 offen offset:1024
    buffer_load_dwordx4 a[0:3], v2, s[8:11], s67 offen offset:2048
    buffer_load_dwordx4 a[4:7], v2, s[8:11], s67 offen offset:3072
    s_add_u32 s67, s64, 45056
    buffer_load_dwordx4 a[8:11], v2, s[8:11], s67 offen offset:0
    buffer_load_dwordx4 a[12:15], v2, s[8:11], s67 offen offset:1024
    buffer_load_dwordx4 a[16:19], v2, s[8:11], s67 offen offset:2048
    buffer_load_dwordx4 a[20:23], v2, s[8:11], s67 offen offset:3072
    s_add_u32 s67, s64, 49152
    buffer_load_dwordx4 a[24:27], v2, s[8:11], s67 offen offset:0
    buffer_load_dwordx4 a[28:31], v2, s[8:11], s67 offen offset:1024
    buffer_load_dwordx4 a[32:35], v2, s[8:11], s67 offen offset:2048
    buffer_load_dwordx4 a[36:39], v2, s[8:11], s67 offen offset:3072
    s_add_u32 s67, s64, 53248
    buffer_load_dwordx4 a[40:43], v2, s[8:11], s67 offen offset:0
    buffer_load_dwordx4 a[44:47], v2, s[8:11], s67 offen offset:1024
KF_C4:
KF_C3:
    v_cndmask_b32 v252, 0, v244, s[52:53]
    v_cndmask_b32 v252, v252, v245, s[54:55]
    v_cndmask_b32 v252, v252, v246, s[56:57]
    v_cndmask_b32 v252, v252, v247, s[58:59]
    v_cndmask_b32 v253, 0, v248, s[52:53]
    v_cndmask_b32 v253, v253, v249, s[54:55]
    v_cndmask_b32 v253, v253, v250, s[56:57]
    v_cndmask_b32 v253, v253, v251, s[58:59]
    v_permlane16_swap_b32 v187, v215
    v_permlane16_swap_b32 v160, v188
    v_permlane16_swap_b32 v252, v253
    v_permlane16_swap_b32 v161, v189
    v_permlane16_swap_b32 v162, v190
    v_add_f32 v254, v252, v253
    v_permlane16_swap_b32 v163, v191
    v_permlane16_swap_b32 v164, v192
    v_mov_b32 v255, v254
    v_permlane16_swap_b32 v165, v193
    v_permlane16_swap_b32 v166, v194
    v_mul_f32 v252, s32, v187
    v_permlane16_swap_b32 v167, v195
    v_permlane16_swap_b32 v168, v196
    v_permlane32_swap_b32 v254, v255
    v_permlane16_swap_b32 v169, v197
    v_permlane16_swap_b32 v170, v198
    v_mul_f32 v253, v252, v252
    v_permlane16_swap_b32 v171, v199
    v_permlane16_swap_b32 v172, v200
    v_add_f32 v254, v254, v255
    v_permlane16_swap_b32 v173, v201
    v_permlane16_swap_b32 v174, v202
    v_fma_f32 v254, v254, s32, -v253
    v_permlane16_swap_b32 v175, v203
    v_permlane16_swap_b32 v176, v204
    v_max_f32 v254, 0, v254
    v_permlane16_swap_b32 v177, v205
    v_permlane16_swap_b32 v178, v206
    v_add_f32 v254, s33, v254
    v_permlane16_swap_b32 v179, v207
    v_permlane16_swap_b32 v180, v208
    v_rsq_f32 v254, v254
    v_permlane16_swap_b32 v181, v209
    v_permlane16_swap_b32 v182, v210
    v_permlane16_swap_b32 v183, v211
    v_permlane16_swap_b32 v184, v212
    v_permlane16_swap_b32 v185, v213
    v_permlane16_swap_b32 v186, v214
    v_pk_fma_f32 v[188:189], v[92:93], v[252:253], v[188:189] op_sel_hi:[1,0,1] neg_lo:[0,1,0] neg_hi:[0,1,0]
    v_pk_fma_f32 v[190:191], v[94:95], v[252:253], v[190:191] op_sel_hi:[1,0,1] neg_lo:[0,1,0] neg_hi:[0,1,0]
    v_pk_fma_f32 v[192:193], v[96:97], v[252:253], v[192:193] op_sel_hi:[1,0,1] neg_lo:[0,1,0] neg_hi:[0,1,0]
    v_pk_fma_f32 v[194:195], v[98:99], v[252:253], v[194:195] op_sel_hi:[1,0,1] neg_lo:[0,1,0] neg_hi:[0,1,0]
    v_pk_fma_f32 v[196:197], v[100:101], v[252:253], v[196:197] op_sel_hi:[1,0,1] neg_lo:[0,1,0] neg_hi:[0,1,0]
    v_pk_fma_f32 v[198:199], v[102:103], v[252:253], v[198:199] op_sel_hi:[1,0,1] neg_lo:[0,1,0] neg_hi:[0,1,0]
    v_pk_fma_f32 v[200:201], v[104:105], v[252:253], v[200:201] op_sel_hi:[1,0,1] neg_lo:[0,1,0] neg_hi:[0,1,0]
    v_pk_fma_f32 v[202:203], v[106:107], v[252:253], v[202:203] op_sel_hi:[1,0,1] neg_lo:[0,1,0] neg_hi:[0,1,0]
    v_pk_fma_f32 v[204:205], v[108:109], v[252:253], v[204:205] op_sel_hi:[1,0,1] neg_lo:[0,1,0] neg_hi:[0,1,0]
    v_pk_fma_f32 v[206:207], v[110:111], v[252:253], v[206:207] op_sel_hi:[1,0,1] neg_lo:[0,1,0] neg_hi:[0,1,0]
    v_pk_fma_f32 v[208:209], v[112:113], v[252:253], v[208:209] op_sel_hi:[1,0,1] neg_lo:[0,1,0] neg_hi:[0,1,0]
    v_pk_fma_f32 v[210:211], v[114:115], v[252:253], v[210:211] op_sel_hi:[1,0,1] neg_lo:[0,1,0] neg_hi:[0,1,0]
    v_pk_fma_f32 v[212:213], v[116:117], v[252:253], v[212:213] op_sel_hi:[1,0,1] neg_lo:[0,1,0] neg_hi:[0,1,0]
    v_pk_fma_f32 v[214:215], v[118:119], v[252:253], v[214:215] op_sel_hi:[1,0,1] neg_lo:[0,1,0] neg_hi:[0,1,0]
    v_pk_fma_f32 v[178:179], v[82:83], v[252:253], v[178:179] op_sel_hi:[1,0,1] neg_lo:[0,1,0] neg_hi:[0,1,0]
    v_pk_fma_f32 v[180:181], v[84:85], v[252:253], v[180:181] op_sel_hi:[1,0,1] neg_lo:[0,1,0] neg_hi:[0,1,0]
    v_pk_fma_f32 v[182:183], v[86:87], v[252:253], v[182:183] op_sel_hi:[1,0,1] neg_lo:[0,1,0] neg_hi:[0,1,0]
    v_pk_fma_f32 v[184:185], v[88:89], v[252:253], v[184:185] op_sel_hi:[1,0,1] neg_lo:[0,1,0] neg_hi:[0,1,0]
    v_pk_fma_f32 v[186:187], v[90:91], v[252:253], v[186:187] op_sel_hi:[1,0,1] neg_lo:[0,1,0] neg_hi:[0,1,0]
    v_mul_f32 v158, s34, v254
    v_pk_mul_f32 v[178:179], v[178:179], v[254:255] op_sel_hi:[1,0]
    v_pk_mul_f32 v[206:207], v[206:207], v[254:255] op_sel_hi:[1,0]
    v_pk_mul_f32 v[180:181], v[180:181], v[254:255] op_sel_hi:[1,0]
    v_pk_mul_f32 v[208:209], v[208:209], v[254:255] op_sel_hi:[1,0]
    v_pk_mul_f32 v[182:183], v[182:183], v[254:255] op_sel_hi:[1,0]
    v_pk_mul_f32 v[210:211], v[210:211], v[254:255] op_sel_hi:[1,0]
    v_pk_mul_f32 v[184:185], v[184:185], v[254:255] op_sel_hi:[1,0]
    v_pk_mul_f32 v[212:213], v[212:213], v[254:255] op_sel_hi:[1,0]
    v_pk_mul_f32 v[186:187], v[186:187], v[254:255] op_sel_hi:[1,0]
    v_pk_mul_f32 v[214:215], v[214:215], v[254:255] op_sel_hi:[1,0]
    s_waitcnt vmcnt(10)
    v_cvt_pk_bf16_f32 v16, v178, v179
    v_cvt_pk_bf16_f32 v17, v180, v181
    v_cvt_pk_bf16_f32 v18, v182, v183
    v_cvt_pk_bf16_f32 v19, v184, v185
    s_waitcnt vmcnt(9)
    v_cvt_pk_bf16_f32 v20, v186, v206
    v_cvt_pk_bf16_f32 v21, v207, v208
    s_waitcnt vmcnt(8)
    v_cvt_pk_bf16_f32 v22, v209, v210
    v_cvt_pk_bf16_f32 v23, v211, v212
    v_cvt_pk_bf16_f32 v24, v213, v214
    v_mov_b32 v25, 0x3f80
    v_mov_b32 v223, 0
    v_mov_b32 v231, 0
    s_barrier
    ds_write_b128 v12, v[16:19]
    ds_write_b128 v12, v[20:23] offset:16
    ds_write_b64 v12, v[24:25] offset:32
    v_max3_f32 v148, v188, v189, v190
    v_min3_f32 v149, v188, v189, v190
    v_max3_f32 v148, v148, v191, v192
    v_min3_f32 v149, v149, v191, v192
    v_max3_f32 v148, v148, v193, v194
    v_min3_f32 v149, v149, v193, v194
    v_max3_f32 v148, v148, v195, v196
    v_min3_f32 v149, v149, v195, v196
    v_max3_f32 v148, v148, v197, v198
    v_min3_f32 v149, v149, v197, v198
    v_max3_f32 v148, v148, v199, v200
    v_min3_f32 v149, v149, v199, v200
    v_max3_f32 v148, v148, v201, v202
    v_min3_f32 v149, v149, v201, v202
    v_max3_f32 v148, v148, v203, v204
    v_min3_f32 v149, v149, v203, v204
    v_max_f32 v148, v148, v205
    v_min_f32 v149, v149, v205
    v_mul_f32 v150, v148, v158
    v_mul_f32 v152, v149, v158
    v_pk_fma_f32 v[112:113], v[188:189], v[158:159], v[150:151] op_sel_hi:[1,0,0] neg_lo:[0,0,1] neg_hi:[0,0,1]
    v_pk_fma_f32 v[130:131], v[188:189], v[158:159], v[152:153] op_sel_hi:[1,0,0] neg_lo:[1,0,0] neg_hi:[1,0,0]
    v_pk_fma_f32 v[114:115], v[190:191], v[158:159], v[150:151] op_sel_hi:[1,0,0] neg_lo:[0,0,1] neg_hi:[0,0,1]
    v_pk_fma_f32 v[132:133], v[190:191], v[158:159], v[152:153] op_sel_hi:[1,0,0] neg_lo:[1,0,0] neg_hi:[1,0,0]
    v_pk_fma_f32 v[116:117], v[192:193], v[158:159], v[150:151] op_sel_hi:[1,0,0] neg_lo:[0,0,1] neg_hi:[0,0,1]
    v_pk_fma_f32 v[134:135], v[192:193], v[158:159], v[152:153] op_sel_hi:[1,0,0] neg_lo:[1,0,0] neg_hi:[1,0,0]
    v_pk_fma_f32 v[118:119], v[194:195], v[158:159], v[150:151] op_sel_hi:[1,0,0] neg_lo:[0,0,1] neg_hi:[0,0,1]
    v_pk_fma_f32 v[136:137], v[194:195], v[158:159], v[152:153] op_sel_hi:[1,0,0] neg_lo:[1,0,0] neg_hi:[1,0,0]
    v_pk_fma_f32 v[120:121], v[196:197], v[158:159], v[150:151] op_sel_hi:[1,0,0] neg_lo:[0,0,1] neg_hi:[0,0,1]
    v_pk_fma_f32 v[138:139], v[196:197], v[158:159], v[152:153] op_sel_hi:[1,0,0] neg_lo:[1,0,0] neg_hi:[1,0,0]
    v_pk_fma_f32 v[122:123], v[198:199], v[158:159], v[150:151] op_sel_hi:[1,0,0] neg_lo:[0,0,1] neg_hi:[0,0,1]
    v_pk_fma_f32 v[140:141], v[198:199], v[158:159], v[152:153] op_sel_hi:[1,0,0] neg_lo:[1,0,0] neg_hi:[1,0,0]
    v_pk_fma_f32 v[124:125], v[200:201], v[158:159], v[150:151] op_sel_hi:[1,0,0] neg_lo:[0,0,1] neg_hi:[0,0,1]
    v_pk_fma_f32 v[142:143], v[200:201], v[158:159], v[152:153] op_sel_hi:[1,0,0] neg_lo:[1,0,0] neg_hi:[1,0,0]
    v_pk_fma_f32 v[126:127], v[202:203], v[158:159], v[150:151] op_sel_hi:[1,0,0] neg_lo:[0,0,1] neg_hi:[0,0,1]
    v_pk_fma_f32 v[144:145], v[202:203], v[158:159], v[152:153] op_sel_hi:[1,0,0] neg_lo:[1,0,0] neg_hi:[1,0,0]
    v_pk_fma_f32 v[128:129], v[204:205], v[158:159], v[150:151] op_sel_hi:[1,0,0] neg_lo:[0,0,1] neg_hi:[0,0,1]
    v_pk_fma_f32 v[146:147], v[204:205], v[158:159], v[152:153] op_sel_hi:[1,0,0] neg_lo:[1,0,0] neg_hi:[1,0,0]
    v_exp_f32 v112, v112
    v_exp_f32 v130, v130
    v_exp_f32 v113, v113
    v_exp_f32 v131, v131
    v_exp_f32 v114, v114
    v_exp_f32 v132, v132
    v_exp_f32 v115, v115
    v_exp_f32 v133, v133
    v_exp_f32 v116, v116
    v_exp_f32 v134, v134
    v_pk_add_f32 v[154:155], v[112:113], v[114:115]
    v_pk_add_f32 v[156:157], v[130:131], v[132:133]
    v_exp_f32 v117, v117
    v_exp_f32 v135, v135
    v_exp_f32 v118, v118
    v_exp_f32 v136, v136
    v_pk_add_f32 v[154:155], v[154:155], v[116:117]
    v_pk_add_f32 v[156:157], v[156:157], v[134:135]
    v_exp_f32 v119, v119
    v_exp_f32 v137, v137
    v_exp_f32 v120, v120
    v_exp_f32 v138, v138
    v_pk_add_f32 v[154:155], v[154:155], v[118:119]
    v_pk_add_f32 v[156:157], v[156:157], v[136:137]
    v_exp_f32 v121, v121
    v_exp_f32 v139, v139
    v_exp_f32 v122, v122
    v_exp_f32 v140, v140
    v_pk_add_f32 v[154:155], v[154:155], v[120:121]
    v_pk_add_f32 v[156:157], v[156:157], v[138:139]
    v_exp_f32 v123, v123
    v_exp_f32 v141, v141
    v_exp_f32 v124, v124
    v_exp_f32 v142, v142
    v_pk_add_f32 v[154:155], v[154:155], v[122:123]
    v_pk_add_f32 v[156:157], v[156:157], v[140:141]
    v_exp_f32 v125, v125
    v_exp_f32 v143, v143
    v_exp_f32 v126, v126
    v_exp_f32 v144, v144
    v_pk_add_f32 v[154:155], v[154:155], v[124:125]
    v_pk_add_f32 v[156:157], v[156:157], v[142:143]
    v_exp_f32 v127, v127
    v_exp_f32 v145, v145
    v_exp_f32 v128, v128
    v_exp_f32 v146, v146
    v_pk_add_f32 v[154:155], v[154:155], v[126:127]
    v_pk_add_f32 v[156:157], v[156:157], v[144:145]
    v_exp_f32 v129, v129
    v_exp_f32 v147, v147
    v_pk_add_f32 v[154:155], v[154:155], v[128:129]
    v_pk_add_f32 v[156:157], v[156:157], v[146:147]
    v_add_f32 v154, v154, v155
    v_add_f32 v156, v156, v157
    v_rcp_f32 v154, v154
    v_rcp_f32 v156, v156
    v_pk_mul_f32 v[112:113], v[112:113], v[154:155] op_sel_hi:[1,0]
    v_pk_mul_f32 v[130:131], v[130:131], v[156:157] op_sel_hi:[1,0]
    v_pk_mul_f32 v[114:115], v[114:115], v[154:155] op_sel_hi:[1,0]
    v_pk_mul_f32 v[132:133], v[132:133], v[156:157] op_sel_hi:[1,0]
    v_pk_mul_f32 v[116:117], v[116:117], v[154:155] op_sel_hi:[1,0]
    v_pk_mul_f32 v[134:135], v[134:135], v[156:157] op_sel_hi:[1,0]
    v_pk_mul_f32 v[118:119], v[118:119], v[154:155] op_sel_hi:[1,0]
    v_pk_mul_f32 v[136:137], v[136:137], v[156:157] op_sel_hi:[1,0]
    v_pk_mul_f32 v[120:121], v[120:121], v[154:155] op_sel_hi:[1,0]
    v_pk_mul_f32 v[138:139], v[138:139], v[156:157] op_sel_hi:[1,0]
    v_pk_mul_f32 v[122:123], v[122:123], v[154:155] op_sel_hi:[1,0]
    v_pk_mul_f32 v[140:141], v[140:141], v[156:157] op_sel_hi:[1,0]
    v_pk_mul_f32 v[124:125], v[124:125], v[154:155] op_sel_hi:[1,0]
    v_pk_mul_f32 v[142:143], v[142:143], v[156:157] op_sel_hi:[1,0]
    v_pk_mul_f32 v[126:127], v[126:127], v[154:155] op_sel_hi:[1,0]
    v_pk_mul_f32 v[144:145], v[144:145], v[156:157] op_sel_hi:[1,0]
    v_pk_mul_f32 v[128:129], v[128:129], v[154:155] op_sel_hi:[1,0]
    v_pk_mul_f32 v[146:147], v[146:147], v[156:157] op_sel_hi:[1,0]
    v_cvt_pk_bf16_f32 v216, v112, v113
    v_cvt_pk_bf16_f32 v226, v130, v131
    v_cvt_pk_bf16_f32 v217, v114, v115
    v_cvt_pk_bf16_f32 v227, v132, v133
    v_cvt_pk_bf16_f32 v218, v116, v117
    v_cvt_pk_bf16_f32 v228, v134, v135
    v_cvt_pk_bf16_f32 v219, v118, v119
    v_cvt_pk_bf16_f32 v229, v136, v137
    v_cvt_pk_bf16_f32 v220, v120, v121
    v_cvt_pk_bf16_f32 v230, v138, v139
    v_cvt_pk_bf16_f32 v221, v122, v123
    v_cvt_pk_bf16_f32 v232, v140, v141
    v_cvt_pk_bf16_f32 v222, v124, v125
    v_cvt_pk_bf16_f32 v233, v142, v143
    v_cvt_pk_bf16_f32 v224, v126, v127
    v_cvt_pk_bf16_f32 v234, v144, v145
    v_cvt_pk_bf16_f32 v225, v128, v129
    v_cvt_pk_bf16_f32 v235, v146, v147
    ds_write_b128 v11, v[216:219] offset:0
    ds_write_b128 v11, v[220:223] offset:16
    ds_write_b128 v11, v[224:227] offset:32
    ds_write_b128 v11, v[228:231] offset:48
    ds_write_b128 v11, v[232:235] offset:64
    s_cmp_eq_u32 s49, 0
    s_cselect_b32 s52, -1, 0xffff
    s_cselect_b32 s53, -1, 0
    s_and_b32 s54, s52, 0x40ff40ff
    s_and_b32 s55, s53, 0x40ff40ff
    s_and_b32 s23, s2, 15
    s_lshl_b32 s23, s23, 8
    s_add_u32 s23, s23, 15048704
    s_or_b32 s4, s3, s25
    s_cmp_eq_u32 s4, 0
    s_cselect_b32 s23, s23, 0x7ff00000
    v_mov_b32 v56, 1
    v_mov_b32 v57, 0
    s_waitcnt vmcnt(0)
    s_or_b32 s4, s3, s25
    s_cmp_eq_u32 s4, 0
    s_nop 1
    s_cbranch_scc0 KF_C5
    s_mov_b64 exec, 0xffff
    v_cmp_ne_u32 vcc, 10, v40
    s_mov_b64 exec, -1
    s_cmp_eq_u64 vcc, 0
    s_cbranch_scc1 KF_GP_GO
KF_GP:
    s_mov_b64 exec, 0xffff
    buffer_load_dword v40, v41, s[8:11], s24 offen sc1
    s_waitcnt vmcnt(0)
    v_cmp_ne_u32 vcc, 10, v40
    s_mov_b64 exec, -1
    s_sub_u32 s68, s68, 1
    s_cselect_b64 s[36:37], 0, vcc
    s_cselect_b32 s68, 0, s68
    s_cmp_eq_u64 s[36:37], 0
    s_cbranch_scc1 KF_GP_GO
    s_sleep 6
    s_branch KF_GP
KF_GP_GO:
KF_C5:
    s_waitcnt lgkmcnt(0)
    s_barrier
    s_mov_b64 exec, 1
    buffer_atomic_add v56, v57, s[8:11], s23 offen sc1
    s_mov_b64 exec, -1
    ds_read_b64_tr_b16 v[16:17], v238 offset:0
    ds_read_b64_tr_b16 v[18:19], v238 offset:192
    ds_read_b64_tr_b16 v[32:33], v239 offset:0
    ds_read_b64_tr_b16 v[34:35], v239 offset:320
    ds_read_b64_tr_b16 v[36:37], v239 offset:32
    ds_read_b64_tr_b16 v[38:39], v239 offset:352
    ds_read_b64_tr_b16 v[40:41], v239 offset:64
    ds_read_b64_tr_b16 v[42:43], v239 offset:384
    ds_read_b64_tr_b16 v[20:21], v238 offset:1536
    ds_read_b64_tr_b16 v[22:23], v238 offset:1728
    ds_read_b64_tr_b16 v[44:45], v239 offset:2560
    ds_read_b64_tr_b16 v[46:47], v239 offset:2880
    ds_read_b64_tr_b16 v[48:49], v239 offset:2592
    ds_read_b64_tr_b16 v[50:51], v239 offset:2912
    ds_read_b64_tr_b16 v[52:53], v239 offset:2624
    ds_read_b64_tr_b16 v[54:55], v239 offset:2944
    ds_read_b64_tr_b16 v[24:25], v238 offset:3072
    ds_read_b64_tr_b16 v[26:27], v238 offset:3264
    ds_read_b64_tr_b16 v[132:133], v239 offset:5120
    ds_read_b64_tr_b16 v[134:135], v239 offset:5440
    ds_read_b64_tr_b16 v[136:137], v239 offset:5152
    ds_read_b64_tr_b16 v[138:139], v239 offset:5472
    ds_read_b64_tr_b16 v[140:141], v239 offset:5184
    ds_read_b64_tr_b16 v[142:143], v239 offset:5504
    ds_read_b64_tr_b16 v[28:29], v238 offset:4608
    ds_read_b64_tr_b16 v[30:31], v238 offset:4800
    ds_read_b64_tr_b16 v[144:145], v239 offset:7680
    ds_read_b64_tr_b16 v[146:147], v239 offset:8000
    ds_read_b64_tr_b16 v[148:149], v239 offset:7712
    ds_read_b64_tr_b16 v[150:151], v239 offset:8032
    ds_read_b64_tr_b16 v[152:153], v239 offset:7744
    ds_read_b64_tr_b16 v[154:155], v239 offset:8064
    s_cmp_eq_u32 s71, 0
    s_nop 0
    s_cbranch_scc1 KF_C6
    v_lshrrev_b32 v58, 2, v1
    v_mul_u32_u24 v58, 36864, v58
    v_and_b32 v59, 3, v1
    v_lshl_add_u32 v58, v59, 4, v58
    s_add_u32 s4, s19, 16640
    s_lshl_b32 s5, s70, 6
    s_add_u32 s5, s5, 2785280
    s_add_u32 m0, s4, 0
    s_nop 0
    buffer_load_dwordx4 v58, s[8:11], s5 offen lds
    s_add_u32 s5, s5, 589824
    s_add_u32 m0, s4, 1024
    s_nop 0
    buffer_load_dwordx4 v58, s[8:11], s5 offen lds
    s_add_u32 s5, s5, 589824
    s_add_u32 m0, s4, 2048
    s_nop 0
    buffer_load_dwordx4 v58, s[8:11], s5 offen lds
    s_add_u32 s5, s5, 589824
    s_add_u32 m0, s4, 3072
    s_nop 0
    buffer_load_dwordx4 v58, s[8:11], s5 offen lds
KF_C6:
    v_pk_fma_f32 v[160:161], v[64:65], v[252:253], v[160:161] op_sel_hi:[1,0,1] neg_lo:[0,1,0] neg_hi:[0,1,0]
    v_pk_fma_f32 v[162:163], v[66:67], v[252:253], v[162:163] op_sel_hi:[1,0,1] neg_lo:[0,1,0] neg_hi:[0,1,0]
    v_pk_fma_f32 v[164:165], v[68:69], v[252:253], v[164:165] op_sel_hi:[1,0,1] neg_lo:[0,1,0] neg_hi:[0,1,0]
    v_pk_fma_f32 v[166:167], v[70:71], v[252:253], v[166:167] op_sel_hi:[1,0,1] neg_lo:[0,1,0] neg_hi:[0,1,0]
    v_pk_fma_f32 v[168:169], v[72:73], v[252:253], v[168:169] op_sel_hi:[1,0,1] neg_lo:[0,1,0] neg_hi:[0,1,0]
    v_pk_fma_f32 v[170:171], v[74:75], v[252:253], v[170:171] op_sel_hi:[1,0,1] neg_lo:[0,1,0] neg_hi:[0,1,0]
    v_pk_fma_f32 v[172:173], v[76:77], v[252:253], v[172:173] op_sel_hi:[1,0,1] neg_lo:[0,1,0] neg_hi:[0,1,0]
    v_pk_fma_f32 v[174:175], v[78:79], v[252:253], v[174:175] op_sel_hi:[1,0,1] neg_lo:[0,1,0] neg_hi:[0,1,0]
    v_pk_fma_f32 v[176:177], v[80:81], v[252:253], v[176:177] op_sel_hi:[1,0,1] neg_lo:[0,1,0] neg_hi:[0,1,0]
    v_mfma_f32_16x16x32_bf16 v[120:123], v[16:19], v[32:35], 0
    v_mfma_f32_16x16x32_bf16 v[124:127], v[16:19], v[36:39], 0
    v_mfma_f32_16x16x32_bf16 v[128:131], v[16:19], v[40:43], 0
    v_mfma_f32_16x16x32_bf16 v[120:123], v[20:23], v[44:47], v[120:123]
    v_mfma_f32_16x16x32_bf16 v[124:127], v[20:23], v[48:51], v[124:127]
    v_mfma_f32_16x16x32_bf16 v[128:131], v[20:23], v[52:55], v[128:131]
    s_waitcnt lgkmcnt(12)
    v_mfma_f32_16x16x32_bf16 v[120:123], v[24:27], v[132:135], v[120:123]
    s_waitcnt lgkmcnt(10)
    v_mfma_f32_16x16x32_bf16 v[124:127], v[24:27], v[136:139], v[124:127]
    s_waitcnt lgkmcnt(8)
    v_mfma_f32_16x16x32_bf16 v[128:131], v[24:27], v[140:143], v[128:131]
    s_waitcnt lgkmcnt(4)
    v_mfma_f32_16x16x32_bf16 v[120:123], v[28:31], v[144:147], v[120:123]
    s_waitcnt lgkmcnt(2)
    v_mfma_f32_16x16x32_bf16 v[124:127], v[28:31], v[148:151], v[124:127]
    s_waitcnt lgkmcnt(0)
    v_mfma_f32_16x16x32_bf16 v[128:131], v[28:31], v[152:155], v[128:131]
    v_max3_f32 v100, v160, v161, v162
    v_min3_f32 v101, v160, v161, v162
    v_max3_f32 v100, v100, v163, v164
    v_min3_f32 v101, v101, v163, v164
    s_mov_b32 exec_lo, 0x40004000
    s_mov_b32 exec_hi, 0x40004000
    v_mov_b32 v120, 1.0
    v_mov_b32 v121, 1.0
    v_mov_b32 v122, 1.0
    v_mov_b32 v123, 1.0
    v_mov_b32 v124, 1.0
    v_mov_b32 v125, 1.0
    v_mov_b32 v126, 1.0
    v_mov_b32 v127, 1.0
    v_mov_b32 v128, 1.0
    v_mov_b32 v129, 1.0
    v_mov_b32 v130, 1.0
    v_mov_b32 v131, 1.0
    s_mov_b64 exec, s[52:53]
    buffer_atomic_add_f32 v120, v240, s[8:11], s51 offen offset:0
    buffer_atomic_add_f32 v121, v240, s[8:11], s51 offen offset:192
    buffer_atomic_add_f32 v122, v240, s[8:11], s51 offen offset:384
    buffer_atomic_add_f32 v123, v240, s[8:11], s51 offen offset:576
    buffer_atomic_add_f32 v124, v240, s[8:11], s51 offen offset:64
    buffer_atomic_add_f32 v125, v240, s[8:11], s51 offen offset:256
    buffer_atomic_add_f32 v126, v240, s[8:11], s51 offen offset:448
    buffer_atomic_add_f32 v127, v240, s[8:11], s51 offen offset:640
    s_mov_b64 exec, s[54:55]
    buffer_atomic_add_f32 v128, v240, s[8:11], s51 offen offset:128
    buffer_atomic_add_f32 v129, v240, s[8:11], s51 offen offset:320
    buffer_atomic_add_f32 v130, v240, s[8:11], s51 offen offset:512
    buffer_atomic_add_f32 v131, v240, s[8:11], s51 offen offset:704
    s_mov_b64 exec, -1
    v_max3_f32 v100, v100, v165, v166
    v_min3_f32 v101, v101, v165, v166
    v_max3_f32 v100, v100, v167, v168
    v_min3_f32 v101, v101, v167, v168
    v_max3_f32 v100, v100, v169, v170
    v_min3_f32 v101, v101, v169, v170
    v_max3_f32 v100, v100, v171, v172
    v_min3_f32 v101, v101, v171, v172
    v_max3_f32 v100, v100, v173, v174
    v_min3_f32 v101, v101, v173, v174
    v_max3_f32 v100, v100, v175, v176
    v_min3_f32 v101, v101, v175, v176
    v_max_f32 v100, v100, v177
    v_min_f32 v101, v101, v177
    v_mul_f32 v102, v100, v158
    v_mul_f32 v104, v101, v158
    v_pk_fma_f32 v[64:65], v[160:161], v[158:159], v[102:103] op_sel_hi:[1,0,0] neg_lo:[0,0,1] neg_hi:[0,0,1]
    v_pk_fma_f32 v[82:83], v[160:161], v[158:159], v[104:105] op_sel_hi:[1,0,0] neg_lo:[1,0,0] neg_hi:[1,0,0]
    v_pk_fma_f32 v[66:67], v[162:163], v[158:159], v[102:103] op_sel_hi:[1,0,0] neg_lo:[0,0,1] neg_hi:[0,0,1]
    v_pk_fma_f32 v[84:85], v[162:163], v[158:159], v[104:105] op_sel_hi:[1,0,0] neg_lo:[1,0,0] neg_hi:[1,0,0]
    v_pk_fma_f32 v[68:69], v[164:165], v[158:159], v[102:103] op_sel_hi:[1,0,0] neg_lo:[0,0,1] neg_hi:[0,0,1]
    v_pk_fma_f32 v[86:87], v[164:165], v[158:159], v[104:105] op_sel_hi:[1,0,0] neg_lo:[1,0,0] neg_hi:[1,0,0]
    v_pk_fma_f32 v[70:71], v[166:167], v[158:159], v[102:103] op_sel_hi:[1,0,0] neg_lo:[0,0,1] neg_hi:[0,0,1]
    v_pk_fma_f32 v[88:89], v[166:167], v[158:159], v[104:105] op_sel_hi:[1,0,0] neg_lo:[1,0,0] neg_hi:[1,0,0]
    v_pk_fma_f32 v[72:73], v[168:169], v[158:159], v[102:103] op_sel_hi:[1,0,0] neg_lo:[0,0,1] neg_hi:[0,0,1]
    v_pk_fma_f32 v[90:91], v[168:169], v[158:159], v[104:105] op_sel_hi:[1,0,0] neg_lo:[1,0,0] neg_hi:[1,0,0]
    v_pk_fma_f32 v[74:75], v[170:171], v[158:159], v[102:103] op_sel_hi:[1,0,0] neg_lo:[0,0,1] neg_hi:[0,0,1]
    v_pk_fma_f32 v[92:93], v[170:171], v[158:159], v[104:105] op_sel_hi:[1,0,0] neg_lo:[1,0,0] neg_hi:[1,0,0]
    v_pk_fma_f32 v[76:77], v[172:173], v[158:159], v[102:103] op_sel_hi:[1,0,0] neg_lo:[0,0,1] neg_hi:[0,0,1]
    v_pk_fma_f32 v[94:95], v[172:173], v[158:159], v[104:105] op_sel_hi:[1,0,0] neg_lo:[1,0,0] neg_hi:[1,0,0]
    v_pk_fma_f32 v[78:79], v[174:175], v[158:159], v[102:103] op_sel_hi:[1,0,0] neg_lo:[0,0,1] neg_hi:[0,0,1]
    v_pk_fma_f32 v[96:97], v[174:175], v[158:159], v[104:105] op_sel_hi:[1,0,0] neg_lo:[1,0,0] neg_hi:[1,0,0]
    v_pk_fma_f32 v[80:81], v[176:177], v[158:159], v[102:103] op_sel_hi:[1,0,0] neg_lo:[0,0,1] neg_hi:[0,0,1]
    v_pk_fma_f32 v[98:99], v[176:177], v[158:159], v[104:105] op_sel_hi:[1,0,0] neg_lo:[1,0,0] neg_hi:[1,0,0]
    v_exp_f32 v64, v64
    v_exp_f32 v82, v82
    s_cmp_eq_u32 s25, 0
    s_nop 3
    s_cbranch_scc0 KF_C7
    v_mov_b32 v16, -1
    v_mov_b32 v17, -1
    v_mov_b32 v18, -1
    v_mov_b32 v19, -1
    s_lshl_b32 s6, s20, 4
    s_add_u32 s6, s6, s21
    s_lshl_b32 s6, s6, 2
    s_add_u32 s6, s6, s3
    s_mul_i32 s6, s6, 2304
    s_add_u32 s6, s6, 7503872
    buffer_store_dwordx4 v[16:19], v2, s[8:11], s6 offen offset:0 sc1
    buffer_store_dwordx4 v[16:19], v2, s[8:11], s6 offen offset:1024 sc1
    s_mov_b64 exec, 0xffff
    buffer_store_dwordx4 v[16:19], v2, s[8:11], s6 offen offset:2048 sc1
    s_mov_b64 exec, -1
    s_nop 0
KF_C7:
    v_exp_f32 v65, v65
    v_exp_f32 v83, v83
    v_exp_f32 v66, v66
    v_exp_f32 v84, v84
    v_exp_f32 v67, v67
    v_exp_f32 v85, v85
    v_exp_f32 v68, v68
    v_exp_f32 v86, v86
    v_pk_add_f32 v[106:107], v[64:65], v[66:67]
    v_pk_add_f32 v[108:109], v[82:83], v[84:85]
    v_exp_f32 v69, v69
    v_exp_f32 v87, v87
    v_exp_f32 v70, v70
    v_exp_f32 v88, v88
    v_pk_add_f32 v[106:107], v[106:107], v[68:69]
    v_pk_add_f32 v[108:109], v[108:109], v[86:87]
    v_exp_f32 v71, v71
    v_exp_f32 v89, v89
    v_exp_f32 v72, v72
    v_exp_f32 v90, v90
    v_pk_add_f32 v[106:107], v[106:107], v[70:71]
    v_pk_add_f32 v[108:109], v[108:109], v[88:89]
    v_exp_f32 v73, v73
    v_exp_f32 v91, v91
    v_exp_f32 v74, v74
    v_exp_f32 v92, v92
    v_pk_add_f32 v[106:107], v[106:107], v[72:73]
    v_pk_add_f32 v[108:109], v[108:109], v[90:91]
    v_exp_f32 v75, v75
    v_exp_f32 v93, v93
    v_exp_f32 v76, v76
    v_exp_f32 v94, v94
    v_pk_add_f32 v[106:107], v[106:107], v[74:75]
    v_pk_add_f32 v[108:109], v[108:109], v[92:93]
    v_exp_f32 v77, v77
    v_exp_f32 v95, v95
    v_exp_f32 v78, v78
    v_exp_f32 v96, v96
    v_pk_add_f32 v[106:107], v[106:107], v[76:77]
    v_pk_add_f32 v[108:109], v[108:109], v[94:95]
    v_exp_f32 v79, v79
    v_exp_f32 v97, v97
    v_exp_f32 v80, v80
    v_exp_f32 v98, v98
    v_pk_add_f32 v[106:107], v[106:107], v[78:79]
    v_pk_add_f32 v[108:109], v[108:109], v[96:97]
    v_exp_f32 v81, v81
    v_exp_f32 v99, v99
    v_pk_add_f32 v[106:107], v[106:107], v[80:81]
    v_pk_add_f32 v[108:109], v[108:109], v[98:99]
    v_add_f32 v106, v106, v107
    v_add_f32 v108, v108, v109
    v_rcp_f32 v106, v106
    v_rcp_f32 v108, v108
    v_pk_mul_f32 v[64:65], v[64:65], v[106:107] op_sel_hi:[1,0]
    v_pk_mul_f32 v[82:83], v[82:83], v[108:109] op_sel_hi:[1,0]
    v_pk_mul_f32 v[66:67], v[66:67], v[106:107] op_sel_hi:[1,0]
    v_pk_mul_f32 v[84:85], v[84:85], v[108:109] op_sel_hi:[1,0]
    v_pk_mul_f32 v[68:69], v[68:69], v[106:107] op_sel_hi:[1,0]
    v_pk_mul_f32 v[86:87], v[86:87], v[108:109] op_sel_hi:[1,0]
    v_pk_mul_f32 v[70:71], v[70:71], v[106:107] op_sel_hi:[1,0]
    v_pk_mul_f32 v[88:89], v[88:89], v[108:109] op_sel_hi:[1,0]
    v_pk_mul_f32 v[72:73], v[72:73], v[106:107] op_sel_hi:[1,0]
    v_pk_mul_f32 v[90:91], v[90:91], v[108:109] op_sel_hi:[1,0]
    v_pk_mul_f32 v[74:75], v[74:75], v[106:107] op_sel_hi:[1,0]
    v_pk_mul_f32 v[92:93], v[92:93], v[108:109] op_sel_hi:[1,0]
    v_pk_mul_f32 v[76:77], v[76:77], v[106:107] op_sel_hi:[1,0]
    v_pk_mul_f32 v[94:95], v[94:95], v[108:109] op_sel_hi:[1,0]
    v_pk_mul_f32 v[78:79], v[78:79], v[106:107] op_sel_hi:[1,0]
    v_pk_mul_f32 v[96:97], v[96:97], v[108:109] op_sel_hi:[1,0]
    v_pk_mul_f32 v[80:81], v[80:81], v[106:107] op_sel_hi:[1,0]
    v_pk_mul_f32 v[98:99], v[98:99], v[108:109] op_sel_hi:[1,0]
    v_cvt_pk_bf16_f32 v216, v64, v65
    v_cvt_pk_bf16_f32 v226, v82, v83
    v_cvt_pk_bf16_f32 v217, v66, v67
    v_cvt_pk_bf16_f32 v227, v84, v85
    v_cvt_pk_bf16_f32 v218, v68, v69
    v_cvt_pk_bf16_f32 v228, v86, v87
    v_cvt_pk_bf16_f32 v219, v70, v71
    v_cvt_pk_bf16_f32 v229, v88, v89
    v_cvt_pk_bf16_f32 v220, v72, v73
    v_cvt_pk_bf16_f32 v230, v90, v91
    v_cvt_pk_bf16_f32 v221, v74, v75
    v_cvt_pk_bf16_f32 v232, v92, v93
    v_cvt_pk_bf16_f32 v222, v76, v77
    v_cvt_pk_bf16_f32 v233, v94, v95
    v_cvt_pk_bf16_f32 v224, v78, v79
    v_cvt_pk_bf16_f32 v234, v96, v97
    v_cvt_pk_bf16_f32 v225, v80, v81
    v_cvt_pk_bf16_f32 v235, v98, v99
    s_mov_b32 s56, 0x88888888
    s_mov_b32 s57, 0x88888888
    s_cmp_eq_u32 s25, 0
    s_nop 1
    s_cbranch_scc0 KF_KVA
    s_cmp_eq_u32 s3, 0
    s_cbranch_scc1 KF_KVB
    s_cmp_eq_u32 s71, 0
    s_cbranch_scc1 KF_KVC
    s_waitcnt vmcnt(15)
    v_add_u32 v150, 1, v3
    v_and_b32 v151, 3, v150
    v_and_b32 v150, 0x1c, v150
    v_lshl_add_u32 v150, v4, 3, v150
    v_lshlrev_b32 v150, 1, v150
    v_mul_u32_u24 v151, 4160, v151
    v_add3_u32 v150, v150, v151, s19
    v_lshlrev_b32 v152, 5, v3
    v_lshlrev_b32 v151, 4, v4
    v_sub_u32 v151, v151, v152
    s_add_u32 s4, s19, 17120
    v_add_u32 v151, s4, v151
    ds_read_b64 v[16:17], v150 offset:0
    ds_read_b64 v[18:19], v150 offset:8
    ds_read_b128 v[48:51], v151 offset:3584
    ds_read_b64 v[20:21], v150 offset:512
    ds_read_b64 v[22:23], v150 offset:520
    ds_read_b128 v[52:55], v151 offset:3072
    ds_read_b64 v[24:25], v150 offset:1024
    ds_read_b64 v[26:27], v150 offset:1032
    ds_read_b128 v[56:59], v151 offset:2560
    ds_read_b64 v[28:29], v150 offset:1536
    ds_read_b64 v[30:31], v150 offset:1544
    ds_read_b128 v[60:63], v151 offset:2048
    ds_read_b64 v[32:33], v150 offset:2048
    ds_read_b64 v[34:35], v150 offset:2056
    ds_read_b128 v[64:67], v151 offset:1536
    ds_read_b64 v[36:37], v150 offset:2560
    ds_read_b64 v[38:39], v150 offset:2568
    ds_read_b128 v[68:71], v151 offset:1024
    ds_read_b64 v[40:41], v150 offset:3072
    ds_read_b64 v[42:43], v150 offset:3080
    ds_read_b128 v[72:75], v151 offset:512
    ds_read_b64 v[44:45], v150 offset:3584
    ds_read_b64 v[46:47], v150 offset:3592
    ds_read_b128 v[76:79], v151 offset:0
    v_mfma_f32_16x16x32_bf16 a[224:227], v[16:19], v[48:51], 0
    v_mfma_f32_16x16x32_bf16 a[228:231], v[16:19], v[52:55], 0
    v_mfma_f32_16x16x32_bf16 a[228:231], v[20:23], v[48:51], a[228:231]
    v_mfma_f32_16x16x32_bf16 a[232:235], v[20:23], v[52:55], 0
    v_mfma_f32_16x16x32_bf16 a[232:235], v[16:19], v[56:59], a[232:235]
    s_add_u32 s65, s64, 0
    buffer_load_dwordx4 a[56:59], v2, s[8:11], s65 offen offset:0
    v_mfma_f32_16x16x32_bf16 a[236:239], v[20:23], v[56:59], 0
    v_mfma_f32_16x16x32_bf16 a[232:235], v[24:27], v[48:51], a[232:235]
    v_mfma_f32_16x16x32_bf16 a[236:239], v[24:27], v[52:55], a[236:239]
    v_mfma_f32_16x16x32_bf16 a[240:243], v[24:27], v[56:59], 0
    ds_read_b64 v[80:81], v150 offset:64
    s_add_u32 s66, s64, 18432
    buffer_load_dwordx4 a[128:131], v2, s[8:11], s66 offen offset:0
    s_waitcnt lgkmcnt(13)
    v_mfma_f32_16x16x32_bf16 a[236:239], v[16:19], v[60:63], a[236:239]
    ds_read_b64 v[82:83], v150 offset:72
    v_mfma_f32_16x16x32_bf16 a[240:243], v[20:23], v[60:63], a[240:243]
    ds_read_b128 v[112:115], v151 offset:3648
    v_mfma_f32_16x16x32_bf16 a[244:247], v[24:27], v[60:63], 0
    ds_read_b64 v[84:85], v150 offset:576
    v_mfma_f32_16x16x32_bf16 a[236:239], v[28:31], v[48:51], a[236:239]
    ds_read_b64 v[86:87], v150 offset:584
    buffer_load_dwordx4 a[60:63], v2, s[8:11], s65 offen offset:1024
    v_mfma_f32_16x16x32_bf16 a[240:243], v[28:31], v[52:55], a[240:243]
    ds_read_b128 v[116:119], v151 offset:3136
    v_mfma_f32_16x16x32_bf16 a[244:247], v[28:31], v[56:59], a[244:247]
    ds_read_b64 v[88:89], v150 offset:1088
    v_mfma_f32_16x16x32_bf16 a[248:251], v[28:31], v[60:63], 0
    ds_read_b64 v[90:91], v150 offset:1096
    v_mfma_f32_16x16x32_bf16 a[240:243], v[16:19], v[64:67], a[240:243]
    ds_read_b128 v[120:123], v151 offset:2624
    buffer_load_dwordx4 a[132:135], v2, s[8:11], s66 offen offset:1024
    v_mfma_f32_16x16x32_bf16 a[244:247], v[20:23], v[64:67], a[244:247]
    ds_read_b64 v[92:93], v150 offset:1600
    v_mfma_f32_16x16x32_bf16 a[248:251], v[24:27], v[64:67], a[248:251]
    ds_read_b64 v[94:95], v150 offset:1608
    v_mfma_f32_16x16x32_bf16 a[252:255], v[28:31], v[64:67], 0
    ds_read_b128 v[124:127], v151 offset:2112
    v_mfma_f32_16x16x32_bf16 a[240:243], v[32:35], v[48:51], a[240:243]
    ds_read_b64 v[96:97], v150 offset:2112
    buffer_load_dwordx4 a[64:67], v2, s[8:11], s65 offen offset:2048
    v_mfma_f32_16x16x32_bf16 a[244:247], v[32:35], v[52:55], a[244:247]
    ds_read_b64 v[98:99], v150 offset:2120
    v_mfma_f32_16x16x32_bf16 a[248:251], v[32:35], v[56:59], a[248:251]
    ds_read_b128 v[128:131], v151 offset:1600
    v_mfma_f32_16x16x32_bf16 a[252:255], v[32:35], v[60:63], a[252:255]
    ds_read_b64 v[100:101], v150 offset:2624
    v_mfma_f32_16x16x32_bf16 a[244:247], v[16:19], v[68:71], a[244:247]
    ds_read_b64 v[102:103], v150 offset:2632
    buffer_load_dwordx4 a[136:139], v2, s[8:11], s66 offen offset:2048
    v_mfma_f32_16x16x32_bf16 a[248:251], v[20:23], v[68:71], a[248:251]
    ds_read_b128 v[132:135], v151 offset:1088
    v_mfma_f32_16x16x32_bf16 a[252:255], v[24:27], v[68:71], a[252:255]
    ds_read_b64 v[104:105], v150 offset:3136
    v_mfma_f32_16x16x32_bf16 a[244:247], v[36:39], v[48:51], a[244:247]
    ds_read_b64 v[106:107], v150 offset:3144
    v_mfma_f32_16x16x32_bf16 a[248:251], v[36:39], v[52:55], a[248:251]
    ds_read_b128 v[136:139], v151 offset:576
    buffer_load_dwordx4 a[68:71], v2, s[8:11], s65 offen offset:3072
    v_mfma_f32_16x16x32_bf16 a[252:255], v[36:39], v[56:59], a[252:255]
    ds_read_b64 v[108:109], v150 offset:3648
    v_mfma_f32_16x16x32_bf16 a[248:251], v[16:19], v[72:75], a[248:251]
    ds_read_b64 v[110:111], v150 offset:3656
    v_mfma_f32_16x16x32_bf16 a[252:255], v[20:23], v[72:75], a[252:255]
    ds_read_b128 v[140:143], v151 offset:64
    v_mfma_f32_16x16x32_bf16 a[248:251], v[40:43], v[48:51], a[248:251]
    buffer_load_dwordx4 a[140:143], v2, s[8:11], s66 offen offset:3072
    v_mfma_f32_16x16x32_bf16 a[252:255], v[40:43], v[52:55], a[252:255]
    v_mfma_f32_16x16x32_bf16 a[252:255], v[16:19], v[76:79], a[252:255]
    v_mfma_f32_16x16x32_bf16 a[252:255], v[44:47], v[48:51], a[252:255]
    v_mfma_f32_16x16x32_bf16 a[224:227], v[80:83], v[112:115], a[224:227]
    s_add_u32 s65, s64, 4096
    buffer_load_dwordx4 a[72:75], v2, s[8:11], s65 offen offset:0
    v_mfma_f32_16x16x32_bf16 a[228:231], v[80:83], v[116:119], a[228:231]
    v_mfma_f32_16x16x32_bf16 a[228:231], v[84:87], v[112:115], a[228:231]
    v_mfma_f32_16x16x32_bf16 a[232:235], v[84:87], v[116:119], a[232:235]
    v_mfma_f32_16x16x32_bf16 a[232:235], v[80:83], v[120:123], a[232:235]
    s_add_u32 s66, s64, 22528
    buffer_load_dwordx4 a[144:147], v2, s[8:11], s66 offen offset:0
    v_mfma_f32_16x16x32_bf16 a[236:239], v[84:87], v[120:123], a[236:239]
    v_mfma_f32_16x16x32_bf16 a[232:235], v[88:91], v[112:115], a[232:235]
    v_mfma_f32_16x16x32_bf16 a[236:239], v[88:91], v[116:119], a[236:239]
    v_mfma_f32_16x16x32_bf16 a[240:243], v[88:91], v[120:123], a[240:243]
    ds_read_b64 v[16:17], v150 offset:128
    buffer_load_dwordx4 a[76:79], v2, s[8:11], s65 offen offset:1024
    s_waitcnt lgkmcnt(13)
    v_mfma_f32_16x16x32_bf16 a[236:239], v[80:83], v[124:127], a[236:239]
    ds_read_b64 v[18:19], v150 offset:136
    v_mfma_f32_16x16x32_bf16 a[240:243], v[84:87], v[124:127], a[240:243]
    ds_read_b128 v[48:51], v151 offset:3712
    v_mfma_f32_16x16x32_bf16 a[244:247], v[88:91], v[124:127], a[244:247]
    ds_read_b64 v[20:21], v150 offset:640
    v_mfma_f32_16x16x32_bf16 a[236:239], v[92:95], v[112:115], a[236:239]
    ds_read_b64 v[22:23], v150 offset:648
    buffer_load_dwordx4 a[148:151], v2, s[8:11], s66 offen offset:1024
    v_mfma_f32_16x16x32_bf16 a[240:243], v[92:95], v[116:119], a[240:243]
    ds_read_b128 v[52:55], v151 offset:3200
    v_mfma_f32_16x16x32_bf16 a[244:247], v[92:95], v[120:123], a[244:247]
    ds_read_b64 v[24:25], v150 offset:1152
    v_mfma_f32_16x16x32_bf16 a[248:251], v[92:95], v[124:127], a[248:251]
    ds_read_b64 v[26:27], v150 offset:1160
    v_mfma_f32_16x16x32_bf16 a[240:243], v[80:83], v[128:131], a[240:243]
    ds_read_b128 v[56:59], v151 offset:2688
    buffer_load_dwordx4 a[80:83], v2, s[8:11], s65 offen offset:2048
    v_mfma_f32_16x16x32_bf16 a[244:247], v[84:87], v[128:131], a[244:247]
    ds_read_b64 v[28:29], v150 offset:1664
    v_mfma_f32_16x16x32_bf16 a[248:251], v[88:91], v[128:131], a[248:251]
    ds_read_b64 v[30:31], v150 offset:1672
    v_mfma_f32_16x16x32_bf16 a[252:255], v[92:95], v[128:131], a[252:255]
    ds_read_b128 v[60:63], v151 offset:2176
    v_mfma_f32_16x16x32_bf16 a[240:243], v[96:99], v[112:115], a[240:243]
    ds_read_b64 v[32:33], v150 offset:2176
    buffer_load_dwordx4 a[152:155], v2, s[8:11], s66 offen offset:2048
    v_mfma_f32_16x16x32_bf16 a[244:247], v[96:99], v[116:119], a[244:247]
    ds_read_b64 v[34:35], v150 offset:2184
    v_mfma_f32_16x16x32_bf16 a[248:251], v[96:99], v[120:123], a[248:251]
    ds_read_b128 v[64:67], v151 offset:1664
    v_mfma_f32_16x16x32_bf16 a[252:255], v[96:99], v[124:127], a[252:255]
    ds_read_b64 v[36:37], v150 offset:2688
    v_mfma_f32_16x16x32_bf16 a[244:247], v[80:83], v[132:135], a[244:247]
    ds_read_b64 v[38:39], v150 offset:2696
    buffer_load_dwordx4 a[84:87], v2, s[8:11], s65 offen offset:3072
    v_mfma_f32_16x16x32_bf16 a[248:251], v[84:87], v[132:135], a[248:251]
    ds_read_b128 v[68:71], v151 offset:1152
    v_mfma_f32_16x16x32_bf16 a[252:255], v[88:91], v[132:135], a[252:255]
    ds_read_b64 v[40:41], v150 offset:3200
    v_mfma_f32_16x16x32_bf16 a[244:247], v[100:103], v[112:115], a[244:247]
    ds_read_b64 v[42:43], v150 offset:3208
    v_mfma_f32_16x16x32_bf16 a[248:251], v[100:103], v[116:119], a[248:251]
    ds_read_b128 v[72:75], v151 offset:640
    buffer_load_dwordx4 a[156:159], v2, s[8:11], s66 offen offset:3072
    v_mfma_f32_16x16x32_bf16 a[252:255], v[100:103], v[120:123], a[252:255]
    ds_read_b64 v[44:45], v150 offset:3712
    v_mfma_f32_16x16x32_bf16 a[248:251], v[80:83], v[136:139], a[248:251]
    ds_read_b64 v[46:47], v150 offset:3720
    v_mfma_f32_16x16x32_bf16 a[252:255], v[84:87], v[136:139], a[252:255]
    ds_read_b128 v[76:79], v151 offset:128
    v_mfma_f32_16x16x32_bf16 a[248:251], v[104:107], v[112:115], a[248:251]
    s_add_u32 s65, s64, 8192
    buffer_load_dwordx4 a[88:91], v2, s[8:11], s65 offen offset:0
    v_mfma_f32_16x16x32_bf16 a[252:255], v[104:107], v[116:119], a[252:255]
    v_mfma_f32_16x16x32_bf16 a[252:255], v[80:83], v[140:143], a[252:255]
    v_mfma_f32_16x16x32_bf16 a[252:255], v[108:111], v[112:115], a[252:255]
    v_mfma_f32_16x16x32_bf16 a[224:227], v[16:19], v[48:51], a[224:227]
    s_add_u32 s66, s64, 26624
    buffer_load_dwordx4 a[160:163], v2, s[8:11], s66 offen offset:0
    v_mfma_f32_16x16x32_bf16 a[228:231], v[16:19], v[52:55], a[228:231]
    v_mfma_f32_16x16x32_bf16 a[228:231], v[20:23], v[48:51], a[228:231]
    v_mfma_f32_16x16x32_bf16 a[232:235], v[20:23], v[52:55], a[232:235]
    v_mfma_f32_16x16x32_bf16 a[232:235], v[16:19], v[56:59], a[232:235]
    buffer_load_dwordx4 a[92:95], v2, s[8:11], s65 offen offset:1024
    v_mfma_f32_16x16x32_bf16 a[236:239], v[20:23], v[56:59], a[236:239]
    v_mfma_f32_16x16x32_bf16 a[232:235], v[24:27], v[48:51], a[232:235]
    v_mfma_f32_16x16x32_bf16 a[236:239], v[24:27], v[52:55], a[236:239]
    v_mfma_f32_16x16x32_bf16 a[240:243], v[24:27], v[56:59], a[240:243]
    ds_read_b64 v[80:81], v150 offset:192
    buffer_load_dwordx4 a[164:167], v2, s[8:11], s66 offen offset:1024
    s_waitcnt lgkmcnt(13)
    v_mfma_f32_16x16x32_bf16 a[236:239], v[16:19], v[60:63], a[236:239]
    ds_read_b64 v[82:83], v150 offset:200
    v_mfma_f32_16x16x32_bf16 a[240:243], v[20:23], v[60:63], a[240:243]
    ds_read_b128 v[112:115], v151 offset:3776
    v_mfma_f32_16x16x32_bf16 a[244:247], v[24:27], v[60:63], a[244:247]
    ds_read_b64 v[84:85], v150 offset:704
    v_mfma_f32_16x16x32_bf16 a[236:239], v[28:31], v[48:51], a[236:239]
    ds_read_b64 v[86:87], v150 offset:712
    buffer_load_dwordx4 a[96:99], v2, s[8:11], s65 offen offset:2048
    v_mfma_f32_16x16x32_bf16 a[240:243], v[28:31], v[52:55], a[240:243]
    ds_read_b128 v[116:119], v151 offset:3264
    v_mfma_f32_16x16x32_bf16 a[244:247], v[28:31], v[56:59], a[244:247]
    ds_read_b64 v[88:89], v150 offset:1216
    v_mfma_f32_16x16x32_bf16 a[248:251], v[28:31], v[60:63], a[248:251]
    ds_read_b64 v[90:91], v150 offset:1224
    v_mfma_f32_16x16x32_bf16 a[240:243], v[16:19], v[64:67], a[240:243]
    ds_read_b128 v[120:123], v151 offset:2752
    buffer_load_dwordx4 a[168:171], v2, s[8:11], s66 offen offset:2048
    v_mfma_f32_16x16x32_bf16 a[244:247], v[20:23], v[64:67], a[244:247]
    ds_read_b64 v[92:93], v150 offset:1728
    v_mfma_f32_16x16x32_bf16 a[248:251], v[24:27], v[64:67], a[248:251]
    ds_read_b64 v[94:95], v150 offset:1736
    v_mfma_f32_16x16x32_bf16 a[252:255], v[28:31], v[64:67], a[252:255]
    ds_read_b128 v[124:127], v151 offset:2240
    v_mfma_f32_16x16x32_bf16 a[240:243], v[32:35], v[48:51], a[240:243]
    ds_read_b64 v[96:97], v150 offset:2240
    buffer_load_dwordx4 a[100:103], v2, s[8:11], s65 offen offset:3072
    v_mfma_f32_16x16x32_bf16 a[244:247], v[32:35], v[52:55], a[244:247]
    ds_read_b64 v[98:99], v150 offset:2248
    v_mfma_f32_16x16x32_bf16 a[248:251], v[32:35], v[56:59], a[248:251]
    ds_read_b128 v[128:131], v151 offset:1728
    v_mfma_f32_16x16x32_bf16 a[252:255], v[32:35], v[60:63], a[252:255]
    ds_read_b64 v[100:101], v150 offset:2752
    v_mfma_f32_16x16x32_bf16 a[244:247], v[16:19], v[68:71], a[244:247]
    ds_read_b64 v[102:103], v150 offset:2760
    buffer_load_dwordx4 a[172:175], v2, s[8:11], s66 offen offset:3072
    v_mfma_f32_16x16x32_bf16 a[248:251], v[20:23], v[68:71], a[248:251]
    ds_read_b128 v[132:135], v151 offset:1216
    v_mfma_f32_16x16x32_bf16 a[252:255], v[24:27], v[68:71], a[252:255]
    ds_read_b64 v[104:105], v150 offset:3264
    v_mfma_f32_16x16x32_bf16 a[244:247], v[36:39], v[48:51], a[244:247]
    ds_read_b64 v[106:107], v150 offset:3272
    v_mfma_f32_16x16x32_bf16 a[248:251], v[36:39], v[52:55], a[248:251]
    ds_read_b128 v[136:139], v151 offset:704
    s_add_u32 s65, s64, 12288
    buffer_load_dwordx4 a[104:107], v2, s[8:11], s65 offen offset:0
    v_mfma_f32_16x16x32_bf16 a[252:255], v[36:39], v[56:59], a[252:255]
    ds_read_b64 v[108:109], v150 offset:3776
    v_mfma_f32_16x16x32_bf16 a[248:251], v[16:19], v[72:75], a[248:251]
    ds_read_b64 v[110:111], v150 offset:3784
    v_mfma_f32_16x16x32_bf16 a[252:255], v[20:23], v[72:75], a[252:255]
    ds_read_b128 v[140:143], v151 offset:192
    v_mfma_f32_16x16x32_bf16 a[248:251], v[40:43], v[48:51], a[248:251]
    s_add_u32 s66, s64, 30720
    buffer_load_dwordx4 a[176:179], v2, s[8:11], s66 offen offset:0
    v_mfma_f32_16x16x32_bf16 a[252:255], v[40:43], v[52:55], a[252:255]
    v_mfma_f32_16x16x32_bf16 a[252:255], v[16:19], v[76:79], a[252:255]
    v_mfma_f32_16x16x32_bf16 a[252:255], v[44:47], v[48:51], a[252:255]
    v_mfma_f32_16x16x32_bf16 a[224:227], v[80:83], v[112:115], a[224:227]
    buffer_load_dwordx4 a[108:111], v2, s[8:11], s65 offen offset:1024
    v_mfma_f32_16x16x32_bf16 a[228:231], v[80:83], v[116:119], a[228:231]
    v_mfma_f32_16x16x32_bf16 a[228:231], v[84:87], v[112:115], a[228:231]
    v_mfma_f32_16x16x32_bf16 a[232:235], v[84:87], v[116:119], a[232:235]
    v_mfma_f32_16x16x32_bf16 a[232:235], v[80:83], v[120:123], a[232:235]
    buffer_load_dwordx4 a[180:183], v2, s[8:11], s66 offen offset:1024
    v_mfma_f32_16x16x32_bf16 a[236:239], v[84:87], v[120:123], a[236:239]
    v_mfma_f32_16x16x32_bf16 a[232:235], v[88:91], v[112:115], a[232:235]
    v_mfma_f32_16x16x32_bf16 a[236:239], v[88:91], v[116:119], a[236:239]
    v_mfma_f32_16x16x32_bf16 a[240:243], v[88:91], v[120:123], a[240:243]
    ds_read_b64 v[16:17], v150 offset:256
    buffer_load_dwordx4 a[112:115], v2, s[8:11], s65 offen offset:2048
    s_waitcnt lgkmcnt(13)
    v_mfma_f32_16x16x32_bf16 a[236:239], v[80:83], v[124:127], a[236:239]
    ds_read_b64 v[18:19], v150 offset:264
    v_mfma_f32_16x16x32_bf16 a[240:243], v[84:87], v[124:127], a[240:243]
    ds_read_b128 v[48:51], v151 offset:3840
    v_mfma_f32_16x16x32_bf16 a[244:247], v[88:91], v[124:127], a[244:247]
    ds_read_b64 v[20:21], v150 offset:768
    v_mfma_f32_16x16x32_bf16 a[236:239], v[92:95], v[112:115], a[236:239]
    ds_read_b64 v[22:23], v150 offset:776
    buffer_load_dwordx4 a[184:187], v2, s[8:11], s66 offen offset:2048
    v_mfma_f32_16x16x32_bf16 a[240:243], v[92:95], v[116:119], a[240:243]
    ds_read_b128 v[52:55], v151 offset:3328
    v_mfma_f32_16x16x32_bf16 a[244:247], v[92:95], v[120:123], a[244:247]
    ds_read_b64 v[24:25], v150 offset:1280
    v_mfma_f32_16x16x32_bf16 a[248:251], v[92:95], v[124:127], a[248:251]
    ds_read_b64 v[26:27], v150 offset:1288
    v_mfma_f32_16x16x32_bf16 a[240:243], v[80:83], v[128:131], a[240:243]
    ds_read_b128 v[56:59], v151 offset:2816
    buffer_load_dwordx4 a[116:119], v2, s[8:11], s65 offen offset:3072
    v_mfma_f32_16x16x32_bf16 a[244:247], v[84:87], v[128:131], a[244:247]
    ds_read_b64 v[28:29], v150 offset:1792
    v_mfma_f32_16x16x32_bf16 a[248:251], v[88:91], v[128:131], a[248:251]
    ds_read_b64 v[30:31], v150 offset:1800
    v_mfma_f32_16x16x32_bf16 a[252:255], v[92:95], v[128:131], a[252:255]
    ds_read_b128 v[60:63], v151 offset:2304
    v_mfma_f32_16x16x32_bf16 a[240:243], v[96:99], v[112:115], a[240:243]
    ds_read_b64 v[32:33], v150 offset:2304
    buffer_load_dwordx4 a[188:191], v2, s[8:11], s66 offen offset:3072
    v_mfma_f32_16x16x32_bf16 a[244:247], v[96:99], v[116:119], a[244:247]
    ds_read_b64 v[34:35], v150 offset:2312
    v_mfma_f32_16x16x32_bf16 a[248:251], v[96:99], v[120:123], a[248:251]
    ds_read_b128 v[64:67], v151 offset:1792
    v_mfma_f32_16x16x32_bf16 a[252:255], v[96:99], v[124:127], a[252:255]
    ds_read_b64 v[36:37], v150 offset:2816
    v_mfma_f32_16x16x32_bf16 a[244:247], v[80:83], v[132:135], a[244:247]
    ds_read_b64 v[38:39], v150 offset:2824
    s_add_u32 s65, s64, 16384
    buffer_load_dwordx4 a[120:123], v2, s[8:11], s65 offen offset:0
    v_mfma_f32_16x16x32_bf16 a[248:251], v[84:87], v[132:135], a[248:251]
    ds_read_b128 v[68:71], v151 offset:1280
    v_mfma_f32_16x16x32_bf16 a[252:255], v[88:91], v[132:135], a[252:255]
    ds_read_b64 v[40:41], v150 offset:3328
    v_mfma_f32_16x16x32_bf16 a[244:247], v[100:103], v[112:115], a[244:247]
    ds_read_b64 v[42:43], v150 offset:3336
    v_mfma_f32_16x16x32_bf16 a[248:251], v[100:103], v[116:119], a[248:251]
    ds_read_b128 v[72:75], v151 offset:768
    s_add_u32 s66, s64, 34816
    buffer_load_dwordx4 a[192:195], v2, s[8:11], s66 offen offset:0
    v_mfma_f32_16x16x32_bf16 a[252:255], v[100:103], v[120:123], a[252:255]
    ds_read_b64 v[44:45], v150 offset:3840
    v_mfma_f32_16x16x32_bf16 a[248:251], v[80:83], v[136:139], a[248:251]
    ds_read_b64 v[46:47], v150 offset:3848
    v_mfma_f32_16x16x32_bf16 a[252:255], v[84:87], v[136:139], a[252:255]
    ds_read_b128 v[76:79], v151 offset:256
    v_mfma_f32_16x16x32_bf16 a[248:251], v[104:107], v[112:115], a[248:251]
    buffer_load_dwordx4 a[124:127], v2, s[8:11], s65 offen offset:1024
    v_mfma_f32_16x16x32_bf16 a[252:255], v[104:107], v[116:119], a[252:255]
    v_mfma_f32_16x16x32_bf16 a[252:255], v[80:83], v[140:143], a[252:255]
    v_mfma_f32_16x16x32_bf16 a[252:255], v[108:111], v[112:115], a[252:255]
    v_mfma_f32_16x16x32_bf16 a[224:227], v[16:19], v[48:51], a[224:227]
    buffer_load_dwordx4 a[196:199], v2, s[8:11], s66 offen offset:1024
    v_mfma_f32_16x16x32_bf16 a[228:231], v[16:19], v[52:55], a[228:231]
    v_mfma_f32_16x16x32_bf16 a[228:231], v[20:23], v[48:51], a[228:231]
    v_mfma_f32_16x16x32_bf16 a[232:235], v[20:23], v[52:55], a[232:235]
    v_mfma_f32_16x16x32_bf16 a[232:235], v[16:19], v[56:59], a[232:235]
    v_mfma_f32_16x16x32_bf16 a[236:239], v[20:23], v[56:59], a[236:239]
    v_mfma_f32_16x16x32_bf16 a[232:235], v[24:27], v[48:51], a[232:235]
    v_mfma_f32_16x16x32_bf16 a[236:239], v[24:27], v[52:55], a[236:239]
    v_mfma_f32_16x16x32_bf16 a[240:243], v[24:27], v[56:59], a[240:243]
    s_waitcnt lgkmcnt(12)
    v_mfma_f32_16x16x32_bf16 a[236:239], v[16:19], v[60:63], a[236:239]
    v_mfma_f32_16x16x32_bf16 a[240:243], v[20:23], v[60:63], a[240:243]
    v_mfma_f32_16x16x32_bf16 a[244:247], v[24:27], v[60:63], a[244:247]
    v_mfma_f32_16x16x32_bf16 a[236:239], v[28:31], v[48:51], a[236:239]
    v_mfma_f32_16x16x32_bf16 a[240:243], v[28:31], v[52:55], a[240:243]
    v_mfma_f32_16x16x32_bf16 a[244:247], v[28:31], v[56:59], a[244:247]
    v_mfma_f32_16x16x32_bf16 a[248:251], v[28:31], v[60:63], a[248:251]
    s_waitcnt lgkmcnt(9)
    v_mfma_f32_16x16x32_bf16 a[240:243], v[16:19], v[64:67], a[240:243]
    v_mfma_f32_16x16x32_bf16 a[244:247], v[20:23], v[64:67], a[244:247]
    v_mfma_f32_16x16x32_bf16 a[248:251], v[24:27], v[64:67], a[248:251]
    v_mfma_f32_16x16x32_bf16 a[252:255], v[28:31], v[64:67], a[252:255]
    v_mfma_f32_16x16x32_bf16 a[240:243], v[32:35], v[48:51], a[240:243]
    v_mfma_f32_16x16x32_bf16 a[244:247], v[32:35], v[52:55], a[244:247]
    v_mfma_f32_16x16x32_bf16 a[248:251], v[32:35], v[56:59], a[248:251]
    v_mfma_f32_16x16x32_bf16 a[252:255], v[32:35], v[60:63], a[252:255]
    s_waitcnt lgkmcnt(6)
    v_mfma_f32_16x16x32_bf16 a[244:247], v[16:19], v[68:71], a[244:247]
    v_mfma_f32_16x16x32_bf16 a[248:251], v[20:23], v[68:71], a[248:251]
    v_mfma_f32_16x16x32_bf16 a[252:255], v[24:27], v[68:71], a[252:255]
    v_mfma_f32_16x16x32_bf16 a[244:247], v[36:39], v[48:51], a[244:247]
    v_mfma_f32_16x16x32_bf16 a[248:251], v[36:39], v[52:55], a[248:251]
    v_mfma_f32_16x16x32_bf16 a[252:255], v[36:39], v[56:59], a[252:255]
    s_waitcnt lgkmcnt(3)
    v_mfma_f32_16x16x32_bf16 a[248:251], v[16:19], v[72:75], a[248:251]
    v_mfma_f32_16x16x32_bf16 a[252:255], v[20:23], v[72:75], a[252:255]
    v_mfma_f32_16x16x32_bf16 a[248:251], v[40:43], v[48:51], a[248:251]
    v_mfma_f32_16x16x32_bf16 a[252:255], v[40:43], v[52:55], a[252:255]
    s_waitcnt lgkmcnt(0)
    v_mfma_f32_16x16x32_bf16 a[252:255], v[16:19], v[76:79], a[252:255]
    v_mfma_f32_16x16x32_bf16 a[252:255], v[44:47], v[48:51], a[252:255]
    s_waitcnt vmcnt(36)
    s_nop 6
    s_branch KF_KVJ
KF_KVC:
    s_add_u32 s65, s64, 0
    buffer_load_dwordx4 a[56:59], v2, s[8:11], s65 offen offset:0
    s_add_u32 s66, s64, 18432
    buffer_load_dwordx4 a[128:131], v2, s[8:11], s66 offen offset:0
    buffer_load_dwordx4 a[60:63], v2, s[8:11], s65 offen offset:1024
    buffer_load_dwordx4 a[132:135], v2, s[8:11], s66 offen offset:1024
    buffer_load_dwordx4 a[64:67], v2, s[8:11], s65 offen offset:2048
    buffer_load_dwordx4 a[136:139], v2, s[8:11], s66 offen offset:2048
    buffer_load_dwordx4 a[68:71], v2, s[8:11], s65 offen offset:3072
    buffer_load_dwordx4 a[140:143], v2, s[8:11], s66 offen offset:3072
    s_add_u32 s65, s64, 4096
    buffer_load_dwordx4 a[72:75], v2, s[8:11], s65 offen offset:0
    s_add_u32 s66, s64, 22528
    buffer_load_dwordx4 a[144:147], v2, s[8:11], s66 offen offset:0
    buffer_load_dwordx4 a[76:79], v2, s[8:11], s65 offen offset:1024
    buffer_load_dwordx4 a[148:151], v2, s[8:11], s66 offen offset:1024
    buffer_load_dwordx4 a[80:83], v2, s[8:11], s65 offen offset:2048
    buffer_load_dwordx4 a[152:155], v2, s[8:11], s66 offen offset:2048
    buffer_load_dwordx4 a[84:87], v2, s[8:11], s65 offen offset:3072
    buffer_load_dwordx4 a[156:159], v2, s[8:11], s66 offen offset:3072
    s_add_u32 s65, s64, 8192
    buffer_load_dwordx4 a[88:91], v2, s[8:11], s65 offen offset:0
    s_add_u32 s66, s64, 26624
    buffer_load_dwordx4 a[160:163], v2, s[8:11], s66 offen offset:0
    buffer_load_dwordx4 a[92:95], v2, s[8:11], s65 offen offset:1024
    buffer_load_dwordx4 a[164:167], v2, s[8:11], s66 offen offset:1024
    buffer_load_dwordx4 a[96:99], v2, s[8:11], s65 offen offset:2048
    buffer_load_dwordx4 a[168:171], v2, s[8:11], s66 offen offset:2048
    buffer_load_dwordx4 a[100:103], v2, s[8:11], s65 offen offset:3072
    buffer_load_dwordx4 a[172:175], v2, s[8:11], s66 offen offset:3072
    s_add_u32 s65, s64, 12288
    buffer_load_dwordx4 a[104:107], v2, s[8:11], s65 offen offset:0
    s_add_u32 s66, s64, 30720
    buffer_load_dwordx4 a[176:179], v2, s[8:11], s66 offen offset:0
    buffer_load_dwordx4 a[108:111], v2, s[8:11], s65 offen offset:1024
    buffer_load_dwordx4 a[180:183], v2, s[8:11], s66 offen offset:1024
    buffer_load_dwordx4 a[112:115], v2, s[8:11], s65 offen offset:2048
    buffer_load_dwordx4 a[184:187], v2, s[8:11], s66 offen offset:2048
    buffer_load_dwordx4 a[116:119], v2, s[8:11], s65 offen offset:3072
    buffer_load_dwordx4 a[188:191], v2, s[8:11], s66 offen offset:3072
    s_add_u32 s65, s64, 16384
    buffer_load_dwordx4 a[120:123], v2, s[8:11], s65 offen offset:0
    s_add_u32 s66, s64, 34816
    buffer_load_dwordx4 a[192:195], v2, s[8:11], s66 offen offset:0
    buffer_load_dwordx4 a[124:127], v2, s[8:11], s65 offen offset:1024
    buffer_load_dwordx4 a[196:199], v2, s[8:11], s66 offen offset:1024
    s_waitcnt vmcnt(36)
    s_branch KF_KVJ
KF_KVB:
    v_mov_b32 v190, 0x41800000
    s_add_u32 s4, s39, 4096
    s_mov_b32 s24, 15048704
    v_lshlrev_b32 v195, 8, v1
    v_mov_b32 v194, 16
    s_add_u32 s65, s64, 0
    buffer_load_dwordx4 a[56:59], v2, s[8:11], s65 offen offset:0
    s_add_u32 s66, s64, 18432
    buffer_load_dwordx4 a[128:131], v2, s[8:11], s66 offen offset:0
    s_add_u32 s67, s64, 36864
    buffer_load_dwordx4 a[200:203], v2, s[8:11], s67 offen offset:0
    buffer_load_dwordx4 a[60:63], v2, s[8:11], s65 offen offset:1024
    buffer_load_dwordx4 a[132:135], v2, s[8:11], s66 offen offset:1024
    buffer_load_dwordx4 a[204:207], v2, s[8:11], s67 offen offset:1024
    buffer_load_dwordx4 a[64:67], v2, s[8:11], s65 offen offset:2048
    buffer_load_dwordx4 a[136:139], v2, s[8:11], s66 offen offset:2048
    buffer_load_dwordx4 a[208:211], v2, s[8:11], s67 offen offset:2048
    buffer_load_dwordx4 a[68:71], v2, s[8:11], s65 offen offset:3072
    buffer_load_dwordx4 a[140:143], v2, s[8:11], s66 offen offset:3072
    buffer_load_dwordx4 a[212:215], v2, s[8:11], s67 offen offset:3072
    s_add_u32 s65, s64, 4096
    buffer_load_dwordx4 a[72:75], v2, s[8:11], s65 offen offset:0
    s_add_u32 s66, s64, 22528
    buffer_load_dwordx4 a[144:147], v2, s[8:11], s66 offen offset:0
    s_add_u32 s67, s64, 40960
    buffer_load_dwordx4 a[216:219], v2, s[8:11], s67 offen offset:0
    buffer_load_dwordx4 a[76:79], v2, s[8:11], s65 offen offset:1024
    buffer_load_dwordx4 a[148:151], v2, s[8:11], s66 offen offset:1024
    buffer_load_dwordx4 a[220:223], v2, s[8:11], s67 offen offset:1024
    buffer_load_dwordx4 a[80:83], v2, s[8:11], s65 offen offset:2048
    buffer_load_dwordx4 a[152:155], v2, s[8:11], s66 offen offset:2048
    buffer_load_dwordx4 a[0:3], v2, s[8:11], s67 offen offset:2048
    buffer_load_dwordx4 a[84:87], v2, s[8:11], s65 offen offset:3072
    buffer_load_dwordx4 a[156:159], v2, s[8:11], s66 offen offset:3072
    buffer_load_dwordx4 a[4:7], v2, s[8:11], s67 offen offset:3072
    s_add_u32 s65, s64, 8192
    buffer_load_dwordx4 a[88:91], v2, s[8:11], s65 offen offset:0
    s_add_u32 s66, s64, 26624
    buffer_load_dwordx4 a[160:163], v2, s[8:11], s66 offen offset:0
    s_add_u32 s67, s64, 45056
    buffer_load_dwordx4 a[8:11], v2, s[8:11], s67 offen offset:0
    buffer_load_dwordx4 a[92:95], v2, s[8:11], s65 offen offset:1024
    buffer_load_dwordx4 a[164:167], v2, s[8:11], s66 offen offset:1024
    buffer_load_dwordx4 a[12:15], v2, s[8:11], s67 offen offset:1024
    buffer_load_dwordx4 a[96:99], v2, s[8:11], s65 offen offset:2048
    buffer_load_dwordx4 a[168:171], v2, s[8:11], s66 offen offset:2048
    buffer_load_dwordx4 a[16:19], v2, s[8:11], s67 offen offset:2048
    buffer_load_dwordx4 a[100:103], v2, s[8:11], s65 offen offset:3072
    buffer_load_dwordx4 a[172:175], v2, s[8:11], s66 offen offset:3072
    buffer_load_dwordx4 a[20:23], v2, s[8:11], s67 offen offset:3072
    s_add_u32 s65, s64, 12288
    buffer_load_dwordx4 a[104:107], v2, s[8:11], s65 offen offset:0
    s_add_u32 s66, s64, 30720
    buffer_load_dwordx4 a[176:179], v2, s[8:11], s66 offen offset:0
    s_add_u32 s67, s64, 49152
    buffer_load_dwordx4 a[24:27], v2, s[8:11], s67 offen offset:0
    buffer_load_dwordx4 a[108:111], v2, s[8:11], s65 offen offset:1024
    buffer_load_dwordx4 a[180:183], v2, s[8:11], s66 offen offset:1024
    buffer_load_dwordx4 a[28:31], v2, s[8:11], s67 offen offset:1024
    buffer_load_dwordx4 a[112:115], v2, s[8:11], s65 offen offset:2048
    buffer_load_dwordx4 a[184:187], v2, s[8:11], s66 offen offset:2048
    buffer_load_dwordx4 a[32:35], v2, s[8:11], s67 offen offset:2048
    buffer_load_dwordx4 a[116:119], v2, s[8:11], s65 offen offset:3072
    buffer_load_dwordx4 a[188:191], v2, s[8:11], s66 offen offset:3072
    buffer_load_dwordx4 a[36:39], v2, s[8:11], s67 offen offset:3072
    s_add_u32 s65, s64, 16384
    buffer_load_dwordx4 a[120:123], v2, s[8:11], s65 offen offset:0
    s_add_u32 s66, s64, 34816
    buffer_load_dwordx4 a[192:195], v2, s[8:11], s66 offen offset:0
    s_add_u32 s67, s64, 53248
    buffer_load_dwordx4 a[40:43], v2, s[8:11], s67 offen offset:0
    buffer_load_dwordx4 a[124:127], v2, s[8:11], s65 offen offset:1024
    buffer_load_dwordx4 a[196:199], v2, s[8:11], s66 offen offset:1024
    buffer_load_dwordx4 a[44:47], v2, s[8:11], s67 offen offset:1024
KF_KQ:
    buffer_load_dwordx4 v[160:163], v2, s[8:11], s39 offen offset:0 sc1
    buffer_load_dwordx4 v[164:167], v2, s[8:11], s39 offen offset:1024 sc1
    buffer_load_dwordx4 v[168:171], v2, s[8:11], s39 offen offset:2048 sc1
    buffer_load_dwordx4 v[172:175], v2, s[8:11], s39 offen offset:3072 sc1
    buffer_load_dwordx4 v[176:179], v2, s[8:11], s4 offen offset:0 sc1
    buffer_load_dwordx4 v[180:183], v2, s[8:11], s4 offen offset:1024 sc1
    buffer_load_dwordx4 v[184:187], v2, s[8:11], s4 offen offset:2048 sc1
    s_mov_b32 exec_hi, 0
    buffer_load_dwordx4 v[188:191], v2, s[8:11], s4 offen offset:3072 sc1
    s_mov_b32 exec_lo, 0xffff
    buffer_load_dword v194, v195, s[8:11], s24 offen sc1
    s_mov_b64 exec, -1
    s_waitcnt vmcnt(6)
    v_min3_u32 v192, v162, v166, v170
    s_waitcnt vmcnt(4)
    v_min3_u32 v192, v192, v174, v178
    s_waitcnt vmcnt(2)
    v_min3_u32 v192, v192, v182, v186
    s_waitcnt vmcnt(1)
    v_min_u32 v192, v192, v190
    v_cmp_ne_u32 vcc, 0x41800000, v192
    s_and_b64 s[58:59], vcc, s[56:57]
    s_waitcnt vmcnt(0)
    v_cmp_ne_u32 vcc, 16, v194
    s_or_b64 s[58:59], s[58:59], vcc
    s_sub_u32 s68, s68, 1
    s_cselect_b64 s[36:37], 0, s[58:59]
    s_cselect_b32 s68, 0, s68
    s_cmp_eq_u64 s[36:37], 0
    s_cbranch_scc1 KF_KQ_GO
    s_sleep 3
    s_branch KF_KQ
KF_KQ_GO:
    v_cvt_pk_bf16_f32 v16, v160, v161
    v_cvt_pk_bf16_f32 v17, v162, v163
    ds_write_b64 v241, v[16:17] offset:0
    v_cvt_pk_bf16_f32 v18, v164, v165
    v_cvt_pk_bf16_f32 v19, v166, v167
    ds_write_b64 v241, v[18:19] offset:512
    v_cvt_pk_bf16_f32 v20, v168, v169
    v_cvt_pk_bf16_f32 v21, v170, v171
    ds_write_b64 v241, v[20:21] offset:1024
    v_cvt_pk_bf16_f32 v22, v172, v173
    v_cvt_pk_bf16_f32 v23, v174, v175
    ds_write_b64 v241, v[22:23] offset:1536
    v_cvt_pk_bf16_f32 v24, v176, v177
    v_cvt_pk_bf16_f32 v25, v178, v179
    ds_write_b64 v241, v[24:25] offset:2048
    v_cvt_pk_bf16_f32 v26, v180, v181
    v_cvt_pk_bf16_f32 v27, v182, v183
    ds_write_b64 v241, v[26:27] offset:2560
    v_cvt_pk_bf16_f32 v28, v184, v185
    v_cvt_pk_bf16_f32 v29, v186, v187
    ds_write_b64 v241, v[28:29] offset:3072
    v_cvt_pk_bf16_f32 v30, v188, v189
    v_cvt_pk_bf16_f32 v31, v190, v191
    s_mov_b32 exec_hi, 0
    ds_write_b64 v241, v[30:31] offset:3584
    s_mov_b32 exec_hi, -1
    s_nop 1
    s_branch KF_KVJ
KF_KVA:
    v_mov_b32 v166, 0x41800000
    s_sleep 16
    s_nop 3
KF_KP:
    buffer_load_dwordx4 v[160:163], v2, s[8:11], s39 offen sc1
    s_mov_b32 exec_hi, 0xffffff
    buffer_load_dwordx4 v[164:167], v2, s[8:11], s39 offen offset:1024 sc1
    s_mov_b32 exec_hi, -1
    s_waitcnt vmcnt(0)
    v_min_u32 v168, v162, v166
    v_cmp_ne_u32 vcc, 0x41800000, v168
    s_and_b64 s[58:59], vcc, s[56:57]
    s_sub_u32 s68, s68, 1
    s_cselect_b64 s[36:37], 0, s[58:59]
    s_cselect_b32 s68, 0, s68
    s_cmp_eq_u64 s[36:37], 0
    s_cbranch_scc1 KF_KP_GO
    s_sleep 3
    s_branch KF_KP
KF_KP_GO:
    v_cvt_pk_bf16_f32 v168, v160, v161
    v_cvt_pk_bf16_f32 v169, v162, v163
    v_cvt_pk_bf16_f32 v170, v164, v165
    v_cvt_pk_bf16_f32 v171, v166, v167
    ds_write_b64 v241, v[168:169]
    s_mov_b32 exec_hi, 0xffffff
    ds_write_b64 v241, v[170:171] offset:512
    s_mov_b32 exec_hi, -1
    s_nop 0
KF_KVJ:
    s_waitcnt lgkmcnt(0)
    s_barrier
    ds_read_b128 v[96:99], v242 offset:1536
    ds_read_b128 v[100:103], v242 offset:1552
    ds_read_b128 v[104:107], v242 offset:1568
    ds_read_b128 v[108:111], v242 offset:1584
    ds_read_b128 v[112:115], v242 offset:1600
    ds_read_b128 v[16:19], v242 offset:0
    ds_read_b128 v[20:23], v242 offset:16
    ds_read_b128 v[24:27], v242 offset:32
    ds_read_b128 v[28:31], v242 offset:48
    ds_read_b128 v[32:35], v242 offset:64
    ds_read_b128 v[36:39], v242 offset:384
    ds_read_b128 v[40:43], v242 offset:400
    ds_read_b128 v[44:47], v242 offset:416
    ds_read_b128 v[48:51], v242 offset:432
    ds_read_b128 v[52:55], v242 offset:448
    ds_read_b128 v[56:59], v242 offset:768
    ds_read_b128 v[60:63], v242 offset:784
    ds_read_b128 v[64:67], v242 offset:800
    ds_read_b128 v[68:71], v242 offset:816
    ds_read_b128 v[72:75], v242 offset:832
    ds_read_b128 v[76:79], v242 offset:1152
    ds_read_b128 v[80:83], v242 offset:1168
    ds_read_b128 v[84:87], v242 offset:1184
    ds_read_b128 v[88:91], v242 offset:1200
    ds_read_b128 v[92:95], v242 offset:1216
    v_mfma_f32_16x16x32_bf16 v[132:135], v[96:99], v[216:219], 0
    v_mfma_f32_16x16x32_bf16 v[132:135], v[100:103], v[220:223], v[132:135]
    v_mfma_f32_16x16x32_bf16 v[132:135], v[104:107], v[224:227], v[132:135]
    v_mfma_f32_16x16x32_bf16 v[132:135], v[108:111], v[228:231], v[132:135]
    v_mfma_f32_16x16x32_bf16 v[132:135], v[112:115], v[232:235], v[132:135]
    v_mfma_f32_16x16x32_bf16 v[116:119], v[16:19], v[216:219], 0
    v_mfma_f32_16x16x32_bf16 v[116:119], v[20:23], v[220:223], v[116:119]
    v_mfma_f32_16x16x32_bf16 v[116:119], v[24:27], v[224:227], v[116:119]
    v_mfma_f32_16x16x32_bf16 v[116:119], v[28:31], v[228:231], v[116:119]
    v_mfma_f32_16x16x32_bf16 v[116:119], v[32:35], v[232:235], v[116:119]
    s_waitcnt lgkmcnt(14)
    v_mfma_f32_16x16x32_bf16 v[120:123], v[36:39], v[216:219], 0
    s_waitcnt lgkmcnt(13)
    v_mfma_f32_16x16x32_bf16 v[120:123], v[40:43], v[220:223], v[120:123]
    s_waitcnt lgkmcnt(12)
    v_mfma_f32_16x16x32_bf16 v[120:123], v[44:47], v[224:227], v[120:123]
    s_waitcnt lgkmcnt(11)
    v_mfma_f32_16x16x32_bf16 v[120:123], v[48:51], v[228:231], v[120:123]
    s_waitcnt lgkmcnt(10)
    v_mfma_f32_16x16x32_bf16 v[120:123], v[52:55], v[232:235], v[120:123]
    v_add_f32 v134, 0x358637bd, v134
    v_rcp_f32 v134, v134
    s_waitcnt lgkmcnt(9)
    v_mfma_f32_16x16x32_bf16 v[124:127], v[56:59], v[216:219], 0
    s_waitcnt lgkmcnt(8)
    v_mfma_f32_16x16x32_bf16 v[124:127], v[60:63], v[220:223], v[124:127]
    s_waitcnt lgkmcnt(7)
    v_mfma_f32_16x16x32_bf16 v[124:127], v[64:67], v[224:227], v[124:127]
    s_waitcnt lgkmcnt(6)
    v_mfma_f32_16x16x32_bf16 v[124:127], v[68:71], v[228:231], v[124:127]
    s_waitcnt lgkmcnt(5)
    v_mfma_f32_16x16x32_bf16 v[124:127], v[72:75], v[232:235], v[124:127]
    s_waitcnt lgkmcnt(4)
    v_mfma_f32_16x16x32_bf16 v[128:131], v[76:79], v[216:219], 0
    s_waitcnt lgkmcnt(3)
    v_mfma_f32_16x16x32_bf16 v[128:131], v[80:83], v[220:223], v[128:131]
    s_waitcnt lgkmcnt(2)
    v_mfma_f32_16x16x32_bf16 v[128:131], v[84:87], v[224:227], v[128:131]
    s_waitcnt lgkmcnt(1)
    v_mfma_f32_16x16x32_bf16 v[128:131], v[88:91], v[228:231], v[128:131]
    s_waitcnt lgkmcnt(0)
    v_mfma_f32_16x16x32_bf16 v[128:131], v[92:95], v[232:235], v[128:131]
    v_mul_f32 v132, v132, v134
    v_mul_f32 v133, v133, v134
    v_cvt_pk_bf16_f32 v144, v132, v133
    v_min_u32 v144, -2, v144
    buffer_store_dword v144, v14, s[8:11], s38 offen sc1
    v_mul_f32 v116, v116, v134
    v_mul_f32 v117, v117, v134
    v_cvt_pk_bf16_f32 v136, v116, v117
    v_min_u32 v136, -2, v136
    v_mul_f32 v118, v118, v134
    v_mul_f32 v119, v119, v134
    v_cvt_pk_bf16_f32 v137, v118, v119
    v_min_u32 v137, -2, v137
    v_mul_f32 v120, v120, v134
    v_mul_f32 v121, v121, v134
    v_cvt_pk_bf16_f32 v138, v120, v121
    v_min_u32 v138, -2, v138
    v_mul_f32 v122, v122, v134
    v_mul_f32 v123, v123, v134
    v_cvt_pk_bf16_f32 v139, v122, v123
    v_min_u32 v139, -2, v139
    buffer_store_dwordx4 v[136:139], v13, s[8:11], s50 offen sc1
    v_mul_f32 v124, v124, v134
    v_mul_f32 v125, v125, v134
    v_cvt_pk_bf16_f32 v140, v124, v125
    v_min_u32 v140, -2, v140
    v_mul_f32 v126, v126, v134
    v_mul_f32 v127, v127, v134
    v_cvt_pk_bf16_f32 v141, v126, v127
    v_min_u32 v141, -2, v141
    v_mul_f32 v128, v128, v134
    v_mul_f32 v129, v129, v134
    v_cvt_pk_bf16_f32 v142, v128, v129
    v_min_u32 v142, -2, v142
    v_mul_f32 v130, v130, v134
    v_mul_f32 v131, v131, v134
    v_cvt_pk_bf16_f32 v143, v130, v131
    v_min_u32 v143, -2, v143
    buffer_store_dwordx4 v[140:143], v13, s[8:11], s50 offen offset:256 sc1
    s_cmp_eq_u32 s71, 0
    s_nop 2
    s_cbranch_scc1 KF_ONC
    ds_read_b64 v[80:81], v150 offset:320
    ds_read_b64 v[82:83], v150 offset:328
    ds_read_b128 v[112:115], v151 offset:3904
    ds_read_b64 v[84:85], v150 offset:832
    ds_read_b64 v[86:87], v150 offset:840
    ds_read_b128 v[116:119], v151 offset:3392
    ds_read_b64 v[88:89], v150 offset:1344
    ds_read_b64 v[90:91], v150 offset:1352
    ds_read_b128 v[120:123], v151 offset:2880
    ds_read_b64 v[92:93], v150 offset:1856
    ds_read_b64 v[94:95], v150 offset:1864
    ds_read_b128 v[124:127], v151 offset:2368
    ds_read_b64 v[96:97], v150 offset:2368
    ds_read_b64 v[98:99], v150 offset:2376
    ds_read_b128 v[128:131], v151 offset:1856
    ds_read_b64 v[100:101], v150 offset:2880
    ds_read_b64 v[102:103], v150 offset:2888
    ds_read_b128 v[132:135], v151 offset:1344
    ds_read_b64 v[104:105], v150 offset:3392
    ds_read_b64 v[106:107], v150 offset:3400
    ds_read_b128 v[136:139], v151 offset:832
    ds_read_b64 v[108:109], v150 offset:3904
    ds_read_b64 v[110:111], v150 offset:3912
    ds_read_b128 v[140:143], v151 offset:320
    buffer_load_dwordx4 v[244:247], v237, s[72:75], s40 offen offset:0
    buffer_load_dwordx4 v[248:251], v237, s[72:75], s40 offen offset:32
    buffer_load_dwordx4 v[252:255], v237, s[72:75], s41 offen offset:64
    v_mfma_f32_16x16x32_bf16 a[224:227], v[80:83], v[112:115], a[224:227]
    v_mfma_f32_16x16x32_bf16 a[228:231], v[80:83], v[116:119], a[228:231]
    v_mfma_f32_16x16x32_bf16 a[228:231], v[84:87], v[112:115], a[228:231]
    s_lshl_b32 s4, s3, 11
    s_add_u32 s4, s4, 155648
    s_cmp_eq_u32 s3, 0
    s_cselect_b32 s4, 154624, s4
    v_add_u32 v11, s4, v2
    v_mfma_f32_16x16x32_bf16 a[232:235], v[84:87], v[116:119], a[232:235]
    v_mfma_f32_16x16x32_bf16 a[232:235], v[80:83], v[120:123], a[232:235]
    v_lshrrev_b32 v12, 1, v4
    v_lshlrev_b32 v12, 3, v12
    v_lshrrev_b32 v13, 2, v3
    v_add_u32 v12, v12, v13
    v_lshlrev_b32 v12, 6, v12
    v_mfma_f32_16x16x32_bf16 a[236:239], v[84:87], v[120:123], a[236:239]
    v_mfma_f32_16x16x32_bf16 a[232:235], v[88:91], v[112:115], a[232:235]
    v_and_b32 v13, 1, v4
    v_lshl_add_u32 v12, v13, 5, v12
    v_and_b32 v13, 3, v3
    v_lshl_add_u32 v12, v13, 3, v12
    v_add_u32 v12, s4, v12
    v_mfma_f32_16x16x32_bf16 a[236:239], v[88:91], v[116:119], a[236:239]
    v_mfma_f32_16x16x32_bf16 a[240:243], v[88:91], v[120:123], a[240:243]
    ds_read_b64 v[16:17], v150 offset:384
    v_and_b32 v8, 31, v1
    v_lshrrev_b32 v7, 5, v1
    s_waitcnt lgkmcnt(13)
    v_mfma_f32_16x16x32_bf16 a[236:239], v[80:83], v[124:127], a[236:239]
    ds_read_b64 v[18:19], v150 offset:392
    v_mfma_f32_16x16x32_bf16 a[240:243], v[84:87], v[124:127], a[240:243]
    ds_read_b128 v[48:51], v151 offset:3968
    v_lshlrev_b32 v13, 3, v8
    v_add_u32 v14, 153600, v13
    s_lshl_b32 s4, s3, 8
    v_add_u32 v15, s4, v14
    v_mfma_f32_16x16x32_bf16 a[244:247], v[88:91], v[124:127], a[244:247]
    ds_read_b64 v[20:21], v150 offset:896
    v_mfma_f32_16x16x32_bf16 a[236:239], v[92:95], v[112:115], a[236:239]
    ds_read_b64 v[22:23], v150 offset:904
    v_add_u32 v234, s61, v7
    v_add_u32 v232, 1, v234
    v_and_b32 v232, 3, v232
    v_lshl_add_u32 v232, v232, 8, v13
    v_mfma_f32_16x16x32_bf16 a[240:243], v[92:95], v[116:119], a[240:243]
    ds_read_b128 v[52:55], v151 offset:3456
    v_mfma_f32_16x16x32_bf16 a[244:247], v[92:95], v[120:123], a[244:247]
    ds_read_b64 v[24:25], v150 offset:1408
    v_add_u32 v233, 3, v234
    v_and_b32 v233, 3, v233
    v_lshl_add_u32 v233, v233, 8, v13
    v_mfma_f32_16x16x32_bf16 a[248:251], v[92:95], v[124:127], a[248:251]
    ds_read_b64 v[26:27], v150 offset:1416
    v_mfma_f32_16x16x32_bf16 a[240:243], v[80:83], v[128:131], a[240:243]
    ds_read_b128 v[56:59], v151 offset:2944
    v_mfma_f32_16x16x32_bf16 a[244:247], v[84:87], v[128:131], a[244:247]
    ds_read_b64 v[28:29], v150 offset:1920
    v_mfma_f32_16x16x32_bf16 a[248:251], v[88:91], v[128:131], a[248:251]
    ds_read_b64 v[30:31], v150 offset:1928
    v_mfma_f32_16x16x32_bf16 a[252:255], v[92:95], v[128:131], a[252:255]
    ds_read_b128 v[60:63], v151 offset:2432
    v_mfma_f32_16x16x32_bf16 a[240:243], v[96:99], v[112:115], a[240:243]
    ds_read_b64 v[32:33], v150 offset:2432
    v_mfma_f32_16x16x32_bf16 a[244:247], v[96:99], v[116:119], a[244:247]
    ds_read_b64 v[34:35], v150 offset:2440
    v_mfma_f32_16x16x32_bf16 a[248:251], v[96:99], v[120:123], a[248:251]
    ds_read_b128 v[64:67], v151 offset:1920
    v_mfma_f32_16x16x32_bf16 a[252:255], v[96:99], v[124:127], a[252:255]
    ds_read_b64 v[36:37], v150 offset:2944
    v_mfma_f32_16x16x32_bf16 a[244:247], v[80:83], v[132:135], a[244:247]
    ds_read_b64 v[38:39], v150 offset:2952
    v_mfma_f32_16x16x32_bf16 a[248:251], v[84:87], v[132:135], a[248:251]
    ds_read_b128 v[68:71], v151 offset:1408
    v_mfma_f32_16x16x32_bf16 a[252:255], v[88:91], v[132:135], a[252:255]
    ds_read_b64 v[40:41], v150 offset:3456
    v_mfma_f32_16x16x32_bf16 a[244:247], v[100:103], v[112:115], a[244:247]
    ds_read_b64 v[42:43], v150 offset:3464
    v_mfma_f32_16x16x32_bf16 a[248:251], v[100:103], v[116:119], a[248:251]
    ds_read_b128 v[72:75], v151 offset:896
    v_mfma_f32_16x16x32_bf16 a[252:255], v[100:103], v[120:123], a[252:255]
    ds_read_b64 v[44:45], v150 offset:3968
    v_mfma_f32_16x16x32_bf16 a[248:251], v[80:83], v[136:139], a[248:251]
    ds_read_b64 v[46:47], v150 offset:3976
    v_mfma_f32_16x16x32_bf16 a[252:255], v[84:87], v[136:139], a[252:255]
    ds_read_b128 v[76:79], v151 offset:384
    v_mfma_f32_16x16x32_bf16 a[248:251], v[104:107], v[112:115], a[248:251]
    v_mfma_f32_16x16x32_bf16 a[252:255], v[104:107], v[116:119], a[252:255]
    v_mfma_f32_16x16x32_bf16 a[252:255], v[80:83], v[140:143], a[252:255]
    v_mfma_f32_16x16x32_bf16 a[252:255], v[108:111], v[112:115], a[252:255]
    v_mfma_f32_16x16x32_bf16 a[224:227], v[16:19], v[48:51], a[224:227]
    v_mfma_f32_16x16x32_bf16 a[228:231], v[16:19], v[52:55], a[228:231]
    v_mfma_f32_16x16x32_bf16 a[228:231], v[20:23], v[48:51], a[228:231]
    v_mfma_f32_16x16x32_bf16 a[232:235], v[20:23], v[52:55], a[232:235]
    v_mfma_f32_16x16x32_bf16 a[232:235], v[16:19], v[56:59], a[232:235]
    v_mfma_f32_16x16x32_bf16 a[236:239], v[20:23], v[56:59], a[236:239]
    v_mfma_f32_16x16x32_bf16 a[232:235], v[24:27], v[48:51], a[232:235]
    v_mfma_f32_16x16x32_bf16 a[236:239], v[24:27], v[52:55], a[236:239]
    v_mfma_f32_16x16x32_bf16 a[240:243], v[24:27], v[56:59], a[240:243]
    ds_read_b64 v[80:81], v150 offset:448
    s_waitcnt lgkmcnt(13)
    v_mfma_f32_16x16x32_bf16 a[236:239], v[16:19], v[60:63], a[236:239]
    ds_read_b64 v[82:83], v150 offset:456
    v_mfma_f32_16x16x32_bf16 a[240:243], v[20:23], v[60:63], a[240:243]
    ds_read_b128 v[112:115], v151 offset:4032
    v_mfma_f32_16x16x32_bf16 a[244:247], v[24:27], v[60:63], a[244:247]
    ds_read_b64 v[84:85], v150 offset:960
    v_mfma_f32_16x16x32_bf16 a[236:239], v[28:31], v[48:51], a[236:239]
    ds_read_b64 v[86:87], v150 offset:968
    v_mfma_f32_16x16x32_bf16 a[240:243], v[28:31], v[52:55], a[240:243]
    ds_read_b128 v[116:119], v151 offset:3520
    v_mfma_f32_16x16x32_bf16 a[244:247], v[28:31], v[56:59], a[244:247]
    ds_read_b64 v[88:89], v150 offset:1472
    v_mfma_f32_16x16x32_bf16 a[248:251], v[28:31], v[60:63], a[248:251]
    ds_read_b64 v[90:91], v150 offset:1480
    v_mfma_f32_16x16x32_bf16 a[240:243], v[16:19], v[64:67], a[240:243]
    ds_read_b128 v[120:123], v151 offset:3008
    v_mfma_f32_16x16x32_bf16 a[244:247], v[20:23], v[64:67], a[244:247]
    ds_read_b64 v[92:93], v150 offset:1984
    v_mfma_f32_16x16x32_bf16 a[248:251], v[24:27], v[64:67], a[248:251]
    ds_read_b64 v[94:95], v150 offset:1992
    v_mfma_f32_16x16x32_bf16 a[252:255], v[28:31], v[64:67], a[252:255]
    ds_read_b128 v[124:127], v151 offset:2496
    v_mfma_f32_16x16x32_bf16 a[240:243], v[32:35], v[48:51], a[240:243]
    ds_read_b64 v[96:97], v150 offset:2496
    v_mfma_f32_16x16x32_bf16 a[244:247], v[32:35], v[52:55], a[244:247]
    ds_read_b64 v[98:99], v150 offset:2504
    v_mfma_f32_16x16x32_bf16 a[248:251], v[32:35], v[56:59], a[248:251]
    ds_read_b128 v[128:131], v151 offset:1984
    v_mfma_f32_16x16x32_bf16 a[252:255], v[32:35], v[60:63], a[252:255]
    ds_read_b64 v[100:101], v150 offset:3008
    buffer_load_dwordx4 v[160:163], v2, s[8:11], s45 offen offset:0 sc1
    buffer_load_dwordx4 v[164:167], v2, s[8:11], s45 offen offset:1024 sc1
    buffer_load_dwordx4 v[168:171], v2, s[8:11], s45 offen offset:2048 sc1
    buffer_load_dwordx4 v[172:175], v2, s[8:11], s45 offen offset:3072 sc1
    buffer_load_dwordx4 v[176:179], v2, s[8:11], s46 offen offset:0 sc1
    buffer_load_dwordx4 v[180:183], v2, s[8:11], s46 offen offset:1024 sc1
    buffer_load_dwordx4 v[184:187], v2, s[8:11], s46 offen offset:2048 sc1
    buffer_load_dwordx4 v[188:191], v2, s[8:11], s46 offen offset:3072 sc1
    buffer_load_dwordx4 v[192:195], v2, s[8:11], s47 offen offset:0 sc1
    v_mfma_f32_16x16x32_bf16 a[244:247], v[16:19], v[68:71], a[244:247]
    ds_read_b64 v[102:103], v150 offset:3016
    v_mfma_f32_16x16x32_bf16 a[248:251], v[20:23], v[68:71], a[248:251]
    ds_read_b128 v[132:135], v151 offset:1472
    v_mfma_f32_16x16x32_bf16 a[252:255], v[24:27], v[68:71], a[252:255]
    ds_read_b64 v[104:105], v150 offset:3520
    v_mfma_f32_16x16x32_bf16 a[244:247], v[36:39], v[48:51], a[244:247]
    ds_read_b64 v[106:107], v150 offset:3528
    v_mfma_f32_16x16x32_bf16 a[248:251], v[36:39], v[52:55], a[248:251]
    ds_read_b128 v[136:139], v151 offset:960
    v_mfma_f32_16x16x32_bf16 a[252:255], v[36:39], v[56:59], a[252:255]
    ds_read_b64 v[108:109], v150 offset:4032
    v_mfma_f32_16x16x32_bf16 a[248:251], v[16:19], v[72:75], a[248:251]
    ds_read_b64 v[110:111], v150 offset:4040
    v_mfma_f32_16x16x32_bf16 a[252:255], v[20:23], v[72:75], a[252:255]
    ds_read_b128 v[140:143], v151 offset:448
    v_mfma_f32_16x16x32_bf16 a[248:251], v[40:43], v[48:51], a[248:251]
    v_mfma_f32_16x16x32_bf16 a[252:255], v[40:43], v[52:55], a[252:255]
    v_mfma_f32_16x16x32_bf16 a[252:255], v[16:19], v[76:79], a[252:255]
    v_mfma_f32_16x16x32_bf16 a[252:255], v[44:47], v[48:51], a[252:255]
    v_mfma_f32_16x16x32_bf16 a[224:227], v[80:83], v[112:115], a[224:227]
    v_mfma_f32_16x16x32_bf16 a[228:231], v[80:83], v[116:119], a[228:231]
    v_mfma_f32_16x16x32_bf16 a[228:231], v[84:87], v[112:115], a[228:231]
    v_mfma_f32_16x16x32_bf16 a[232:235], v[84:87], v[116:119], a[232:235]
    v_mfma_f32_16x16x32_bf16 a[232:235], v[80:83], v[120:123], a[232:235]
    v_mfma_f32_16x16x32_bf16 a[236:239], v[84:87], v[120:123], a[236:239]
    v_mfma_f32_16x16x32_bf16 a[232:235], v[88:91], v[112:115], a[232:235]
    v_mfma_f32_16x16x32_bf16 a[236:239], v[88:91], v[116:119], a[236:239]
    v_mfma_f32_16x16x32_bf16 a[240:243], v[88:91], v[120:123], a[240:243]
    v_lshlrev_b32 v48, 5, v3
    s_waitcnt lgkmcnt(12)
    v_mfma_f32_16x16x32_bf16 a[236:239], v[80:83], v[124:127], a[236:239]
    v_lshl_add_u32 v49, v4, 3, v48
    v_mfma_f32_16x16x32_bf16 a[240:243], v[84:87], v[124:127], a[240:243]
    s_add_u32 s4, s19, 17144
    v_mfma_f32_16x16x32_bf16 a[244:247], v[88:91], v[124:127], a[244:247]
    v_sub_u32 v48, s4, v49
    v_mfma_f32_16x16x32_bf16 a[236:239], v[92:95], v[112:115], a[236:239]
    ds_read_b64 v[16:17], v48 offset:3584
    v_mfma_f32_16x16x32_bf16 a[240:243], v[92:95], v[116:119], a[240:243]
    ds_read_b64 v[18:19], v48 offset:3072
    v_mfma_f32_16x16x32_bf16 a[244:247], v[92:95], v[120:123], a[244:247]
    ds_read_b64 v[20:21], v48 offset:2560
    v_mfma_f32_16x16x32_bf16 a[248:251], v[92:95], v[124:127], a[248:251]
    ds_read_b64 v[22:23], v48 offset:2048
    s_waitcnt lgkmcnt(13)
    v_mfma_f32_16x16x32_bf16 a[240:243], v[80:83], v[128:131], a[240:243]
    ds_read_b64 v[24:25], v48 offset:1536
    v_mfma_f32_16x16x32_bf16 a[244:247], v[84:87], v[128:131], a[244:247]
    ds_read_b64 v[26:27], v48 offset:1024
    v_mfma_f32_16x16x32_bf16 a[248:251], v[88:91], v[128:131], a[248:251]
    ds_read_b64 v[28:29], v48 offset:512
    v_mfma_f32_16x16x32_bf16 a[252:255], v[92:95], v[128:131], a[252:255]
    ds_read_b64 v[30:31], v48 offset:0
    v_mfma_f32_16x16x32_bf16 a[240:243], v[96:99], v[112:115], a[240:243]
    s_add_u32 s4, s18, 5144576
    v_mfma_f32_16x16x32_bf16 a[244:247], v[96:99], v[116:119], a[244:247]
    v_mfma_f32_16x16x32_bf16 a[248:251], v[96:99], v[120:123], a[248:251]
    v_mfma_f32_16x16x32_bf16 a[252:255], v[96:99], v[124:127], a[252:255]
    s_waitcnt lgkmcnt(14)
    v_mfma_f32_16x16x32_bf16 a[244:247], v[80:83], v[132:135], a[244:247]
    v_mfma_f32_16x16x32_bf16 a[248:251], v[84:87], v[132:135], a[248:251]
    v_mfma_f32_16x16x32_bf16 a[252:255], v[88:91], v[132:135], a[252:255]
    v_mfma_f32_16x16x32_bf16 a[244:247], v[100:103], v[112:115], a[244:247]
    v_mfma_f32_16x16x32_bf16 a[248:251], v[100:103], v[116:119], a[248:251]
    v_mfma_f32_16x16x32_bf16 a[252:255], v[100:103], v[120:123], a[252:255]
    s_waitcnt lgkmcnt(11)
    v_mfma_f32_16x16x32_bf16 a[248:251], v[80:83], v[136:139], a[248:251]
    v_mfma_f32_16x16x32_bf16 a[252:255], v[84:87], v[136:139], a[252:255]
    v_mfma_f32_16x16x32_bf16 a[248:251], v[104:107], v[112:115], a[248:251]
    v_mfma_f32_16x16x32_bf16 a[252:255], v[104:107], v[116:119], a[252:255]
    s_waitcnt lgkmcnt(8)
    v_mfma_f32_16x16x32_bf16 a[252:255], v[80:83], v[140:143], a[252:255]
    v_mfma_f32_16x16x32_bf16 a[252:255], v[108:111], v[112:115], a[252:255]
    v_accvgpr_read_b32 v36, a224
    v_accvgpr_read_b32 v37, a225
    v_accvgpr_read_b32 v38, a226
    v_accvgpr_read_b32 v39, a227
    s_waitcnt lgkmcnt(7)
    v_and_b32 v32, s69, v17
    v_lshlrev_b32 v33, 16, v17
    v_and_b32 v34, s69, v16
    v_lshlrev_b32 v35, 16, v16
    v_fmac_f32 v36, s17, v32
    v_fmac_f32 v37, s17, v33
    v_fmac_f32 v38, s17, v34
    v_fmac_f32 v39, s17, v35
    v_cvt_pk_bf16_f32 v16, v36, v37
    v_cvt_pk_bf16_f32 v17, v38, v39
    v_min_u32 v16, -2, v16
    v_min_u32 v17, -2, v17
    buffer_store_dwordx2 v[16:17], v49, s[8:11], s4 offen offset:0 sc1
    v_accvgpr_read_b32 v44, a252
    v_accvgpr_read_b32 v45, a253
    v_accvgpr_read_b32 v46, a254
    v_accvgpr_read_b32 v47, a255
    s_waitcnt lgkmcnt(0)
    v_and_b32 v40, s69, v31
    v_lshlrev_b32 v41, 16, v31
    v_and_b32 v42, s69, v30
    v_lshlrev_b32 v43, 16, v30
    v_fmac_f32 v44, s17, v40
    v_fmac_f32 v45, s17, v41
    v_fmac_f32 v46, s17, v42
    v_fmac_f32 v47, s17, v43
    v_cvt_pk_bf16_f32 v30, v44, v45
    v_cvt_pk_bf16_f32 v31, v46, v47
    v_min_u32 v30, -2, v30
    v_min_u32 v31, -2, v31
    buffer_store_dwordx2 v[30:31], v49, s[8:11], s4 offen offset:3584 sc1
    v_accvgpr_read_b32 v44, a228
    v_accvgpr_read_b32 v45, a229
    v_accvgpr_read_b32 v46, a230
    v_accvgpr_read_b32 v47, a231
    v_and_b32 v40, s69, v19
    v_lshlrev_b32 v41, 16, v19
    v_and_b32 v42, s69, v18
    v_lshlrev_b32 v43, 16, v18
    v_fmac_f32 v44, s17, v40
    v_fmac_f32 v45, s17, v41
    v_fmac_f32 v46, s17, v42
    v_fmac_f32 v47, s17, v43
    v_cvt_pk_bf16_f32 v18, v44, v45
    v_cvt_pk_bf16_f32 v19, v46, v47
    v_min_u32 v18, -2, v18
    v_min_u32 v19, -2, v19
    buffer_store_dwordx2 v[18:19], v49, s[8:11], s4 offen offset:512 sc1
    v_accvgpr_read_b32 v36, a248
    v_accvgpr_read_b32 v37, a249
    v_accvgpr_read_b32 v38, a250
    v_accvgpr_read_b32 v39, a251
    v_and_b32 v32, s69, v29
    v_lshlrev_b32 v33, 16, v29
    v_and_b32 v34, s69, v28
    v_lshlrev_b32 v35, 16, v28
    v_fmac_f32 v36, s17, v32
    v_fmac_f32 v37, s17, v33
    v_fmac_f32 v38, s17, v34
    v_fmac_f32 v39, s17, v35
    v_cvt_pk_bf16_f32 v28, v36, v37
    v_cvt_pk_bf16_f32 v29, v38, v39
    v_min_u32 v28, -2, v28
    v_min_u32 v29, -2, v29
    buffer_store_dwordx2 v[28:29], v49, s[8:11], s4 offen offset:3072 sc1
    v_accvgpr_read_b32 v36, a232
    v_accvgpr_read_b32 v37, a233
    v_accvgpr_read_b32 v38, a234
    v_accvgpr_read_b32 v39, a235
    v_and_b32 v32, s69, v21
    v_lshlrev_b32 v33, 16, v21
    v_and_b32 v34, s69, v20
    v_lshlrev_b32 v35, 16, v20
    v_fmac_f32 v36, s17, v32
    v_fmac_f32 v37, s17, v33
    v_fmac_f32 v38, s17, v34
    v_fmac_f32 v39, s17, v35
    v_cvt_pk_bf16_f32 v20, v36, v37
    v_cvt_pk_bf16_f32 v21, v38, v39
    v_min_u32 v20, -2, v20
    v_min_u32 v21, -2, v21
    buffer_store_dwordx2 v[20:21], v49, s[8:11], s4 offen offset:1024 sc1
    v_accvgpr_read_b32 v44, a244
    v_accvgpr_read_b32 v45, a245
    v_accvgpr_read_b32 v46, a246
    v_accvgpr_read_b32 v47, a247
    v_and_b32 v40, s69, v27
    v_lshlrev_b32 v41, 16, v27
    v_and_b32 v42, s69, v26
    v_lshlrev_b32 v43, 16, v26
    v_fmac_f32 v44, s17, v40
    v_fmac_f32 v45, s17, v41
    v_fmac_f32 v46, s17, v42
    v_fmac_f32 v47, s17, v43
    v_cvt_pk_bf16_f32 v26, v44, v45
    v_cvt_pk_bf16_f32 v27, v46, v47
    v_min_u32 v26, -2, v26
    v_min_u32 v27, -2, v27
    buffer_store_dwordx2 v[26:27], v49, s[8:11], s4 offen offset:2560 sc1
    v_accvgpr_read_b32 v44, a236
    v_accvgpr_read_b32 v45, a237
    v_accvgpr_read_b32 v46, a238
    v_accvgpr_read_b32 v47, a239
    v_and_b32 v40, s69, v23
    v_lshlrev_b32 v41, 16, v23
    v_and_b32 v42, s69, v22
    v_lshlrev_b32 v43, 16, v22
    v_fmac_f32 v44, s17, v40
    v_fmac_f32 v45, s17, v41
    v_fmac_f32 v46, s17, v42
    v_fmac_f32 v47, s17, v43
    v_cvt_pk_bf16_f32 v22, v44, v45
    v_cvt_pk_bf16_f32 v23, v46, v47
    v_min_u32 v22, -2, v22
    v_min_u32 v23, -2, v23
    buffer_store_dwordx2 v[22:23], v49, s[8:11], s4 offen offset:1536 sc1
    v_accvgpr_read_b32 v36, a240
    v_accvgpr_read_b32 v37, a241
    v_accvgpr_read_b32 v38, a242
    v_accvgpr_read_b32 v39, a243
    v_and_b32 v32, s69, v25
    v_lshlrev_b32 v33, 16, v25
    v_and_b32 v34, s69, v24
    v_lshlrev_b32 v35, 16, v24
    v_fmac_f32 v36, s17, v32
    v_fmac_f32 v37, s17, v33
    v_fmac_f32 v38, s17, v34
    v_fmac_f32 v39, s17, v35
    v_cvt_pk_bf16_f32 v24, v36, v37
    v_cvt_pk_bf16_f32 v25, v38, v39
    v_min_u32 v24, -2, v24
    v_min_u32 v25, -2, v25
    buffer_store_dwordx2 v[24:25], v49, s[8:11], s4 offen offset:2048 sc1
    s_waitcnt vmcnt(8)
    s_nop 2
    s_branch KF_OP_CHK
KF_ONC:
    s_cmp_eq_u32 s25, 0
    s_cbranch_scc0 KF_OL2
    buffer_load_dwordx4 v[244:247], v237, s[72:75], s40 offen offset:0
    buffer_load_dwordx4 v[248:251], v237, s[72:75], s40 offen offset:32
    buffer_load_dwordx4 v[252:255], v237, s[72:75], s41 offen offset:64
    s_branch KF_OL1
KF_OL2:
    v_accvgpr_read_b32 v244, a224
    v_accvgpr_read_b32 v245, a225
    v_accvgpr_read_b32 v246, a226
    v_accvgpr_read_b32 v247, a227
    v_accvgpr_read_b32 v248, a228
    v_accvgpr_read_b32 v249, a229
    v_accvgpr_read_b32 v250, a230
    v_accvgpr_read_b32 v251, a231
    v_accvgpr_read_b32 v252, a232
    v_accvgpr_read_b32 v253, a233
    v_accvgpr_read_b32 v254, a234
    v_accvgpr_read_b32 v255, a235
    v_accvgpr_read_b32 v148, a236
    v_accvgpr_read_b32 v149, a237
    v_accvgpr_read_b32 v150, a238
    v_accvgpr_read_b32 v151, a239
    v_accvgpr_read_b32 v152, a240
    v_accvgpr_read_b32 v153, a241
    v_accvgpr_read_b32 v154, a242
    v_accvgpr_read_b32 v155, a243
    v_accvgpr_read_b32 v156, a244
    v_accvgpr_read_b32 v157, a245
    v_accvgpr_read_b32 v158, a246
    v_accvgpr_read_b32 v159, a247
    v_lshlrev_b32 v200, 16, v148
    v_and_b32 v201, s69, v148
    v_lshlrev_b32 v202, 16, v149
    v_and_b32 v203, s69, v149
    v_lshlrev_b32 v204, 16, v150
    v_and_b32 v205, s69, v150
    v_lshlrev_b32 v206, 16, v151
    v_and_b32 v207, s69, v151
    v_lshlrev_b32 v208, 16, v152
    v_and_b32 v209, s69, v152
    v_lshlrev_b32 v210, 16, v153
    v_and_b32 v211, s69, v153
    v_lshlrev_b32 v212, 16, v154
    v_and_b32 v213, s69, v154
    v_lshlrev_b32 v214, 16, v155
    v_and_b32 v215, s69, v155
    v_lshlrev_b32 v216, 16, v156
    v_and_b32 v217, s69, v156
    v_lshlrev_b32 v218, 16, v157
    v_and_b32 v219, s69, v157
    v_lshlrev_b32 v220, 16, v158
    v_and_b32 v221, s69, v158
    v_lshlrev_b32 v222, 16, v159
    v_and_b32 v223, s69, v159
    s_nop 4
KF_OL1:
    s_lshl_b32 s4, s3, 11
    s_add_u32 s4, s4, 155648
    s_cmp_eq_u32 s3, 0
    s_cselect_b32 s4, 154624, s4
    v_add_u32 v11, s4, v2
    v_lshrrev_b32 v12, 1, v4
    v_lshlrev_b32 v12, 3, v12
    v_lshrrev_b32 v13, 2, v3
    v_add_u32 v12, v12, v13
    v_lshlrev_b32 v12, 6, v12
    v_and_b32 v13, 1, v4
    v_lshl_add_u32 v12, v13, 5, v12
    v_and_b32 v13, 3, v3
    v_lshl_add_u32 v12, v13, 3, v12
    v_add_u32 v12, s4, v12
    v_and_b32 v8, 31, v1
    v_lshrrev_b32 v7, 5, v1
    v_lshlrev_b32 v13, 3, v8
    v_add_u32 v14, 153600, v13
    s_lshl_b32 s4, s3, 8
    v_add_u32 v15, s4, v14
    v_add_u32 v234, s61, v7
    v_add_u32 v232, 1, v234
    v_and_b32 v232, 3, v232
    v_lshl_add_u32 v232, v232, 8, v13
    v_add_u32 v233, 3, v234
    v_and_b32 v233, 3, v233
    v_lshl_add_u32 v233, v233, 8, v13
    s_sleep 6
    s_nop 3
KF_OP:
    buffer_load_dwordx4 v[160:163], v2, s[8:11], s45 offen offset:0 sc1
    buffer_load_dwordx4 v[164:167], v2, s[8:11], s45 offen offset:1024 sc1
    buffer_load_dwordx4 v[168:171], v2, s[8:11], s45 offen offset:2048 sc1
    buffer_load_dwordx4 v[172:175], v2, s[8:11], s45 offen offset:3072 sc1
    buffer_load_dwordx4 v[176:179], v2, s[8:11], s46 offen offset:0 sc1
    buffer_load_dwordx4 v[180:183], v2, s[8:11], s46 offen offset:1024 sc1
    buffer_load_dwordx4 v[184:187], v2, s[8:11], s46 offen offset:2048 sc1
    buffer_load_dwordx4 v[188:191], v2, s[8:11], s46 offen offset:3072 sc1
    buffer_load_dwordx4 v[192:195], v2, s[8:11], s47 offen offset:0 sc1
    s_waitcnt vmcnt(0)
KF_OP_CHK:
    v_max_u32 v234, v160, v161
    v_max3_u32 v234, v234, v162, v163
    v_max3_u32 v234, v234, v164, v165
    v_max3_u32 v234, v234, v166, v167
    v_max3_u32 v234, v234, v168, v169
    v_max3_u32 v234, v234, v170, v171
    v_max3_u32 v234, v234, v172, v173
    v_max3_u32 v234, v234, v174, v175
    v_max3_u32 v234, v234, v176, v177
    v_max3_u32 v234, v234, v178, v179
    v_max3_u32 v234, v234, v180, v181
    v_max3_u32 v234, v234, v182, v183
    v_max3_u32 v234, v234, v184, v185
    v_max3_u32 v234, v234, v186, v187
    v_max3_u32 v234, v234, v188, v189
    v_max3_u32 v234, v234, v190, v191
    v_max3_u32 v234, v234, v192, v193
    v_max3_u32 v234, v234, v194, v195
    v_cmp_eq_u32 vcc, -1, v234
    s_sub_u32 s68, s68, 1
    s_cselect_b64 s[36:37], 0, vcc
    s_cselect_b32 s68, 0, s68
    s_cmp_eq_u64 s[36:37], 0
    s_cbranch_scc1 KF_OP_GO
    s_sleep 3
    s_branch KF_OP
KF_OP_GO:
    ds_write_b128 v236, v[160:163] offset:0
    ds_write_b128 v236, v[164:167] offset:1024
    ds_write_b128 v236, v[168:171] offset:2048
    ds_write_b128 v236, v[172:175] offset:3072
    ds_write_b128 v236, v[176:179] offset:4096
    ds_write_b128 v236, v[180:183] offset:5120
    ds_write_b128 v236, v[184:187] offset:6144
    ds_write_b128 v236, v[188:191] offset:7168
    ds_write_b128 v236, v[192:195] offset:8192
    s_waitcnt lgkmcnt(0)
    s_barrier
    s_cmp_eq_u32 s25, 0
    s_cbranch_scc0 KF_T2
    s_cmp_eq_u32 s3, 0
    s_cbranch_scc1 KF_TA0
    ds_read_b128 v[108:111], v2 offset:0
    ds_read_b128 v[112:115], v2 offset:18432
    s_waitcnt lgkmcnt(1)
    v_mfma_f32_16x16x32_bf16 v[124:127], a[56:59], v[108:111], 0
    ds_read_b128 v[116:119], v2 offset:1024
    v_mov_b32 v20, -1
    v_mov_b32 v21, -1
    v_mov_b32 v22, -1
    v_mov_b32 v23, -1
    s_lshl_b32 s6, s20, 4
    s_add_u32 s6, s6, s21
    s_lshl_b32 s6, s6, 2
    s_add_u32 s6, s6, s3
    s_mul_i32 s6, s6, 2304
    s_add_u32 s6, s6, 9863168
    buffer_store_dwordx4 v[20:23], v2, s[8:11], s6 offen offset:0 sc1
    buffer_store_dwordx4 v[20:23], v2, s[8:11], s6 offen offset:1024 sc1
    s_mov_b64 exec, 0xffff
    buffer_store_dwordx4 v[20:23], v2, s[8:11], s6 offen offset:2048 sc1
    s_mov_b64 exec, -1
    s_waitcnt lgkmcnt(1)
    v_mfma_f32_16x16x32_bf16 v[128:131], a[56:59], v[112:115], 0
    ds_read_b128 v[120:123], v2 offset:19456
    v_mfma_f32_16x16x32_bf16 v[132:135], a[128:131], v[108:111], 0
    v_lshlrev_b32 v52, 16, v244
    s_add_u32 s30, s29, 86016
    s_add_u32 s31, s28, 86016
    s_mov_b32 m0, s30
    s_nop 0
    buffer_load_dwordx4 v2, s[8:11], s31 offen offset:0 lds
    v_mfma_f32_16x16x32_bf16 v[136:139], a[128:131], v[112:115], 0
    v_and_b32 v53, s69, v244
    s_waitcnt lgkmcnt(1)
    v_mfma_f32_16x16x32_bf16 v[124:127], a[60:63], v[116:119], v[124:127]
    ds_read_b128 v[108:111], v2 offset:2048
    buffer_load_dwordx4 v2, s[8:11], s31 offen offset:1024 lds
    s_waitcnt lgkmcnt(1)
    v_mfma_f32_16x16x32_bf16 v[128:131], a[60:63], v[120:123], v[128:131]
    ds_read_b128 v[112:115], v2 offset:20480
    v_mfma_f32_16x16x32_bf16 v[132:135], a[132:135], v[116:119], v[132:135]
    v_lshlrev_b32 v54, 16, v245
    buffer_load_dwordx4 v2, s[8:11], s31 offen offset:2048 lds
    v_mfma_f32_16x16x32_bf16 v[136:139], a[132:135], v[120:123], v[136:139]
    v_and_b32 v55, s69, v245
    s_waitcnt lgkmcnt(1)
    v_mfma_f32_16x16x32_bf16 v[124:127], a[64:67], v[108:111], v[124:127]
    ds_read_b128 v[116:119], v2 offset:3072
    buffer_load_dwordx4 v2, s[8:11], s31 offen offset:3072 lds
    s_waitcnt lgkmcnt(1)
    v_mfma_f32_16x16x32_bf16 v[128:131], a[64:67], v[112:115], v[128:131]
    ds_read_b128 v[120:123], v2 offset:21504
    v_mfma_f32_16x16x32_bf16 v[132:135], a[136:139], v[108:111], v[132:135]
    v_lshlrev_b32 v56, 16, v246
    s_add_u32 s30, s30, 4096
    s_add_u32 s31, s31, 4096
    s_mov_b32 m0, s30
    s_nop 0
    buffer_load_dwordx4 v2, s[8:11], s31 offen offset:0 lds
    v_mfma_f32_16x16x32_bf16 v[136:139], a[136:139], v[112:115], v[136:139]
    v_and_b32 v57, s69, v246
    s_waitcnt lgkmcnt(1)
    v_mfma_f32_16x16x32_bf16 v[124:127], a[68:71], v[116:119], v[124:127]
    ds_read_b128 v[108:111], v2 offset:4096
    s_mov_b64 exec, 0xffff
    buffer_load_dwordx4 v2, s[8:11], s31 offen offset:1024 lds
    s_mov_b64 exec, -1
    s_waitcnt lgkmcnt(1)
    v_mfma_f32_16x16x32_bf16 v[128:131], a[68:71], v[120:123], v[128:131]
    ds_read_b128 v[112:115], v2 offset:22528
    v_mfma_f32_16x16x32_bf16 v[132:135], a[140:143], v[116:119], v[132:135]
    v_lshlrev_b32 v58, 16, v247
    s_add_u32 s30, s29, 107520
    s_add_u32 s31, s28, 107520
    s_mov_b32 m0, s30
    s_nop 0
    buffer_load_dwordx4 v2, s[8:11], s31 offen offset:0 lds
    v_mfma_f32_16x16x32_bf16 v[136:139], a[140:143], v[120:123], v[136:139]
    v_and_b32 v59, s69, v247
    s_waitcnt lgkmcnt(1)
    v_mfma_f32_16x16x32_bf16 v[124:127], a[72:75], v[108:111], v[124:127]
    ds_read_b128 v[116:119], v2 offset:5120
    buffer_load_dwordx4 v2, s[8:11], s31 offen offset:1024 lds
    s_waitcnt lgkmcnt(1)
    v_mfma_f32_16x16x32_bf16 v[128:131], a[72:75], v[112:115], v[128:131]
    ds_read_b128 v[120:123], v2 offset:23552
    v_mfma_f32_16x16x32_bf16 v[132:135], a[144:147], v[108:111], v[132:135]
    v_lshlrev_b32 v60, 16, v248
    buffer_load_dwordx4 v2, s[8:11], s31 offen offset:2048 lds
    v_mfma_f32_16x16x32_bf16 v[136:139], a[144:147], v[112:115], v[136:139]
    v_and_b32 v61, s69, v248
    s_waitcnt lgkmcnt(1)
    v_mfma_f32_16x16x32_bf16 v[124:127], a[76:79], v[116:119], v[124:127]
    ds_read_b128 v[108:111], v2 offset:6144
    buffer_load_dwordx4 v2, s[8:11], s31 offen offset:3072 lds
    s_waitcnt lgkmcnt(1)
    v_mfma_f32_16x16x32_bf16 v[128:131], a[76:79], v[120:123], v[128:131]
    ds_read_b128 v[112:115], v2 offset:24576
    v_mfma_f32_16x16x32_bf16 v[132:135], a[148:151], v[116:119], v[132:135]
    v_lshlrev_b32 v62, 16, v249
    s_add_u32 s30, s30, 4096
    s_add_u32 s31, s31, 4096
    s_mov_b32 m0, s30
    s_nop 0
    buffer_load_dwordx4 v2, s[8:11], s31 offen offset:0 lds
    v_mfma_f32_16x16x32_bf16 v[136:139], a[148:151], v[120:123], v[136:139]
    v_and_b32 v63, s69, v249
    s_waitcnt lgkmcnt(1)
    v_mfma_f32_16x16x32_bf16 v[124:127], a[80:83], v[108:111], v[124:127]
    ds_read_b128 v[116:119], v2 offset:7168
    s_mov_b64 exec, 0xffff
    buffer_load_dwordx4 v2, s[8:11], s31 offen offset:1024 lds
    s_mov_b64 exec, -1
    s_waitcnt lgkmcnt(1)
    v_mfma_f32_16x16x32_bf16 v[128:131], a[80:83], v[112:115], v[128:131]
    ds_read_b128 v[120:123], v2 offset:25600
    v_mfma_f32_16x16x32_bf16 v[132:135], a[152:155], v[108:111], v[132:135]
    v_lshlrev_b32 v64, 16, v250
    s_add_u32 s30, s29, 129024
    s_add_u32 s31, s28, 0
    s_mov_b32 m0, s30
    s_nop 0
    buffer_load_dwordx4 v2, s[8:11], s31 offen offset:0 lds
    v_mfma_f32_16x16x32_bf16 v[136:139], a[152:155], v[112:115], v[136:139]
    v_and_b32 v65, s69, v250
    s_waitcnt lgkmcnt(1)
    v_mfma_f32_16x16x32_bf16 v[124:127], a[84:87], v[116:119], v[124:127]
    ds_read_b128 v[108:111], v2 offset:8192
    buffer_load_dwordx4 v2, s[8:11], s31 offen offset:1024 lds
    s_waitcnt lgkmcnt(1)
    v_mfma_f32_16x16x32_bf16 v[128:131], a[84:87], v[120:123], v[128:131]
    ds_read_b128 v[112:115], v2 offset:26624
    v_mfma_f32_16x16x32_bf16 v[132:135], a[156:159], v[116:119], v[132:135]
    v_lshlrev_b32 v66, 16, v251
    buffer_load_dwordx4 v2, s[8:11], s31 offen offset:2048 lds
    v_mfma_f32_16x16x32_bf16 v[136:139], a[156:159], v[120:123], v[136:139]
    v_and_b32 v67, s69, v251
    s_waitcnt lgkmcnt(1)
    v_mfma_f32_16x16x32_bf16 v[124:127], a[88:91], v[108:111], v[124:127]
    ds_read_b128 v[116:119], v2 offset:9216
    buffer_load_dwordx4 v2, s[8:11], s31 offen offset:3072 lds
    s_waitcnt lgkmcnt(1)
    v_mfma_f32_16x16x32_bf16 v[128:131], a[88:91], v[112:115], v[128:131]
    ds_read_b128 v[120:123], v2 offset:27648
    v_mfma_f32_16x16x32_bf16 v[132:135], a[160:163], v[108:111], v[132:135]
    s_add_u32 s30, s30, 4096
    s_add_u32 s31, s31, 4096
    s_mov_b32 m0, s30
    s_nop 0
    buffer_load_dwordx4 v2, s[8:11], s31 offen offset:0 lds
    v_mfma_f32_16x16x32_bf16 v[136:139], a[160:163], v[112:115], v[136:139]
    s_waitcnt lgkmcnt(1)
    v_mfma_f32_16x16x32_bf16 v[124:127], a[92:95], v[116:119], v[124:127]
    ds_read_b128 v[108:111], v2 offset:10240
    s_mov_b64 exec, 0xffff
    buffer_load_dwordx4 v2, s[8:11], s31 offen offset:1024 lds
    s_mov_b64 exec, -1
    s_waitcnt lgkmcnt(1)
    v_mfma_f32_16x16x32_bf16 v[128:131], a[92:95], v[120:123], v[128:131]
    ds_read_b128 v[112:115], v2 offset:28672
    v_mfma_f32_16x16x32_bf16 v[132:135], a[164:167], v[116:119], v[132:135]
    v_mfma_f32_16x16x32_bf16 v[136:139], a[164:167], v[120:123], v[136:139]
    s_waitcnt lgkmcnt(1)
    v_mfma_f32_16x16x32_bf16 v[124:127], a[96:99], v[108:111], v[124:127]
    ds_read_b128 v[116:119], v2 offset:11264
    s_waitcnt lgkmcnt(1)
    v_mfma_f32_16x16x32_bf16 v[128:131], a[96:99], v[112:115], v[128:131]
    ds_read_b128 v[120:123], v2 offset:29696
    v_mfma_f32_16x16x32_bf16 v[132:135], a[168:171], v[108:111], v[132:135]
    v_mfma_f32_16x16x32_bf16 v[136:139], a[168:171], v[112:115], v[136:139]
    s_waitcnt lgkmcnt(1)
    v_mfma_f32_16x16x32_bf16 v[124:127], a[100:103], v[116:119], v[124:127]
    ds_read_b128 v[108:111], v2 offset:12288
    s_waitcnt lgkmcnt(1)
    v_mfma_f32_16x16x32_bf16 v[128:131], a[100:103], v[120:123], v[128:131]
    ds_read_b128 v[112:115], v2 offset:30720
    v_mfma_f32_16x16x32_bf16 v[132:135], a[172:175], v[116:119], v[132:135]
    v_mfma_f32_16x16x32_bf16 v[136:139], a[172:175], v[120:123], v[136:139]
    s_waitcnt lgkmcnt(1)
    v_mfma_f32_16x16x32_bf16 v[124:127], a[104:107], v[108:111], v[124:127]
    ds_read_b128 v[116:119], v2 offset:13312
    s_waitcnt lgkmcnt(1)
    v_mfma_f32_16x16x32_bf16 v[128:131], a[104:107], v[112:115], v[128:131]
    ds_read_b128 v[120:123], v2 offset:31744
    v_mfma_f32_16x16x32_bf16 v[132:135], a[176:179], v[108:111], v[132:135]
    v_mfma_f32_16x16x32_bf16 v[136:139], a[176:179], v[112:115], v[136:139]
    s_waitcnt lgkmcnt(1)
    v_mfma_f32_16x16x32_bf16 v[124:127], a[108:111], v[116:119], v[124:127]
    ds_read_b128 v[108:111], v2 offset:14336
    buffer_load_dwordx4 v[184:187], v10, s[8:11], s42 offen sc1
    s_waitcnt lgkmcnt(1)
    v_mfma_f32_16x16x32_bf16 v[128:131], a[108:111], v[120:123], v[128:131]
    ds_read_b128 v[112:115], v2 offset:32768
    buffer_load_dwordx4 v[188:191], v10, s[8:11], s43 offen sc1
    v_mfma_f32_16x16x32_bf16 v[132:135], a[180:183], v[116:119], v[132:135]
    v_mfma_f32_16x16x32_bf16 v[136:139], a[180:183], v[120:123], v[136:139]
    s_waitcnt lgkmcnt(1)
    v_mfma_f32_16x16x32_bf16 v[124:127], a[112:115], v[108:111], v[124:127]
    ds_read_b128 v[116:119], v2 offset:15360
    s_waitcnt lgkmcnt(1)
    v_mfma_f32_16x16x32_bf16 v[128:131], a[112:115], v[112:115], v[128:131]
    ds_read_b128 v[120:123], v2 offset:33792
    v_mfma_f32_16x16x32_bf16 v[132:135], a[184:187], v[108:111], v[132:135]
    v_mfma_f32_16x16x32_bf16 v[136:139], a[184:187], v[112:115], v[136:139]
    s_waitcnt lgkmcnt(1)
    v_mfma_f32_16x16x32_bf16 v[124:127], a[116:119], v[116:119], v[124:127]
    ds_read_b128 v[108:111], v2 offset:16384
    s_waitcnt lgkmcnt(1)
    v_mfma_f32_16x16x32_bf16 v[128:131], a[116:119], v[120:123], v[128:131]
    ds_read_b128 v[112:115], v2 offset:34816
    v_mfma_f32_16x16x32_bf16 v[132:135], a[188:191], v[116:119], v[132:135]
    v_mfma_f32_16x16x32_bf16 v[136:139], a[188:191], v[120:123], v[136:139]
    s_waitcnt lgkmcnt(1)
    v_mfma_f32_16x16x32_bf16 v[124:127], a[120:123], v[108:111], v[124:127]
    ds_read_b128 v[116:119], v2 offset:17408
    s_waitcnt lgkmcnt(1)
    v_mfma_f32_16x16x32_bf16 v[128:131], a[120:123], v[112:115], v[128:131]
    ds_read_b128 v[120:123], v2 offset:35840
    v_mfma_f32_16x16x32_bf16 v[132:135], a[192:195], v[108:111], v[132:135]
    v_mfma_f32_16x16x32_bf16 v[136:139], a[192:195], v[112:115], v[136:139]
    s_waitcnt lgkmcnt(1)
    v_mfma_f32_16x16x32_bf16 v[124:127], a[124:127], v[116:119], v[124:127]
    s_waitcnt lgkmcnt(0)
    v_mfma_f32_16x16x32_bf16 v[128:131], a[124:127], v[120:123], v[128:131]
    v_mfma_f32_16x16x32_bf16 v[132:135], a[196:199], v[116:119], v[132:135]
    v_mfma_f32_16x16x32_bf16 v[136:139], a[196:199], v[120:123], v[136:139]
    s_nop 5
    v_permlane16_swap_b32 v124, v128
    v_permlane16_swap_b32 v125, v129
    v_permlane16_swap_b32 v126, v130
    v_permlane16_swap_b32 v127, v131
    v_pk_add_f32 v[124:125], v[124:125], v[52:53]
    v_pk_add_f32 v[126:127], v[126:127], v[54:55]
    v_pk_add_f32 v[128:129], v[128:129], v[56:57]
    v_pk_add_f32 v[130:131], v[130:131], v[58:59]
    v_permlane16_swap_b32 v132, v136
    v_permlane16_swap_b32 v133, v137
    v_permlane16_swap_b32 v134, v138
    v_permlane16_swap_b32 v135, v139
    v_pk_add_f32 v[132:133], v[132:133], v[60:61]
    v_pk_add_f32 v[134:135], v[134:135], v[62:63]
    v_pk_add_f32 v[136:137], v[136:137], v[64:65]
    v_pk_add_f32 v[138:139], v[138:139], v[66:67]
    v_pk_mul_f32 v[170:171], v[124:125], v[124:125]
    v_pk_add_f32 v[168:169], v[124:125], v[126:127]
    v_pk_fma_f32 v[170:171], v[126:127], v[126:127], v[170:171]
    v_pk_fma_f32 v[170:171], v[128:129], v[128:129], v[170:171]
    v_pk_add_f32 v[168:169], v[168:169], v[128:129]
    v_pk_fma_f32 v[170:171], v[130:131], v[130:131], v[170:171]
    v_pk_add_f32 v[168:169], v[168:169], v[130:131]
    v_pk_fma_f32 v[170:171], v[132:133], v[132:133], v[170:171]
    v_pk_add_f32 v[168:169], v[168:169], v[132:133]
    v_pk_fma_f32 v[170:171], v[134:135], v[134:135], v[170:171]
    v_pk_add_f32 v[168:169], v[168:169], v[134:135]
    v_pk_fma_f32 v[170:171], v[136:137], v[136:137], v[170:171]
    v_pk_add_f32 v[168:169], v[168:169], v[136:137]
    v_pk_fma_f32 v[170:171], v[138:139], v[138:139], v[170:171]
    v_pk_add_f32 v[168:169], v[168:169], v[138:139]
    v_add_f32 v168, v168, v169
    v_add_f32 v169, v170, v171
    v_mov_b32 v170, v168
    v_mov_b32 v171, v169
    s_nop 0
    v_permlane32_swap_b32 v168, v170
    v_permlane32_swap_b32 v169, v171
    v_pk_add_f32 v[168:169], v[168:169], v[170:171]
    ds_write_b64 v15, v[168:169]
    s_waitcnt lgkmcnt(0)
    s_barrier
    s_waitcnt vmcnt(0)
    s_nop 0
    s_branch KF_B0_YP_CHK
KF_B0_YP:
    buffer_load_dwordx4 v[184:187], v10, s[8:11], s42 offen sc1
    buffer_load_dwordx4 v[188:191], v10, s[8:11], s43 offen sc1
    s_waitcnt vmcnt(0)
KF_B0_YP_CHK:
    v_max_u32 v234, v184, v185
    v_max3_u32 v234, v234, v186, v187
    v_max3_u32 v234, v234, v188, v189
    v_max3_u32 v234, v234, v190, v191
    v_cmp_eq_u32 vcc, -1, v234
    s_sub_u32 s68, s68, 1
    s_cselect_b64 s[36:37], 0, vcc
    s_cselect_b32 s68, 0, s68
    s_cmp_eq_u64 s[36:37], 0
    s_cbranch_scc1 KF_B0_YP_GO
    s_sleep 3
    s_branch KF_B0_YP
KF_B0_YP_GO:
    ds_write_b128 v11, v[184:187] offset:0
    ds_write_b128 v11, v[188:191] offset:1024
    ds_read_b64_tr_b16 v[148:149], v12 offset:0
    ds_read_b64_tr_b16 v[150:151], v12 offset:256
    ds_read_b64_tr_b16 v[152:153], v12 offset:1024
    ds_read_b64_tr_b16 v[154:155], v12 offset:1280
    s_waitcnt lgkmcnt(3)
    v_lshlrev_b32 v200, 16, v148
    v_and_b32 v201, s69, v148
    v_lshlrev_b32 v202, 16, v149
    v_and_b32 v203, s69, v149
    s_waitcnt lgkmcnt(2)
    v_lshlrev_b32 v204, 16, v150
    v_and_b32 v205, s69, v150
    v_lshlrev_b32 v206, 16, v151
    v_and_b32 v207, s69, v151
    s_waitcnt lgkmcnt(1)
    v_lshlrev_b32 v208, 16, v152
    v_and_b32 v209, s69, v152
    v_lshlrev_b32 v210, 16, v153
    v_and_b32 v211, s69, v153
    s_waitcnt lgkmcnt(0)
    v_lshlrev_b32 v212, 16, v154
    v_and_b32 v213, s69, v154
    v_lshlrev_b32 v214, 16, v155
    v_and_b32 v215, s69, v155
    s_barrier
    ds_read_b64 v[238:239], v14
    s_waitcnt lgkmcnt(0)
    v_pk_fma_f32 v[244:245], v[124:125], v[238:239], v[238:239] op_sel:[0,1,0] op_sel_hi:[1,1,0] neg_lo:[0,0,1] neg_hi:[0,0,1]
    v_pk_fma_f32 v[124:125], v[244:245], v[200:201], v[124:125]
    v_pk_fma_f32 v[246:247], v[126:127], v[238:239], v[238:239] op_sel:[0,1,0] op_sel_hi:[1,1,0] neg_lo:[0,0,1] neg_hi:[0,0,1]
    v_pk_fma_f32 v[126:127], v[246:247], v[202:203], v[126:127]
    v_pk_fma_f32 v[248:249], v[128:129], v[238:239], v[238:239] op_sel:[0,1,0] op_sel_hi:[1,1,0] neg_lo:[0,0,1] neg_hi:[0,0,1]
    v_pk_fma_f32 v[128:129], v[248:249], v[204:205], v[128:129]
    v_pk_fma_f32 v[250:251], v[130:131], v[238:239], v[238:239] op_sel:[0,1,0] op_sel_hi:[1,1,0] neg_lo:[0,0,1] neg_hi:[0,0,1]
    v_pk_fma_f32 v[130:131], v[250:251], v[206:207], v[130:131]
    v_cvt_pk_bf16_f32 v176, v124, v125
    v_cvt_pk_bf16_f32 v177, v126, v127
    v_cvt_pk_bf16_f32 v178, v128, v129
    v_cvt_pk_bf16_f32 v179, v130, v131
    v_min_u32 v176, -2, v176
    v_min_u32 v177, -2, v177
    v_min_u32 v178, -2, v178
    v_min_u32 v179, -2, v179
    buffer_store_dwordx4 v[176:179], v9, s[8:11], s48 offen offset:0 sc1
    v_pk_fma_f32 v[244:245], v[132:133], v[238:239], v[238:239] op_sel:[0,1,0] op_sel_hi:[1,1,0] neg_lo:[0,0,1] neg_hi:[0,0,1]
    v_pk_fma_f32 v[132:133], v[244:245], v[208:209], v[132:133]
    v_pk_fma_f32 v[246:247], v[134:135], v[238:239], v[238:239] op_sel:[0,1,0] op_sel_hi:[1,1,0] neg_lo:[0,0,1] neg_hi:[0,0,1]
    v_pk_fma_f32 v[134:135], v[246:247], v[210:211], v[134:135]
    v_pk_fma_f32 v[248:249], v[136:137], v[238:239], v[238:239] op_sel:[0,1,0] op_sel_hi:[1,1,0] neg_lo:[0,0,1] neg_hi:[0,0,1]
    v_pk_fma_f32 v[136:137], v[248:249], v[212:213], v[136:137]
    v_pk_fma_f32 v[250:251], v[138:139], v[238:239], v[238:239] op_sel:[0,1,0] op_sel_hi:[1,1,0] neg_lo:[0,0,1] neg_hi:[0,0,1]
    v_pk_fma_f32 v[138:139], v[250:251], v[214:215], v[138:139]
    v_cvt_pk_bf16_f32 v180, v132, v133
    v_cvt_pk_bf16_f32 v181, v134, v135
    v_cvt_pk_bf16_f32 v182, v136, v137
    v_cvt_pk_bf16_f32 v183, v138, v139
    v_min_u32 v180, -2, v180
    v_min_u32 v181, -2, v181
    v_min_u32 v182, -2, v182
    v_min_u32 v183, -2, v183
    buffer_store_dwordx4 v[180:183], v9, s[8:11], s48 offen offset:512 sc1
    s_nop 3
    s_branch KF_NEXT
KF_TA0:
    ds_read_b128 v[108:111], v2 offset:0
    ds_read_b128 v[112:115], v2 offset:18432
    s_waitcnt lgkmcnt(1)
    v_mfma_f32_16x16x32_bf16 v[124:127], a[56:59], v[108:111], 0
    ds_read_b128 v[116:119], v2 offset:1024
    v_mov_b32 v20, -1
    v_mov_b32 v21, -1
    v_mov_b32 v22, -1
    v_mov_b32 v23, -1
    s_lshl_b32 s6, s20, 4
    s_add_u32 s6, s6, s21
    s_lshl_b32 s6, s6, 2
    s_add_u32 s6, s6, s3
    s_mul_i32 s6, s6, 2304
    s_add_u32 s6, s6, 9863168
    buffer_store_dwordx4 v[20:23], v2, s[8:11], s6 offen offset:0 sc1
    buffer_store_dwordx4 v[20:23], v2, s[8:11], s6 offen offset:1024 sc1
    s_mov_b64 exec, 0xffff
    buffer_store_dwordx4 v[20:23], v2, s[8:11], s6 offen offset:2048 sc1
    s_mov_b64 exec, -1
    s_waitcnt lgkmcnt(1)
    v_mfma_f32_16x16x32_bf16 v[128:131], a[56:59], v[112:115], 0
    ds_read_b128 v[120:123], v2 offset:19456
    v_mfma_f32_16x16x32_bf16 v[132:135], a[128:131], v[108:111], 0
    v_lshlrev_b32 v52, 16, v244
    s_add_u32 s30, s29, 86016
    s_add_u32 s31, s28, 86016
    s_mov_b32 m0, s30
    s_nop 0
    buffer_load_dwordx4 v2, s[8:11], s31 offen offset:0 lds
    v_mfma_f32_16x16x32_bf16 v[136:139], a[128:131], v[112:115], 0
    v_and_b32 v53, s69, v244
    v_mfma_f32_16x16x32_bf16 v[140:143], a[200:203], v[108:111], 0
    v_lshlrev_b32 v54, 16, v245
    v_mfma_f32_16x16x32_bf16 v[144:147], a[200:203], v[112:115], 0
    v_and_b32 v55, s69, v245
    s_waitcnt lgkmcnt(1)
    v_mfma_f32_16x16x32_bf16 v[124:127], a[60:63], v[116:119], v[124:127]
    ds_read_b128 v[108:111], v2 offset:2048
    buffer_load_dwordx4 v2, s[8:11], s31 offen offset:1024 lds
    s_waitcnt lgkmcnt(1)
    v_mfma_f32_16x16x32_bf16 v[128:131], a[60:63], v[120:123], v[128:131]
    ds_read_b128 v[112:115], v2 offset:20480
    v_mfma_f32_16x16x32_bf16 v[132:135], a[132:135], v[116:119], v[132:135]
    v_lshlrev_b32 v56, 16, v246
    buffer_load_dwordx4 v2, s[8:11], s31 offen offset:2048 lds
    v_mfma_f32_16x16x32_bf16 v[136:139], a[132:135], v[120:123], v[136:139]
    v_and_b32 v57, s69, v246
    v_mfma_f32_16x16x32_bf16 v[140:143], a[204:207], v[116:119], v[140:143]
    v_lshlrev_b32 v58, 16, v247
    v_mfma_f32_16x16x32_bf16 v[144:147], a[204:207], v[120:123], v[144:147]
    v_and_b32 v59, s69, v247
    s_waitcnt lgkmcnt(1)
    v_mfma_f32_16x16x32_bf16 v[124:127], a[64:67], v[108:111], v[124:127]
    ds_read_b128 v[116:119], v2 offset:3072
    buffer_load_dwordx4 v2, s[8:11], s31 offen offset:3072 lds
    s_waitcnt lgkmcnt(1)
    v_mfma_f32_16x16x32_bf16 v[128:131], a[64:67], v[112:115], v[128:131]
    ds_read_b128 v[120:123], v2 offset:21504
    v_mfma_f32_16x16x32_bf16 v[132:135], a[136:139], v[108:111], v[132:135]
    v_lshlrev_b32 v60, 16, v248
    s_add_u32 s30, s30, 4096
    s_add_u32 s31, s31, 4096
    s_mov_b32 m0, s30
    s_nop 0
    buffer_load_dwordx4 v2, s[8:11], s31 offen offset:0 lds
    v_mfma_f32_16x16x32_bf16 v[136:139], a[136:139], v[112:115], v[136:139]
    v_and_b32 v61, s69, v248
    v_mfma_f32_16x16x32_bf16 v[140:143], a[208:211], v[108:111], v[140:143]
    v_lshlrev_b32 v62, 16, v249
    v_mfma_f32_16x16x32_bf16 v[144:147], a[208:211], v[112:115], v[144:147]
    v_and_b32 v63, s69, v249
    s_waitcnt lgkmcnt(1)
    v_mfma_f32_16x16x32_bf16 v[124:127], a[68:71], v[116:119], v[124:127]
    ds_read_b128 v[108:111], v2 offset:4096
    s_mov_b64 exec, 0xffff
    buffer_load_dwordx4 v2, s[8:11], s31 offen offset:1024 lds
    s_mov_b64 exec, -1
    s_waitcnt lgkmcnt(1)
    v_mfma_f32_16x16x32_bf16 v[128:131], a[68:71], v[120:123], v[128:131]
    ds_read_b128 v[112:115], v2 offset:22528
    v_mfma_f32_16x16x32_bf16 v[132:135], a[140:143], v[116:119], v[132:135]
    v_lshlrev_b32 v64, 16, v250
    s_add_u32 s30, s29, 107520
    s_add_u32 s31, s28, 107520
    s_mov_b32 m0, s30
    s_nop 0
    buffer_load_dwordx4 v2, s[8:11], s31 offen offset:0 lds
    v_mfma_f32_16x16x32_bf16 v[136:139], a[140:143], v[120:123], v[136:139]
    v_and_b32 v65, s69, v250
    v_mfma_f32_16x16x32_bf16 v[140:143], a[212:215], v[116:119], v[140:143]
    v_lshlrev_b32 v66, 16, v251
    v_mfma_f32_16x16x32_bf16 v[144:147], a[212:215], v[120:123], v[144:147]
    v_and_b32 v67, s69, v251
    s_waitcnt lgkmcnt(1)
    v_mfma_f32_16x16x32_bf16 v[124:127], a[72:75], v[108:111], v[124:127]
    ds_read_b128 v[116:119], v2 offset:5120
    buffer_load_dwordx4 v2, s[8:11], s31 offen offset:1024 lds
    s_waitcnt lgkmcnt(1)
    v_mfma_f32_16x16x32_bf16 v[128:131], a[72:75], v[112:115], v[128:131]
    ds_read_b128 v[120:123], v2 offset:23552
    v_mfma_f32_16x16x32_bf16 v[132:135], a[144:147], v[108:111], v[132:135]
    v_lshlrev_b32 v68, 16, v252
    buffer_load_dwordx4 v2, s[8:11], s31 offen offset:2048 lds
    v_mfma_f32_16x16x32_bf16 v[136:139], a[144:147], v[112:115], v[136:139]
    v_and_b32 v69, s69, v252
    v_mfma_f32_16x16x32_bf16 v[140:143], a[216:219], v[108:111], v[140:143]
    v_lshlrev_b32 v70, 16, v253
    v_mfma_f32_16x16x32_bf16 v[144:147], a[216:219], v[112:115], v[144:147]
    v_and_b32 v71, s69, v253
    s_waitcnt lgkmcnt(1)
    v_mfma_f32_16x16x32_bf16 v[124:127], a[76:79], v[116:119], v[124:127]
    ds_read_b128 v[108:111], v2 offset:6144
    buffer_load_dwordx4 v2, s[8:11], s31 offen offset:3072 lds
    s_waitcnt lgkmcnt(1)
    v_mfma_f32_16x16x32_bf16 v[128:131], a[76:79], v[120:123], v[128:131]
    ds_read_b128 v[112:115], v2 offset:24576
    v_mfma_f32_16x16x32_bf16 v[132:135], a[148:151], v[116:119], v[132:135]
    v_lshlrev_b32 v72, 16, v254
    s_add_u32 s30, s30, 4096
    s_add_u32 s31, s31, 4096
    s_mov_b32 m0, s30
    s_nop 0
    buffer_load_dwordx4 v2, s[8:11], s31 offen offset:0 lds
    v_mfma_f32_16x16x32_bf16 v[136:139], a[148:151], v[120:123], v[136:139]
    v_and_b32 v73, s69, v254
    v_mfma_f32_16x16x32_bf16 v[140:143], a[220:223], v[116:119], v[140:143]
    v_lshlrev_b32 v74, 16, v255
    v_mfma_f32_16x16x32_bf16 v[144:147], a[220:223], v[120:123], v[144:147]
    v_and_b32 v75, s69, v255
    s_waitcnt lgkmcnt(1)
    v_mfma_f32_16x16x32_bf16 v[124:127], a[80:83], v[108:111], v[124:127]
    ds_read_b128 v[116:119], v2 offset:7168
    s_mov_b64 exec, 0xffff
    buffer_load_dwordx4 v2, s[8:11], s31 offen offset:1024 lds
    s_mov_b64 exec, -1
    s_waitcnt lgkmcnt(1)
    v_mfma_f32_16x16x32_bf16 v[128:131], a[80:83], v[112:115], v[128:131]
    ds_read_b128 v[120:123], v2 offset:25600
    v_mfma_f32_16x16x32_bf16 v[132:135], a[152:155], v[108:111], v[132:135]
    s_add_u32 s30, s29, 129024
    s_add_u32 s31, s28, 0
    s_mov_b32 m0, s30
    s_nop 0
    buffer_load_dwordx4 v2, s[8:11], s31 offen offset:0 lds
    v_mfma_f32_16x16x32_bf16 v[136:139], a[152:155], v[112:115], v[136:139]
    v_mfma_f32_16x16x32_bf16 v[140:143], a[0:3], v[108:111], v[140:143]
    v_mfma_f32_16x16x32_bf16 v[144:147], a[0:3], v[112:115], v[144:147]
    s_waitcnt lgkmcnt(1)
    v_mfma_f32_16x16x32_bf16 v[124:127], a[84:87], v[116:119], v[124:127]
    ds_read_b128 v[108:111], v2 offset:8192
    buffer_load_dwordx4 v2, s[8:11], s31 offen offset:1024 lds
    s_waitcnt lgkmcnt(1)
    v_mfma_f32_16x16x32_bf16 v[128:131], a[84:87], v[120:123], v[128:131]
    ds_read_b128 v[112:115], v2 offset:26624
    v_mfma_f32_16x16x32_bf16 v[132:135], a[156:159], v[116:119], v[132:135]
    buffer_load_dwordx4 v2, s[8:11], s31 offen offset:2048 lds
    v_mfma_f32_16x16x32_bf16 v[136:139], a[156:159], v[120:123], v[136:139]
    v_mfma_f32_16x16x32_bf16 v[140:143], a[4:7], v[116:119], v[140:143]
    v_mfma_f32_16x16x32_bf16 v[144:147], a[4:7], v[120:123], v[144:147]
    s_waitcnt lgkmcnt(1)
    v_mfma_f32_16x16x32_bf16 v[124:127], a[88:91], v[108:111], v[124:127]
    ds_read_b128 v[116:119], v2 offset:9216
    buffer_load_dwordx4 v2, s[8:11], s31 offen offset:3072 lds
    s_waitcnt lgkmcnt(1)
    v_mfma_f32_16x16x32_bf16 v[128:131], a[88:91], v[112:115], v[128:131]
    ds_read_b128 v[120:123], v2 offset:27648
    v_mfma_f32_16x16x32_bf16 v[132:135], a[160:163], v[108:111], v[132:135]
    s_add_u32 s30, s30, 4096
    s_add_u32 s31, s31, 4096
    s_mov_b32 m0, s30
    s_nop 0
    buffer_load_dwordx4 v2, s[8:11], s31 offen offset:0 lds
    v_mfma_f32_16x16x32_bf16 v[136:139], a[160:163], v[112:115], v[136:139]
    v_mfma_f32_16x16x32_bf16 v[140:143], a[8:11], v[108:111], v[140:143]
    v_mfma_f32_16x16x32_bf16 v[144:147], a[8:11], v[112:115], v[144:147]
    s_waitcnt lgkmcnt(1)
    v_mfma_f32_16x16x32_bf16 v[124:127], a[92:95], v[116:119], v[124:127]
    ds_read_b128 v[108:111], v2 offset:10240
    s_mov_b64 exec, 0xffff
    buffer_load_dwordx4 v2, s[8:11], s31 offen offset:1024 lds
    s_mov_b64 exec, -1
    s_waitcnt lgkmcnt(1)
    v_mfma_f32_16x16x32_bf16 v[128:131], a[92:95], v[120:123], v[128:131]
    ds_read_b128 v[112:115], v2 offset:28672
    v_mfma_f32_16x16x32_bf16 v[132:135], a[164:167], v[116:119], v[132:135]
    v_mfma_f32_16x16x32_bf16 v[136:139], a[164:167], v[120:123], v[136:139]
    v_mfma_f32_16x16x32_bf16 v[140:143], a[12:15], v[116:119], v[140:143]
    v_mfma_f32_16x16x32_bf16 v[144:147], a[12:15], v[120:123], v[144:147]
    s_waitcnt lgkmcnt(1)
    v_mfma_f32_16x16x32_bf16 v[124:127], a[96:99], v[108:111], v[124:127]
    ds_read_b128 v[116:119], v2 offset:11264
    s_waitcnt lgkmcnt(1)
    v_mfma_f32_16x16x32_bf16 v[128:131], a[96:99], v[112:115], v[128:131]
    ds_read_b128 v[120:123], v2 offset:29696
    v_mfma_f32_16x16x32_bf16 v[132:135], a[168:171], v[108:111], v[132:135]
    v_mfma_f32_16x16x32_bf16 v[136:139], a[168:171], v[112:115], v[136:139]
    v_mfma_f32_16x16x32_bf16 v[140:143], a[16:19], v[108:111], v[140:143]
    v_mfma_f32_16x16x32_bf16 v[144:147], a[16:19], v[112:115], v[144:147]
    s_waitcnt lgkmcnt(1)
    v_mfma_f32_16x16x32_bf16 v[124:127], a[100:103], v[116:119], v[124:127]
    ds_read_b128 v[108:111], v2 offset:12288
    s_waitcnt lgkmcnt(1)
    v_mfma_f32_16x16x32_bf16 v[128:131], a[100:103], v[120:123], v[128:131]
    ds_read_b128 v[112:115], v2 offset:30720
    v_mfma_f32_16x16x32_bf16 v[132:135], a[172:175], v[116:119], v[132:135]
    v_mfma_f32_16x16x32_bf16 v[136:139], a[172:175], v[120:123], v[136:139]
    v_mfma_f32_16x16x32_bf16 v[140:143], a[20:23], v[116:119], v[140:143]
    v_mfma_f32_16x16x32_bf16 v[144:147], a[20:23], v[120:123], v[144:147]
    s_waitcnt lgkmcnt(1)
    v_mfma_f32_16x16x32_bf16 v[124:127], a[104:107], v[108:111], v[124:127]
    ds_read_b128 v[116:119], v2 offset:13312
    s_waitcnt lgkmcnt(1)
    v_mfma_f32_16x16x32_bf16 v[128:131], a[104:107], v[112:115], v[128:131]
    ds_read_b128 v[120:123], v2 offset:31744
    v_mfma_f32_16x16x32_bf16 v[132:135], a[176:179], v[108:111], v[132:135]
    v_mfma_f32_16x16x32_bf16 v[136:139], a[176:179], v[112:115], v[136:139]
    v_mfma_f32_16x16x32_bf16 v[140:143], a[24:27], v[108:111], v[140:143]
    v_mfma_f32_16x16x32_bf16 v[144:147], a[24:27], v[112:115], v[144:147]
    s_waitcnt lgkmcnt(1)
    v_mfma_f32_16x16x32_bf16 v[124:127], a[108:111], v[116:119], v[124:127]
    ds_read_b128 v[108:111], v2 offset:14336
    buffer_load_dwordx4 v[184:187], v10, s[8:11], s42 offen sc1
    s_waitcnt lgkmcnt(1)
    v_mfma_f32_16x16x32_bf16 v[128:131], a[108:111], v[120:123], v[128:131]
    ds_read_b128 v[112:115], v2 offset:32768
    buffer_load_dwordx4 v[188:191], v10, s[8:11], s43 offen sc1
    v_mfma_f32_16x16x32_bf16 v[132:135], a[180:183], v[116:119], v[132:135]
    buffer_load_dwordx4 v[192:195], v10, s[8:11], s44 offen sc1
    v_mfma_f32_16x16x32_bf16 v[136:139], a[180:183], v[120:123], v[136:139]
    v_mfma_f32_16x16x32_bf16 v[140:143], a[28:31], v[116:119], v[140:143]
    v_mfma_f32_16x16x32_bf16 v[144:147], a[28:31], v[120:123], v[144:147]
    s_waitcnt lgkmcnt(1)
    v_mfma_f32_16x16x32_bf16 v[124:127], a[112:115], v[108:111], v[124:127]
    ds_read_b128 v[116:119], v2 offset:15360
    s_waitcnt lgkmcnt(1)
    v_mfma_f32_16x16x32_bf16 v[128:131], a[112:115], v[112:115], v[128:131]
    ds_read_b128 v[120:123], v2 offset:33792
    v_mfma_f32_16x16x32_bf16 v[132:135], a[184:187], v[108:111], v[132:135]
    v_mfma_f32_16x16x32_bf16 v[136:139], a[184:187], v[112:115], v[136:139]
    v_mfma_f32_16x16x32_bf16 v[140:143], a[32:35], v[108:111], v[140:143]
    v_mfma_f32_16x16x32_bf16 v[144:147], a[32:35], v[112:115], v[144:147]
    s_waitcnt lgkmcnt(1)
    v_mfma_f32_16x16x32_bf16 v[124:127], a[116:119], v[116:119], v[124:127]
    ds_read_b128 v[108:111], v2 offset:16384
    s_waitcnt lgkmcnt(1)
    v_mfma_f32_16x16x32_bf16 v[128:131], a[116:119], v[120:123], v[128:131]
    ds_read_b128 v[112:115], v2 offset:34816
    v_mfma_f32_16x16x32_bf16 v[132:135], a[188:191], v[116:119], v[132:135]
    v_mfma_f32_16x16x32_bf16 v[136:139], a[188:191], v[120:123], v[136:139]
    v_mfma_f32_16x16x32_bf16 v[140:143], a[36:39], v[116:119], v[140:143]
    v_mfma_f32_16x16x32_bf16 v[144:147], a[36:39], v[120:123], v[144:147]
    s_waitcnt lgkmcnt(1)
    v_mfma_f32_16x16x32_bf16 v[124:127], a[120:123], v[108:111], v[124:127]
    ds_read_b128 v[116:119], v2 offset:17408
    s_waitcnt lgkmcnt(1)
    v_mfma_f32_16x16x32_bf16 v[128:131], a[120:123], v[112:115], v[128:131]
    ds_read_b128 v[120:123], v2 offset:35840
    v_mfma_f32_16x16x32_bf16 v[132:135], a[192:195], v[108:111], v[132:135]
    v_mfma_f32_16x16x32_bf16 v[136:139], a[192:195], v[112:115], v[136:139]
    v_mfma_f32_16x16x32_bf16 v[140:143], a[40:43], v[108:111], v[140:143]
    v_mfma_f32_16x16x32_bf16 v[144:147], a[40:43], v[112:115], v[144:147]
    s_waitcnt lgkmcnt(1)
    v_mfma_f32_16x16x32_bf16 v[124:127], a[124:127], v[116:119], v[124:127]
    s_waitcnt lgkmcnt(0)
    v_mfma_f32_16x16x32_bf16 v[128:131], a[124:127], v[120:123], v[128:131]
    v_mfma_f32_16x16x32_bf16 v[132:135], a[196:199], v[116:119], v[132:135]
    v_mfma_f32_16x16x32_bf16 v[136:139], a[196:199], v[120:123], v[136:139]
    v_mfma_f32_16x16x32_bf16 v[140:143], a[44:47], v[116:119], v[140:143]
    v_mfma_f32_16x16x32_bf16 v[144:147], a[44:47], v[120:123], v[144:147]
    s_nop 3
    v_permlane16_swap_b32 v124, v128
    v_permlane16_swap_b32 v125, v129
    v_permlane16_swap_b32 v126, v130
    v_permlane16_swap_b32 v127, v131
    v_pk_add_f32 v[124:125], v[124:125], v[52:53]
    v_pk_add_f32 v[126:127], v[126:127], v[54:55]
    v_pk_add_f32 v[128:129], v[128:129], v[56:57]
    v_pk_add_f32 v[130:131], v[130:131], v[58:59]
    v_permlane16_swap_b32 v132, v136
    v_permlane16_swap_b32 v133, v137
    v_permlane16_swap_b32 v134, v138
    v_permlane16_swap_b32 v135, v139
    v_pk_add_f32 v[132:133], v[132:133], v[60:61]
    v_pk_add_f32 v[134:135], v[134:135], v[62:63]
    v_pk_add_f32 v[136:137], v[136:137], v[64:65]
    v_pk_add_f32 v[138:139], v[138:139], v[66:67]
    v_permlane16_swap_b32 v140, v144
    v_permlane16_swap_b32 v141, v145
    v_permlane16_swap_b32 v142, v146
    v_permlane16_swap_b32 v143, v147
    v_pk_add_f32 v[140:141], v[140:141], v[68:69]
    v_pk_add_f32 v[142:143], v[142:143], v[70:71]
    v_pk_add_f32 v[144:145], v[144:145], v[72:73]
    v_pk_add_f32 v[146:147], v[146:147], v[74:75]
    v_pk_mul_f32 v[170:171], v[124:125], v[124:125]
    v_pk_add_f32 v[168:169], v[124:125], v[126:127]
    v_pk_fma_f32 v[170:171], v[126:127], v[126:127], v[170:171]
    v_pk_fma_f32 v[170:171], v[128:129], v[128:129], v[170:171]
    v_pk_add_f32 v[168:169], v[168:169], v[128:129]
    v_pk_fma_f32 v[170:171], v[130:131], v[130:131], v[170:171]
    v_pk_add_f32 v[168:169], v[168:169], v[130:131]
    v_pk_fma_f32 v[170:171], v[132:133], v[132:133], v[170:171]
    v_pk_add_f32 v[168:169], v[168:169], v[132:133]
    v_pk_fma_f32 v[170:171], v[134:135], v[134:135], v[170:171]
    v_pk_add_f32 v[168:169], v[168:169], v[134:135]
    v_pk_fma_f32 v[170:171], v[136:137], v[136:137], v[170:171]
    v_pk_add_f32 v[168:169], v[168:169], v[136:137]
    v_pk_fma_f32 v[170:171], v[138:139], v[138:139], v[170:171]
    v_pk_add_f32 v[168:169], v[168:169], v[138:139]
    v_pk_fma_f32 v[170:171], v[140:141], v[140:141], v[170:171]
    v_pk_add_f32 v[168:169], v[168:169], v[140:141]
    v_pk_fma_f32 v[170:171], v[142:143], v[142:143], v[170:171]
    v_pk_add_f32 v[168:169], v[168:169], v[142:143]
    v_pk_fma_f32 v[170:171], v[144:145], v[144:145], v[170:171]
    v_pk_add_f32 v[168:169], v[168:169], v[144:145]
    v_pk_fma_f32 v[170:171], v[146:147], v[146:147], v[170:171]
    v_pk_add_f32 v[168:169], v[168:169], v[146:147]
    v_add_f32 v168, v168, v169
    v_add_f32 v169, v170, v171
    v_mov_b32 v170, v168
    v_mov_b32 v171, v169
    s_nop 0
    v_permlane32_swap_b32 v168, v170
    v_permlane32_swap_b32 v169, v171
    v_pk_add_f32 v[168:169], v[168:169], v[170:171]
    s_barrier
    ds_read_b64 v[226:227], v14 offset:256
    ds_read_b64 v[228:229], v14 offset:512
    ds_read_b64 v[230:231], v14 offset:768
    s_waitcnt lgkmcnt(2)
    v_pk_add_f32 v[224:225], v[168:169], v[226:227]
    s_waitcnt lgkmcnt(0)
    v_pk_add_f32 v[228:229], v[228:229], v[230:231]
    v_pk_add_f32 v[224:225], v[224:225], v[228:229]
    v_min_u32 v225, -2, v225
    s_mov_b64 exec, 0xffffffff
    buffer_store_dwordx2 v[224:225], v13, s[8:11], s27 offen sc1
    s_mov_b64 exec, -1
    s_waitcnt vmcnt(1)
    s_nop 0
    s_branch KF_A0_YP_CHK
KF_A0_YP:
    buffer_load_dwordx4 v[184:187], v10, s[8:11], s42 offen sc1
    buffer_load_dwordx4 v[188:191], v10, s[8:11], s43 offen sc1
    buffer_load_dwordx4 v[192:195], v10, s[8:11], s44 offen sc1
    s_waitcnt vmcnt(0)
KF_A0_YP_CHK:
    v_max_u32 v234, v184, v185
    v_max3_u32 v234, v234, v186, v187
    v_max3_u32 v234, v234, v188, v189
    v_max3_u32 v234, v234, v190, v191
    v_max3_u32 v234, v234, v192, v193
    v_max3_u32 v234, v234, v194, v195
    v_cmp_eq_u32 vcc, -1, v234
    s_sub_u32 s68, s68, 1
    s_cselect_b64 s[36:37], 0, vcc
    s_cselect_b32 s68, 0, s68
    s_cmp_eq_u64 s[36:37], 0
    s_cbranch_scc1 KF_A0_YP_GO
    s_sleep 3
    s_branch KF_A0_YP
KF_A0_YP_GO:
    ds_write_b128 v11, v[184:187] offset:0
    ds_write_b128 v11, v[188:191] offset:1024
    ds_write_b128 v11, v[192:195] offset:2048
    ds_read_b64_tr_b16 v[148:149], v12 offset:0
    ds_read_b64_tr_b16 v[150:151], v12 offset:256
    ds_read_b64_tr_b16 v[152:153], v12 offset:1024
    ds_read_b64_tr_b16 v[154:155], v12 offset:1280
    ds_read_b64_tr_b16 v[156:157], v12 offset:2048
    ds_read_b64_tr_b16 v[158:159], v12 offset:2304
    s_waitcnt lgkmcnt(5)
    v_lshlrev_b32 v200, 16, v148
    v_and_b32 v201, s69, v148
    v_lshlrev_b32 v202, 16, v149
    v_and_b32 v203, s69, v149
    s_waitcnt lgkmcnt(4)
    v_lshlrev_b32 v204, 16, v150
    v_and_b32 v205, s69, v150
    v_lshlrev_b32 v206, 16, v151
    v_and_b32 v207, s69, v151
    s_waitcnt lgkmcnt(3)
    v_lshlrev_b32 v208, 16, v152
    v_and_b32 v209, s69, v152
    v_lshlrev_b32 v210, 16, v153
    v_and_b32 v211, s69, v153
    s_waitcnt lgkmcnt(2)
    v_lshlrev_b32 v212, 16, v154
    v_and_b32 v213, s69, v154
    v_lshlrev_b32 v214, 16, v155
    v_and_b32 v215, s69, v155
    s_waitcnt lgkmcnt(1)
    v_lshlrev_b32 v216, 16, v156
    v_and_b32 v217, s69, v156
    v_lshlrev_b32 v218, 16, v157
    v_and_b32 v219, s69, v157
    s_waitcnt lgkmcnt(0)
    v_lshlrev_b32 v220, 16, v158
    v_and_b32 v221, s69, v158
    v_lshlrev_b32 v222, 16, v159
    v_and_b32 v223, s69, v159
    s_sleep 6
    s_nop 3
KF_A0_SP:
    buffer_load_dwordx2 v[238:239], v232, s[8:11], s26 offen sc1
    buffer_load_dwordx2 v[240:241], v233, s[8:11], s26 offen sc1
    s_waitcnt vmcnt(0)
    v_max_u32 v234, v239, v241
    v_cmp_eq_u32 vcc, -1, v234
    s_sub_u32 s68, s68, 1
    s_cselect_b64 s[36:37], 0, vcc
    s_cselect_b32 s68, 0, s68
    s_cmp_eq_u64 s[36:37], 0
    s_cbranch_scc1 KF_A0_SP_GO
    s_sleep 3
    s_branch KF_A0_SP
KF_A0_SP_GO:
    v_pk_add_f32 v[238:239], v[238:239], v[240:241]
    v_mov_b32 v240, v238
    v_mov_b32 v241, v239
    s_nop 0
    v_permlane32_swap_b32 v238, v240
    v_permlane32_swap_b32 v239, v241
    v_pk_add_f32 v[238:239], v[238:239], v[240:241]
    v_mul_f32 v238, s32, v238
    v_mul_f32 v240, v238, v238
    v_fma_f32 v239, v239, s32, -v240
    v_max_f32 v239, 0, v239
    v_add_f32 v239, s33, v239
    v_rsq_f32 v239, v239
    s_nop 0
    v_mul_f32 v238, v238, v239
    ds_write_b64 v14, v[238:239]
    s_waitcnt lgkmcnt(0)
    s_barrier
    v_pk_fma_f32 v[244:245], v[124:125], v[238:239], v[238:239] op_sel:[0,1,0] op_sel_hi:[1,1,0] neg_lo:[0,0,1] neg_hi:[0,0,1]
    v_pk_fma_f32 v[124:125], v[244:245], v[200:201], v[124:125]
    v_pk_fma_f32 v[246:247], v[126:127], v[238:239], v[238:239] op_sel:[0,1,0] op_sel_hi:[1,1,0] neg_lo:[0,0,1] neg_hi:[0,0,1]
    v_pk_fma_f32 v[126:127], v[246:247], v[202:203], v[126:127]
    v_pk_fma_f32 v[248:249], v[128:129], v[238:239], v[238:239] op_sel:[0,1,0] op_sel_hi:[1,1,0] neg_lo:[0,0,1] neg_hi:[0,0,1]
    v_pk_fma_f32 v[128:129], v[248:249], v[204:205], v[128:129]
    v_pk_fma_f32 v[250:251], v[130:131], v[238:239], v[238:239] op_sel:[0,1,0] op_sel_hi:[1,1,0] neg_lo:[0,0,1] neg_hi:[0,0,1]
    v_pk_fma_f32 v[130:131], v[250:251], v[206:207], v[130:131]
    v_cvt_pk_bf16_f32 v176, v124, v125
    v_cvt_pk_bf16_f32 v177, v126, v127
    v_cvt_pk_bf16_f32 v178, v128, v129
    v_cvt_pk_bf16_f32 v179, v130, v131
    v_min_u32 v176, -2, v176
    v_min_u32 v177, -2, v177
    v_min_u32 v178, -2, v178
    v_min_u32 v179, -2, v179
    buffer_store_dwordx4 v[176:179], v9, s[8:11], s48 offen offset:0 sc1
    v_pk_fma_f32 v[244:245], v[132:133], v[238:239], v[238:239] op_sel:[0,1,0] op_sel_hi:[1,1,0] neg_lo:[0,0,1] neg_hi:[0,0,1]
    v_pk_fma_f32 v[132:133], v[244:245], v[208:209], v[132:133]
    v_pk_fma_f32 v[246:247], v[134:135], v[238:239], v[238:239] op_sel:[0,1,0] op_sel_hi:[1,1,0] neg_lo:[0,0,1] neg_hi:[0,0,1]
    v_pk_fma_f32 v[134:135], v[246:247], v[210:211], v[134:135]
    v_pk_fma_f32 v[248:249], v[136:137], v[238:239], v[238:239] op_sel:[0,1,0] op_sel_hi:[1,1,0] neg_lo:[0,0,1] neg_hi:[0,0,1]
    v_pk_fma_f32 v[136:137], v[248:249], v[212:213], v[136:137]
    v_pk_fma_f32 v[250:251], v[138:139], v[238:239], v[238:239] op_sel:[0,1,0] op_sel_hi:[1,1,0] neg_lo:[0,0,1] neg_hi:[0,0,1]
    v_pk_fma_f32 v[138:139], v[250:251], v[214:215], v[138:139]
    v_cvt_pk_bf16_f32 v180, v132, v133
    v_cvt_pk_bf16_f32 v181, v134, v135
    v_cvt_pk_bf16_f32 v182, v136, v137
    v_cvt_pk_bf16_f32 v183, v138, v139
    v_min_u32 v180, -2, v180
    v_min_u32 v181, -2, v181
    v_min_u32 v182, -2, v182
    v_min_u32 v183, -2, v183
    buffer_store_dwordx4 v[180:183], v9, s[8:11], s48 offen offset:512 sc1
    v_pk_fma_f32 v[244:245], v[140:141], v[238:239], v[238:239] op_sel:[0,1,0] op_sel_hi:[1,1,0] neg_lo:[0,0,1] neg_hi:[0,0,1]
    v_pk_fma_f32 v[140:141], v[244:245], v[216:217], v[140:141]
    v_pk_fma_f32 v[246:247], v[142:143], v[238:239], v[238:239] op_sel:[0,1,0] op_sel_hi:[1,1,0] neg_lo:[0,0,1] neg_hi:[0,0,1]
    v_pk_fma_f32 v[142:143], v[246:247], v[218:219], v[142:143]
    v_pk_fma_f32 v[248:249], v[144:145], v[238:239], v[238:239] op_sel:[0,1,0] op_sel_hi:[1,1,0] neg_lo:[0,0,1] neg_hi:[0,0,1]
    v_pk_fma_f32 v[144:145], v[248:249], v[220:221], v[144:145]
    v_pk_fma_f32 v[250:251], v[146:147], v[238:239], v[238:239] op_sel:[0,1,0] op_sel_hi:[1,1,0] neg_lo:[0,0,1] neg_hi:[0,0,1]
    v_pk_fma_f32 v[146:147], v[250:251], v[222:223], v[146:147]
    v_cvt_pk_bf16_f32 v184, v140, v141
    v_cvt_pk_bf16_f32 v185, v142, v143
    v_cvt_pk_bf16_f32 v186, v144, v145
    v_cvt_pk_bf16_f32 v187, v146, v147
    v_min_u32 v184, -2, v184
    v_min_u32 v185, -2, v185
    v_min_u32 v186, -2, v186
    v_min_u32 v187, -2, v187
    buffer_store_dwordx4 v[184:187], v9, s[8:11], s48 offen offset:1024 sc1
    s_nop 3
    s_branch KF_NEXT
KF_T2:
    s_cmp_eq_u32 s3, 0
    s_cbranch_scc1 KF_TA1
    ds_read_b128 v[108:111], v2 offset:0
    ds_read_b128 v[112:115], v2 offset:18432
    s_waitcnt lgkmcnt(1)
    v_mfma_f32_16x16x32_bf16 v[124:127], a[56:59], v[108:111], 0
    ds_read_b128 v[116:119], v2 offset:1024
    s_waitcnt lgkmcnt(1)
    v_mfma_f32_16x16x32_bf16 v[128:131], a[56:59], v[112:115], 0
    ds_read_b128 v[120:123], v2 offset:19456
    v_mfma_f32_16x16x32_bf16 v[132:135], a[128:131], v[108:111], 0
    v_lshlrev_b32 v52, 16, v244
    v_mfma_f32_16x16x32_bf16 v[136:139], a[128:131], v[112:115], 0
    v_and_b32 v53, s69, v244
    s_waitcnt lgkmcnt(1)
    v_mfma_f32_16x16x32_bf16 v[124:127], a[60:63], v[116:119], v[124:127]
    ds_read_b128 v[108:111], v2 offset:2048
    s_waitcnt lgkmcnt(1)
    v_mfma_f32_16x16x32_bf16 v[128:131], a[60:63], v[120:123], v[128:131]
    ds_read_b128 v[112:115], v2 offset:20480
    v_mfma_f32_16x16x32_bf16 v[132:135], a[132:135], v[116:119], v[132:135]
    v_lshlrev_b32 v54, 16, v245
    v_mfma_f32_16x16x32_bf16 v[136:139], a[132:135], v[120:123], v[136:139]
    v_and_b32 v55, s69, v245
    s_waitcnt lgkmcnt(1)
    v_mfma_f32_16x16x32_bf16 v[124:127], a[64:67], v[108:111], v[124:127]
    ds_read_b128 v[116:119], v2 offset:3072
    s_waitcnt lgkmcnt(1)
    v_mfma_f32_16x16x32_bf16 v[128:131], a[64:67], v[112:115], v[128:131]
    ds_read_b128 v[120:123], v2 offset:21504
    v_mfma_f32_16x16x32_bf16 v[132:135], a[136:139], v[108:111], v[132:135]
    v_lshlrev_b32 v56, 16, v246
    v_mfma_f32_16x16x32_bf16 v[136:139], a[136:139], v[112:115], v[136:139]
    v_and_b32 v57, s69, v246
    s_waitcnt lgkmcnt(1)
    v_mfma_f32_16x16x32_bf16 v[124:127], a[68:71], v[116:119], v[124:127]
    ds_read_b128 v[108:111], v2 offset:4096
    s_waitcnt lgkmcnt(1)
    v_mfma_f32_16x16x32_bf16 v[128:131], a[68:71], v[120:123], v[128:131]
    ds_read_b128 v[112:115], v2 offset:22528
    v_mfma_f32_16x16x32_bf16 v[132:135], a[140:143], v[116:119], v[132:135]
    v_lshlrev_b32 v58, 16, v247
    v_mfma_f32_16x16x32_bf16 v[136:139], a[140:143], v[120:123], v[136:139]
    v_and_b32 v59, s69, v247
    s_waitcnt lgkmcnt(1)
    v_mfma_f32_16x16x32_bf16 v[124:127], a[72:75], v[108:111], v[124:127]
    ds_read_b128 v[116:119], v2 offset:5120
    s_waitcnt lgkmcnt(1)
    v_mfma_f32_16x16x32_bf16 v[128:131], a[72:75], v[112:115], v[128:131]
    ds_read_b128 v[120:123], v2 offset:23552
    v_mfma_f32_16x16x32_bf16 v[132:135], a[144:147], v[108:111], v[132:135]
    v_lshlrev_b32 v60, 16, v248
    v_mfma_f32_16x16x32_bf16 v[136:139], a[144:147], v[112:115], v[136:139]
    v_and_b32 v61, s69, v248
    s_waitcnt lgkmcnt(1)
    v_mfma_f32_16x16x32_bf16 v[124:127], a[76:79], v[116:119], v[124:127]
    ds_read_b128 v[108:111], v2 offset:6144
    s_waitcnt lgkmcnt(1)
    v_mfma_f32_16x16x32_bf16 v[128:131], a[76:79], v[120:123], v[128:131]
    ds_read_b128 v[112:115], v2 offset:24576
    v_mfma_f32_16x16x32_bf16 v[132:135], a[148:151], v[116:119], v[132:135]
    v_lshlrev_b32 v62, 16, v249
    v_mfma_f32_16x16x32_bf16 v[136:139], a[148:151], v[120:123], v[136:139]
    v_and_b32 v63, s69, v249
    s_waitcnt lgkmcnt(1)
    v_mfma_f32_16x16x32_bf16 v[124:127], a[80:83], v[108:111], v[124:127]
    ds_read_b128 v[116:119], v2 offset:7168
    s_waitcnt lgkmcnt(1)
    v_mfma_f32_16x16x32_bf16 v[128:131], a[80:83], v[112:115], v[128:131]
    ds_read_b128 v[120:123], v2 offset:25600
    v_mfma_f32_16x16x32_bf16 v[132:135], a[152:155], v[108:111], v[132:135]
    v_lshlrev_b32 v64, 16, v250
    v_mfma_f32_16x16x32_bf16 v[136:139], a[152:155], v[112:115], v[136:139]
    v_and_b32 v65, s69, v250
    s_waitcnt lgkmcnt(1)
    v_mfma_f32_16x16x32_bf16 v[124:127], a[84:87], v[116:119], v[124:127]
    ds_read_b128 v[108:111], v2 offset:8192
    s_waitcnt lgkmcnt(1)
    v_mfma_f32_16x16x32_bf16 v[128:131], a[84:87], v[120:123], v[128:131]
    ds_read_b128 v[112:115], v2 offset:26624
    v_mfma_f32_16x16x32_bf16 v[132:135], a[156:159], v[116:119], v[132:135]
    v_lshlrev_b32 v66, 16, v251
    v_mfma_f32_16x16x32_bf16 v[136:139], a[156:159], v[120:123], v[136:139]
    v_and_b32 v67, s69, v251
    s_waitcnt lgkmcnt(1)
    v_mfma_f32_16x16x32_bf16 v[124:127], a[88:91], v[108:111], v[124:127]
    ds_read_b128 v[116:119], v2 offset:9216
    s_waitcnt lgkmcnt(1)
    v_mfma_f32_16x16x32_bf16 v[128:131], a[88:91], v[112:115], v[128:131]
    ds_read_b128 v[120:123], v2 offset:27648
    v_mfma_f32_16x16x32_bf16 v[132:135], a[160:163], v[108:111], v[132:135]
    v_mfma_f32_16x16x32_bf16 v[136:139], a[160:163], v[112:115], v[136:139]
    s_waitcnt lgkmcnt(1)
    v_mfma_f32_16x16x32_bf16 v[124:127], a[92:95], v[116:119], v[124:127]
    ds_read_b128 v[108:111], v2 offset:10240
    s_waitcnt lgkmcnt(1)
    v_mfma_f32_16x16x32_bf16 v[128:131], a[92:95], v[120:123], v[128:131]
    ds_read_b128 v[112:115], v2 offset:28672
    v_mfma_f32_16x16x32_bf16 v[132:135], a[164:167], v[116:119], v[132:135]
    v_mfma_f32_16x16x32_bf16 v[136:139], a[164:167], v[120:123], v[136:139]
    s_waitcnt lgkmcnt(1)
    v_mfma_f32_16x16x32_bf16 v[124:127], a[96:99], v[108:111], v[124:127]
    ds_read_b128 v[116:119], v2 offset:11264
    s_waitcnt lgkmcnt(1)
    v_mfma_f32_16x16x32_bf16 v[128:131], a[96:99], v[112:115], v[128:131]
    ds_read_b128 v[120:123], v2 offset:29696
    v_mfma_f32_16x16x32_bf16 v[132:135], a[168:171], v[108:111], v[132:135]
    v_mfma_f32_16x16x32_bf16 v[136:139], a[168:171], v[112:115], v[136:139]
    s_waitcnt lgkmcnt(1)
    v_mfma_f32_16x16x32_bf16 v[124:127], a[100:103], v[116:119], v[124:127]
    ds_read_b128 v[108:111], v2 offset:12288
    s_waitcnt lgkmcnt(1)
    v_mfma_f32_16x16x32_bf16 v[128:131], a[100:103], v[120:123], v[128:131]
    ds_read_b128 v[112:115], v2 offset:30720
    v_mfma_f32_16x16x32_bf16 v[132:135], a[172:175], v[116:119], v[132:135]
    v_mfma_f32_16x16x32_bf16 v[136:139], a[172:175], v[120:123], v[136:139]
    s_waitcnt lgkmcnt(1)
    v_mfma_f32_16x16x32_bf16 v[124:127], a[104:107], v[108:111], v[124:127]
    ds_read_b128 v[116:119], v2 offset:13312
    s_waitcnt lgkmcnt(1)
    v_mfma_f32_16x16x32_bf16 v[128:131], a[104:107], v[112:115], v[128:131]
    ds_read_b128 v[120:123], v2 offset:31744
    v_mfma_f32_16x16x32_bf16 v[132:135], a[176:179], v[108:111], v[132:135]
    v_mfma_f32_16x16x32_bf16 v[136:139], a[176:179], v[112:115], v[136:139]
    s_waitcnt lgkmcnt(1)
    v_mfma_f32_16x16x32_bf16 v[124:127], a[108:111], v[116:119], v[124:127]
    ds_read_b128 v[108:111], v2 offset:14336
    s_waitcnt lgkmcnt(1)
    v_mfma_f32_16x16x32_bf16 v[128:131], a[108:111], v[120:123], v[128:131]
    ds_read_b128 v[112:115], v2 offset:32768
    v_mfma_f32_16x16x32_bf16 v[132:135], a[180:183], v[116:119], v[132:135]
    v_mfma_f32_16x16x32_bf16 v[136:139], a[180:183], v[120:123], v[136:139]
    s_waitcnt lgkmcnt(1)
    v_mfma_f32_16x16x32_bf16 v[124:127], a[112:115], v[108:111], v[124:127]
    ds_read_b128 v[116:119], v2 offset:15360
    s_waitcnt lgkmcnt(1)
    v_mfma_f32_16x16x32_bf16 v[128:131], a[112:115], v[112:115], v[128:131]
    ds_read_b128 v[120:123], v2 offset:33792
    v_mfma_f32_16x16x32_bf16 v[132:135], a[184:187], v[108:111], v[132:135]
    v_mfma_f32_16x16x32_bf16 v[136:139], a[184:187], v[112:115], v[136:139]
    s_waitcnt lgkmcnt(1)
    v_mfma_f32_16x16x32_bf16 v[124:127], a[116:119], v[116:119], v[124:127]
    ds_read_b128 v[108:111], v2 offset:16384
    s_waitcnt lgkmcnt(1)
    v_mfma_f32_16x16x32_bf16 v[128:131], a[116:119], v[120:123], v[128:131]
    ds_read_b128 v[112:115], v2 offset:34816
    v_mfma_f32_16x16x32_bf16 v[132:135], a[188:191], v[116:119], v[132:135]
    v_mfma_f32_16x16x32_bf16 v[136:139], a[188:191], v[120:123], v[136:139]
    s_waitcnt lgkmcnt(1)
    v_mfma_f32_16x16x32_bf16 v[124:127], a[120:123], v[108:111], v[124:127]
    ds_read_b128 v[116:119], v2 offset:17408
    s_waitcnt lgkmcnt(1)
    v_mfma_f32_16x16x32_bf16 v[128:131], a[120:123], v[112:115], v[128:131]
    ds_read_b128 v[120:123], v2 offset:35840
    v_mfma_f32_16x16x32_bf16 v[132:135], a[192:195], v[108:111], v[132:135]
    v_mfma_f32_16x16x32_bf16 v[136:139], a[192:195], v[112:115], v[136:139]
    s_waitcnt lgkmcnt(1)
    v_mfma_f32_16x16x32_bf16 v[124:127], a[124:127], v[116:119], v[124:127]
    s_waitcnt lgkmcnt(0)
    v_mfma_f32_16x16x32_bf16 v[128:131], a[124:127], v[120:123], v[128:131]
    v_mfma_f32_16x16x32_bf16 v[132:135], a[196:199], v[116:119], v[132:135]
    v_mfma_f32_16x16x32_bf16 v[136:139], a[196:199], v[120:123], v[136:139]
    s_nop 5
    v_permlane16_swap_b32 v124, v128
    v_permlane16_swap_b32 v125, v129
    v_permlane16_swap_b32 v126, v130
    v_permlane16_swap_b32 v127, v131
    v_pk_add_f32 v[124:125], v[124:125], v[52:53]
    v_pk_add_f32 v[126:127], v[126:127], v[54:55]
    v_pk_add_f32 v[128:129], v[128:129], v[56:57]
    v_pk_add_f32 v[130:131], v[130:131], v[58:59]
    v_permlane16_swap_b32 v132, v136
    v_permlane16_swap_b32 v133, v137
    v_permlane16_swap_b32 v134, v138
    v_permlane16_swap_b32 v135, v139
    v_pk_add_f32 v[132:133], v[132:133], v[60:61]
    v_pk_add_f32 v[134:135], v[134:135], v[62:63]
    v_pk_add_f32 v[136:137], v[136:137], v[64:65]
    v_pk_add_f32 v[138:139], v[138:139], v[66:67]
    v_pk_mul_f32 v[170:171], v[124:125], v[124:125]
    v_pk_add_f32 v[168:169], v[124:125], v[126:127]
    v_pk_fma_f32 v[170:171], v[126:127], v[126:127], v[170:171]
    v_pk_fma_f32 v[170:171], v[128:129], v[128:129], v[170:171]
    v_pk_add_f32 v[168:169], v[168:169], v[128:129]
    v_pk_fma_f32 v[170:171], v[130:131], v[130:131], v[170:171]
    v_pk_add_f32 v[168:169], v[168:169], v[130:131]
    v_pk_fma_f32 v[170:171], v[132:133], v[132:133], v[170:171]
    v_pk_add_f32 v[168:169], v[168:169], v[132:133]
    v_pk_fma_f32 v[170:171], v[134:135], v[134:135], v[170:171]
    v_pk_add_f32 v[168:169], v[168:169], v[134:135]
    v_pk_fma_f32 v[170:171], v[136:137], v[136:137], v[170:171]
    v_pk_add_f32 v[168:169], v[168:169], v[136:137]
    v_pk_fma_f32 v[170:171], v[138:139], v[138:139], v[170:171]
    v_pk_add_f32 v[168:169], v[168:169], v[138:139]
    v_add_f32 v168, v168, v169
    v_add_f32 v169, v170, v171
    v_mov_b32 v170, v168
    v_mov_b32 v171, v169
    s_nop 0
    v_permlane32_swap_b32 v168, v170
    v_permlane32_swap_b32 v169, v171
    v_pk_add_f32 v[168:169], v[168:169], v[170:171]
    ds_write_b64 v15, v[168:169]
    s_waitcnt lgkmcnt(0)
    s_barrier
    s_barrier
    ds_read_b64 v[238:239], v14
    s_waitcnt lgkmcnt(0)
    v_pk_fma_f32 v[244:245], v[124:125], v[238:239], v[238:239] op_sel:[0,1,0] op_sel_hi:[1,1,0] neg_lo:[0,0,1] neg_hi:[0,0,1]
    v_pk_fma_f32 v[124:125], v[244:245], v[200:201], v[124:125]
    v_pk_fma_f32 v[246:247], v[126:127], v[238:239], v[238:239] op_sel:[0,1,0] op_sel_hi:[1,1,0] neg_lo:[0,0,1] neg_hi:[0,0,1]
    v_pk_fma_f32 v[126:127], v[246:247], v[202:203], v[126:127]
    v_pk_fma_f32 v[248:249], v[128:129], v[238:239], v[238:239] op_sel:[0,1,0] op_sel_hi:[1,1,0] neg_lo:[0,0,1] neg_hi:[0,0,1]
    v_pk_fma_f32 v[128:129], v[248:249], v[204:205], v[128:129]
    v_pk_fma_f32 v[250:251], v[130:131], v[238:239], v[238:239] op_sel:[0,1,0] op_sel_hi:[1,1,0] neg_lo:[0,0,1] neg_hi:[0,0,1]
    v_pk_fma_f32 v[130:131], v[250:251], v[206:207], v[130:131]
    v_cvt_pk_bf16_f32 v176, v124, v125
    v_cvt_pk_bf16_f32 v177, v126, v127
    v_cvt_pk_bf16_f32 v178, v128, v129
    v_cvt_pk_bf16_f32 v179, v130, v131
    buffer_store_dwordx4 v[176:179], v237, s[12:15], s40 offen offset:0
    v_pk_fma_f32 v[244:245], v[132:133], v[238:239], v[238:239] op_sel:[0,1,0] op_sel_hi:[1,1,0] neg_lo:[0,0,1] neg_hi:[0,0,1]
    v_pk_fma_f32 v[132:133], v[244:245], v[208:209], v[132:133]
    v_pk_fma_f32 v[246:247], v[134:135], v[238:239], v[238:239] op_sel:[0,1,0] op_sel_hi:[1,1,0] neg_lo:[0,0,1] neg_hi:[0,0,1]
    v_pk_fma_f32 v[134:135], v[246:247], v[210:211], v[134:135]
    v_pk_fma_f32 v[248:249], v[136:137], v[238:239], v[238:239] op_sel:[0,1,0] op_sel_hi:[1,1,0] neg_lo:[0,0,1] neg_hi:[0,0,1]
    v_pk_fma_f32 v[136:137], v[248:249], v[212:213], v[136:137]
    v_pk_fma_f32 v[250:251], v[138:139], v[238:239], v[238:239] op_sel:[0,1,0] op_sel_hi:[1,1,0] neg_lo:[0,0,1] neg_hi:[0,0,1]
    v_pk_fma_f32 v[138:139], v[250:251], v[214:215], v[138:139]
    v_cvt_pk_bf16_f32 v180, v132, v133
    v_cvt_pk_bf16_f32 v181, v134, v135
    v_cvt_pk_bf16_f32 v182, v136, v137
    v_cvt_pk_bf16_f32 v183, v138, v139
    buffer_store_dwordx4 v[180:183], v237, s[12:15], s40 offen offset:32
    s_endpgm
KF_TA1:
    ds_read_b128 v[108:111], v2 offset:0
    ds_read_b128 v[112:115], v2 offset:18432
    s_waitcnt lgkmcnt(1)
    v_mfma_f32_16x16x32_bf16 v[124:127], a[56:59], v[108:111], 0
    ds_read_b128 v[116:119], v2 offset:1024
    s_waitcnt lgkmcnt(1)
    v_mfma_f32_16x16x32_bf16 v[128:131], a[56:59], v[112:115], 0
    ds_read_b128 v[120:123], v2 offset:19456
    v_mfma_f32_16x16x32_bf16 v[132:135], a[128:131], v[108:111], 0
    v_lshlrev_b32 v52, 16, v244
    v_mfma_f32_16x16x32_bf16 v[136:139], a[128:131], v[112:115], 0
    v_and_b32 v53, s69, v244
    v_mfma_f32_16x16x32_bf16 v[140:143], a[200:203], v[108:111], 0
    v_lshlrev_b32 v54, 16, v245
    v_mfma_f32_16x16x32_bf16 v[144:147], a[200:203], v[112:115], 0
    v_and_b32 v55, s69, v245
    s_waitcnt lgkmcnt(1)
    v_mfma_f32_16x16x32_bf16 v[124:127], a[60:63], v[116:119], v[124:127]
    ds_read_b128 v[108:111], v2 offset:2048
    s_waitcnt lgkmcnt(1)
    v_mfma_f32_16x16x32_bf16 v[128:131], a[60:63], v[120:123], v[128:131]
    ds_read_b128 v[112:115], v2 offset:20480
    v_mfma_f32_16x16x32_bf16 v[132:135], a[132:135], v[116:119], v[132:135]
    v_lshlrev_b32 v56, 16, v246
    v_mfma_f32_16x16x32_bf16 v[136:139], a[132:135], v[120:123], v[136:139]
    v_and_b32 v57, s69, v246
    v_mfma_f32_16x16x32_bf16 v[140:143], a[204:207], v[116:119], v[140:143]
    v_lshlrev_b32 v58, 16, v247
    v_mfma_f32_16x16x32_bf16 v[144:147], a[204:207], v[120:123], v[144:147]
    v_and_b32 v59, s69, v247
    s_waitcnt lgkmcnt(1)
    v_mfma_f32_16x16x32_bf16 v[124:127], a[64:67], v[108:111], v[124:127]
    ds_read_b128 v[116:119], v2 offset:3072
    s_waitcnt lgkmcnt(1)
    v_mfma_f32_16x16x32_bf16 v[128:131], a[64:67], v[112:115], v[128:131]
    ds_read_b128 v[120:123], v2 offset:21504
    v_mfma_f32_16x16x32_bf16 v[132:135], a[136:139], v[108:111], v[132:135]
    v_lshlrev_b32 v60, 16, v248
    v_mfma_f32_16x16x32_bf16 v[136:139], a[136:139], v[112:115], v[136:139]
    v_and_b32 v61, s69, v248
    v_mfma_f32_16x16x32_bf16 v[140:143], a[208:211], v[108:111], v[140:143]
    v_lshlrev_b32 v62, 16, v249
    v_mfma_f32_16x16x32_bf16 v[144:147], a[208:211], v[112:115], v[144:147]
    v_and_b32 v63, s69, v249
    s_waitcnt lgkmcnt(1)
    v_mfma_f32_16x16x32_bf16 v[124:127], a[68:71], v[116:119], v[124:127]
    ds_read_b128 v[108:111], v2 offset:4096
    s_waitcnt lgkmcnt(1)
    v_mfma_f32_16x16x32_bf16 v[128:131], a[68:71], v[120:123], v[128:131]
    ds_read_b128 v[112:115], v2 offset:22528
    v_mfma_f32_16x16x32_bf16 v[132:135], a[140:143], v[116:119], v[132:135]
    v_lshlrev_b32 v64, 16, v250
    v_mfma_f32_16x16x32_bf16 v[136:139], a[140:143], v[120:123], v[136:139]
    v_and_b32 v65, s69, v250
    v_mfma_f32_16x16x32_bf16 v[140:143], a[212:215], v[116:119], v[140:143]
    v_lshlrev_b32 v66, 16, v251
    v_mfma_f32_16x16x32_bf16 v[144:147], a[212:215], v[120:123], v[144:147]
    v_and_b32 v67, s69, v251
    s_waitcnt lgkmcnt(1)
    v_mfma_f32_16x16x32_bf16 v[124:127], a[72:75], v[108:111], v[124:127]
    ds_read_b128 v[116:119], v2 offset:5120
    s_waitcnt lgkmcnt(1)
    v_mfma_f32_16x16x32_bf16 v[128:131], a[72:75], v[112:115], v[128:131]
    ds_read_b128 v[120:123], v2 offset:23552
    v_mfma_f32_16x16x32_bf16 v[132:135], a[144:147], v[108:111], v[132:135]
    v_lshlrev_b32 v68, 16, v252
    v_mfma_f32_16x16x32_bf16 v[136:139], a[144:147], v[112:115], v[136:139]
    v_and_b32 v69, s69, v252
    v_mfma_f32_16x16x32_bf16 v[140:143], a[216:219], v[108:111], v[140:143]
    v_lshlrev_b32 v70, 16, v253
    v_mfma_f32_16x16x32_bf16 v[144:147], a[216:219], v[112:115], v[144:147]
    v_and_b32 v71, s69, v253
    s_waitcnt lgkmcnt(1)
    v_mfma_f32_16x16x32_bf16 v[124:127], a[76:79], v[116:119], v[124:127]
    ds_read_b128 v[108:111], v2 offset:6144
    s_waitcnt lgkmcnt(1)
    v_mfma_f32_16x16x32_bf16 v[128:131], a[76:79], v[120:123], v[128:131]
    ds_read_b128 v[112:115], v2 offset:24576
    v_mfma_f32_16x16x32_bf16 v[132:135], a[148:151], v[116:119], v[132:135]
    v_lshlrev_b32 v72, 16, v254
    v_mfma_f32_16x16x32_bf16 v[136:139], a[148:151], v[120:123], v[136:139]
    v_and_b32 v73, s69, v254
    v_mfma_f32_16x16x32_bf16 v[140:143], a[220:223], v[116:119], v[140:143]
    v_lshlrev_b32 v74, 16, v255
    v_mfma_f32_16x16x32_bf16 v[144:147], a[220:223], v[120:123], v[144:147]
    v_and_b32 v75, s69, v255
    s_waitcnt lgkmcnt(1)
    v_mfma_f32_16x16x32_bf16 v[124:127], a[80:83], v[108:111], v[124:127]
    ds_read_b128 v[116:119], v2 offset:7168
    s_waitcnt lgkmcnt(1)
    v_mfma_f32_16x16x32_bf16 v[128:131], a[80:83], v[112:115], v[128:131]
    ds_read_b128 v[120:123], v2 offset:25600
    v_mfma_f32_16x16x32_bf16 v[132:135], a[152:155], v[108:111], v[132:135]
    v_mfma_f32_16x16x32_bf16 v[136:139], a[152:155], v[112:115], v[136:139]
    v_mfma_f32_16x16x32_bf16 v[140:143], a[0:3], v[108:111], v[140:143]
    v_mfma_f32_16x16x32_bf16 v[144:147], a[0:3], v[112:115], v[144:147]
    s_waitcnt lgkmcnt(1)
    v_mfma_f32_16x16x32_bf16 v[124:127], a[84:87], v[116:119], v[124:127]
    ds_read_b128 v[108:111], v2 offset:8192
    s_waitcnt lgkmcnt(1)
    v_mfma_f32_16x16x32_bf16 v[128:131], a[84:87], v[120:123], v[128:131]
    ds_read_b128 v[112:115], v2 offset:26624
    v_mfma_f32_16x16x32_bf16 v[132:135], a[156:159], v[116:119], v[132:135]
    v_mfma_f32_16x16x32_bf16 v[136:139], a[156:159], v[120:123], v[136:139]
    v_mfma_f32_16x16x32_bf16 v[140:143], a[4:7], v[116:119], v[140:143]
    v_mfma_f32_16x16x32_bf16 v[144:147], a[4:7], v[120:123], v[144:147]
    s_waitcnt lgkmcnt(1)
    v_mfma_f32_16x16x32_bf16 v[124:127], a[88:91], v[108:111], v[124:127]
    ds_read_b128 v[116:119], v2 offset:9216
    s_waitcnt lgkmcnt(1)
    v_mfma_f32_16x16x32_bf16 v[128:131], a[88:91], v[112:115], v[128:131]
    ds_read_b128 v[120:123], v2 offset:27648
    v_mfma_f32_16x16x32_bf16 v[132:135], a[160:163], v[108:111], v[132:135]
    v_mfma_f32_16x16x32_bf16 v[136:139], a[160:163], v[112:115], v[136:139]
    v_mfma_f32_16x16x32_bf16 v[140:143], a[8:11], v[108:111], v[140:143]
    v_mfma_f32_16x16x32_bf16 v[144:147], a[8:11], v[112:115], v[144:147]
    s_waitcnt lgkmcnt(1)
    v_mfma_f32_16x16x32_bf16 v[124:127], a[92:95], v[116:119], v[124:127]
    ds_read_b128 v[108:111], v2 offset:10240
    s_waitcnt lgkmcnt(1)
    v_mfma_f32_16x16x32_bf16 v[128:131], a[92:95], v[120:123], v[128:131]
    ds_read_b128 v[112:115], v2 offset:28672
    v_mfma_f32_16x16x32_bf16 v[132:135], a[164:167], v[116:119], v[132:135]
    v_mfma_f32_16x16x32_bf16 v[136:139], a[164:167], v[120:123], v[136:139]
    v_mfma_f32_16x16x32_bf16 v[140:143], a[12:15], v[116:119], v[140:143]
    v_mfma_f32_16x16x32_bf16 v[144:147], a[12:15], v[120:123], v[144:147]
    s_waitcnt lgkmcnt(1)
    v_mfma_f32_16x16x32_bf16 v[124:127], a[96:99], v[108:111], v[124:127]
    ds_read_b128 v[116:119], v2 offset:11264
    s_waitcnt lgkmcnt(1)
    v_mfma_f32_16x16x32_bf16 v[128:131], a[96:99], v[112:115], v[128:131]
    ds_read_b128 v[120:123], v2 offset:29696
    v_mfma_f32_16x16x32_bf16 v[132:135], a[168:171], v[108:111], v[132:135]
    v_mfma_f32_16x16x32_bf16 v[136:139], a[168:171], v[112:115], v[136:139]
    v_mfma_f32_16x16x32_bf16 v[140:143], a[16:19], v[108:111], v[140:143]
    v_mfma_f32_16x16x32_bf16 v[144:147], a[16:19], v[112:115], v[144:147]
    s_waitcnt lgkmcnt(1)
    v_mfma_f32_16x16x32_bf16 v[124:127], a[100:103], v[116:119], v[124:127]
    ds_read_b128 v[108:111], v2 offset:12288
    s_waitcnt lgkmcnt(1)
    v_mfma_f32_16x16x32_bf16 v[128:131], a[100:103], v[120:123], v[128:131]
    ds_read_b128 v[112:115], v2 offset:30720
    v_mfma_f32_16x16x32_bf16 v[132:135], a[172:175], v[116:119], v[132:135]
    v_mfma_f32_16x16x32_bf16 v[136:139], a[172:175], v[120:123], v[136:139]
    v_mfma_f32_16x16x32_bf16 v[140:143], a[20:23], v[116:119], v[140:143]
    v_mfma_f32_16x16x32_bf16 v[144:147], a[20:23], v[120:123], v[144:147]
    s_waitcnt lgkmcnt(1)
    v_mfma_f32_16x16x32_bf16 v[124:127], a[104:107], v[108:111], v[124:127]
    ds_read_b128 v[116:119], v2 offset:13312
    s_waitcnt lgkmcnt(1)
    v_mfma_f32_16x16x32_bf16 v[128:131], a[104:107], v[112:115], v[128:131]
    ds_read_b128 v[120:123], v2 offset:31744
    v_mfma_f32_16x16x32_bf16 v[132:135], a[176:179], v[108:111], v[132:135]
    v_mfma_f32_16x16x32_bf16 v[136:139], a[176:179], v[112:115], v[136:139]
    v_mfma_f32_16x16x32_bf16 v[140:143], a[24:27], v[108:111], v[140:143]
    v_mfma_f32_16x16x32_bf16 v[144:147], a[24:27], v[112:115], v[144:147]
    s_waitcnt lgkmcnt(1)
    v_mfma_f32_16x16x32_bf16 v[124:127], a[108:111], v[116:119], v[124:127]
    ds_read_b128 v[108:111], v2 offset:14336
    s_waitcnt lgkmcnt(1)
    v_mfma_f32_16x16x32_bf16 v[128:131], a[108:111], v[120:123], v[128:131]
    ds_read_b128 v[112:115], v2 offset:32768
    v_mfma_f32_16x16x32_bf16 v[132:135], a[180:183], v[116:119], v[132:135]
    v_mfma_f32_16x16x32_bf16 v[136:139], a[180:183], v[120:123], v[136:139]
    v_mfma_f32_16x16x32_bf16 v[140:143], a[28:31], v[116:119], v[140:143]
    v_mfma_f32_16x16x32_bf16 v[144:147], a[28:31], v[120:123], v[144:147]
    s_waitcnt lgkmcnt(1)
    v_mfma_f32_16x16x32_bf16 v[124:127], a[112:115], v[108:111], v[124:127]
    ds_read_b128 v[116:119], v2 offset:15360
    s_waitcnt lgkmcnt(1)
    v_mfma_f32_16x16x32_bf16 v[128:131], a[112:115], v[112:115], v[128:131]
    ds_read_b128 v[120:123], v2 offset:33792
    v_mfma_f32_16x16x32_bf16 v[132:135], a[184:187], v[108:111], v[132:135]
    v_mfma_f32_16x16x32_bf16 v[136:139], a[184:187], v[112:115], v[136:139]
    v_mfma_f32_16x16x32_bf16 v[140:143], a[32:35], v[108:111], v[140:143]
    v_mfma_f32_16x16x32_bf16 v[144:147], a[32:35], v[112:115], v[144:147]
    s_waitcnt lgkmcnt(1)
    v_mfma_f32_16x16x32_bf16 v[124:127], a[116:119], v[116:119], v[124:127]
    ds_read_b128 v[108:111], v2 offset:16384
    s_waitcnt lgkmcnt(1)
    v_mfma_f32_16x16x32_bf16 v[128:131], a[116:119], v[120:123], v[128:131]
    ds_read_b128 v[112:115], v2 offset:34816
    v_mfma_f32_16x16x32_bf16 v[132:135], a[188:191], v[116:119], v[132:135]
    v_mfma_f32_16x16x32_bf16 v[136:139], a[188:191], v[120:123], v[136:139]
    v_mfma_f32_16x16x32_bf16 v[140:143], a[36:39], v[116:119], v[140:143]
    v_mfma_f32_16x16x32_bf16 v[144:147], a[36:39], v[120:123], v[144:147]
    s_waitcnt lgkmcnt(1)
    v_mfma_f32_16x16x32_bf16 v[124:127], a[120:123], v[108:111], v[124:127]
    ds_read_b128 v[116:119], v2 offset:17408
    s_waitcnt lgkmcnt(1)
    v_mfma_f32_16x16x32_bf16 v[128:131], a[120:123], v[112:115], v[128:131]
    ds_read_b128 v[120:123], v2 offset:35840
    v_mfma_f32_16x16x32_bf16 v[132:135], a[192:195], v[108:111], v[132:135]
    v_mfma_f32_16x16x32_bf16 v[136:139], a[192:195], v[112:115], v[136:139]
    v_mfma_f32_16x16x32_bf16 v[140:143], a[40:43], v[108:111], v[140:143]
    v_mfma_f32_16x16x32_bf16 v[144:147], a[40:43], v[112:115], v[144:147]
    s_waitcnt lgkmcnt(1)
    v_mfma_f32_16x16x32_bf16 v[124:127], a[124:127], v[116:119], v[124:127]
    s_waitcnt lgkmcnt(0)
    v_mfma_f32_16x16x32_bf16 v[128:131], a[124:127], v[120:123], v[128:131]
    v_mfma_f32_16x16x32_bf16 v[132:135], a[196:199], v[116:119], v[132:135]
    v_mfma_f32_16x16x32_bf16 v[136:139], a[196:199], v[120:123], v[136:139]
    v_mfma_f32_16x16x32_bf16 v[140:143], a[44:47], v[116:119], v[140:143]
    v_mfma_f32_16x16x32_bf16 v[144:147], a[44:47], v[120:123], v[144:147]
    s_nop 3
    v_permlane16_swap_b32 v124, v128
    v_permlane16_swap_b32 v125, v129
    v_permlane16_swap_b32 v126, v130
    v_permlane16_swap_b32 v127, v131
    v_pk_add_f32 v[124:125], v[124:125], v[52:53]
    v_pk_add_f32 v[126:127], v[126:127], v[54:55]
    v_pk_add_f32 v[128:129], v[128:129], v[56:57]
    v_pk_add_f32 v[130:131], v[130:131], v[58:59]
    v_permlane16_swap_b32 v132, v136
    v_permlane16_swap_b32 v133, v137
    v_permlane16_swap_b32 v134, v138
    v_permlane16_swap_b32 v135, v139
    v_pk_add_f32 v[132:133], v[132:133], v[60:61]
    v_pk_add_f32 v[134:135], v[134:135], v[62:63]
    v_pk_add_f32 v[136:137], v[136:137], v[64:65]
    v_pk_add_f32 v[138:139], v[138:139], v[66:67]
    v_permlane16_swap_b32 v140, v144
    v_permlane16_swap_b32 v141, v145
    v_permlane16_swap_b32 v142, v146
    v_permlane16_swap_b32 v143, v147
    v_pk_add_f32 v[140:141], v[140:141], v[68:69]
    v_pk_add_f32 v[142:143], v[142:143], v[70:71]
    v_pk_add_f32 v[144:145], v[144:145], v[72:73]
    v_pk_add_f32 v[146:147], v[146:147], v[74:75]
    v_pk_mul_f32 v[170:171], v[124:125], v[124:125]
    v_pk_add_f32 v[168:169], v[124:125], v[126:127]
    v_pk_fma_f32 v[170:171], v[126:127], v[126:127], v[170:171]
    v_pk_fma_f32 v[170:171], v[128:129], v[128:129], v[170:171]
    v_pk_add_f32 v[168:169], v[168:169], v[128:129]
    v_pk_fma_f32 v[170:171], v[130:131], v[130:131], v[170:171]
    v_pk_add_f32 v[168:169], v[168:169], v[130:131]
    v_pk_fma_f32 v[170:171], v[132:133], v[132:133], v[170:171]
    v_pk_add_f32 v[168:169], v[168:169], v[132:133]
    v_pk_fma_f32 v[170:171], v[134:135], v[134:135], v[170:171]
    v_pk_add_f32 v[168:169], v[168:169], v[134:135]
    v_pk_fma_f32 v[170:171], v[136:137], v[136:137], v[170:171]
    v_pk_add_f32 v[168:169], v[168:169], v[136:137]
    v_pk_fma_f32 v[170:171], v[138:139], v[138:139], v[170:171]
    v_pk_add_f32 v[168:169], v[168:169], v[138:139]
    v_pk_fma_f32 v[170:171], v[140:141], v[140:141], v[170:171]
    v_pk_add_f32 v[168:169], v[168:169], v[140:141]
    v_pk_fma_f32 v[170:171], v[142:143], v[142:143], v[170:171]
    v_pk_add_f32 v[168:169], v[168:169], v[142:143]
    v_pk_fma_f32 v[170:171], v[144:145], v[144:145], v[170:171]
    v_pk_add_f32 v[168:169], v[168:169], v[144:145]
    v_pk_fma_f32 v[170:171], v[146:147], v[146:147], v[170:171]
    v_pk_add_f32 v[168:169], v[168:169], v[146:147]
    v_add_f32 v168, v168, v169
    v_add_f32 v169, v170, v171
    v_mov_b32 v170, v168
    v_mov_b32 v171, v169
    s_nop 0
    v_permlane32_swap_b32 v168, v170
    v_permlane32_swap_b32 v169, v171
    v_pk_add_f32 v[168:169], v[168:169], v[170:171]
    s_barrier
    ds_read_b64 v[226:227], v14 offset:256
    ds_read_b64 v[228:229], v14 offset:512
    ds_read_b64 v[230:231], v14 offset:768
    s_waitcnt lgkmcnt(2)
    v_pk_add_f32 v[224:225], v[168:169], v[226:227]
    s_waitcnt lgkmcnt(0)
    v_pk_add_f32 v[228:229], v[228:229], v[230:231]
    v_pk_add_f32 v[224:225], v[224:225], v[228:229]
    v_min_u32 v225, -2, v225
    s_mov_b64 exec, 0xffffffff
    buffer_store_dwordx2 v[224:225], v13, s[8:11], s27 offen sc1
    s_mov_b64 exec, -1
    s_sleep 6
    s_nop 0
KF_A1_SP:
    buffer_load_dwordx2 v[238:239], v232, s[8:11], s26 offen sc1
    buffer_load_dwordx2 v[240:241], v233, s[8:11], s26 offen sc1
    s_waitcnt vmcnt(0)
    v_max_u32 v234, v239, v241
    v_cmp_eq_u32 vcc, -1, v234
    s_sub_u32 s68, s68, 1
    s_cselect_b64 s[36:37], 0, vcc
    s_cselect_b32 s68, 0, s68
    s_cmp_eq_u64 s[36:37], 0
    s_cbranch_scc1 KF_A1_SP_GO
    s_sleep 3
    s_branch KF_A1_SP
KF_A1_SP_GO:
    v_pk_add_f32 v[238:239], v[238:239], v[240:241]
    v_mov_b32 v240, v238
    v_mov_b32 v241, v239
    s_nop 0
    v_permlane32_swap_b32 v238, v240
    v_permlane32_swap_b32 v239, v241
    v_pk_add_f32 v[238:239], v[238:239], v[240:241]
    v_mul_f32 v238, s32, v238
    v_mul_f32 v240, v238, v238
    v_fma_f32 v239, v239, s32, -v240
    v_max_f32 v239, 0, v239
    v_add_f32 v239, s33, v239
    v_rsq_f32 v239, v239
    s_nop 0
    v_mul_f32 v238, v238, v239
    ds_write_b64 v14, v[238:239]
    s_waitcnt lgkmcnt(0)
    s_barrier
    v_pk_fma_f32 v[244:245], v[124:125], v[238:239], v[238:239] op_sel:[0,1,0] op_sel_hi:[1,1,0] neg_lo:[0,0,1] neg_hi:[0,0,1]
    v_pk_fma_f32 v[124:125], v[244:245], v[200:201], v[124:125]
    v_pk_fma_f32 v[246:247], v[126:127], v[238:239], v[238:239] op_sel:[0,1,0] op_sel_hi:[1,1,0] neg_lo:[0,0,1] neg_hi:[0,0,1]
    v_pk_fma_f32 v[126:127], v[246:247], v[202:203], v[126:127]
    v_pk_fma_f32 v[248:249], v[128:129], v[238:239], v[238:239] op_sel:[0,1,0] op_sel_hi:[1,1,0] neg_lo:[0,0,1] neg_hi:[0,0,1]
    v_pk_fma_f32 v[128:129], v[248:249], v[204:205], v[128:129]
    v_pk_fma_f32 v[250:251], v[130:131], v[238:239], v[238:239] op_sel:[0,1,0] op_sel_hi:[1,1,0] neg_lo:[0,0,1] neg_hi:[0,0,1]
    v_pk_fma_f32 v[130:131], v[250:251], v[206:207], v[130:131]
    v_cvt_pk_bf16_f32 v176, v124, v125
    v_cvt_pk_bf16_f32 v177, v126, v127
    v_cvt_pk_bf16_f32 v178, v128, v129
    v_cvt_pk_bf16_f32 v179, v130, v131
    buffer_store_dwordx4 v[176:179], v237, s[12:15], s40 offen offset:0
    v_pk_fma_f32 v[244:245], v[132:133], v[238:239], v[238:239] op_sel:[0,1,0] op_sel_hi:[1,1,0] neg_lo:[0,0,1] neg_hi:[0,0,1]
    v_pk_fma_f32 v[132:133], v[244:245], v[208:209], v[132:133]
    v_pk_fma_f32 v[246:247], v[134:135], v[238:239], v[238:239] op_sel:[0,1,0] op_sel_hi:[1,1,0] neg_lo:[0,0,1] neg_hi:[0,0,1]
    v_pk_fma_f32 v[134:135], v[246:247], v[210:211], v[134:135]
    v_pk_fma_f32 v[248:249], v[136:137], v[238:239], v[238:239] op_sel:[0,1,0] op_sel_hi:[1,1,0] neg_lo:[0,0,1] neg_hi:[0,0,1]
    v_pk_fma_f32 v[136:137], v[248:249], v[212:213], v[136:137]
    v_pk_fma_f32 v[250:251], v[138:139], v[238:239], v[238:239] op_sel:[0,1,0] op_sel_hi:[1,1,0] neg_lo:[0,0,1] neg_hi:[0,0,1]
    v_pk_fma_f32 v[138:139], v[250:251], v[214:215], v[138:139]
    v_cvt_pk_bf16_f32 v180, v132, v133
    v_cvt_pk_bf16_f32 v181, v134, v135
    v_cvt_pk_bf16_f32 v182, v136, v137
    v_cvt_pk_bf16_f32 v183, v138, v139
    buffer_store_dwordx4 v[180:183], v237, s[12:15], s40 offen offset:32
    v_pk_fma_f32 v[244:245], v[140:141], v[238:239], v[238:239] op_sel:[0,1,0] op_sel_hi:[1,1,0] neg_lo:[0,0,1] neg_hi:[0,0,1]
    v_pk_fma_f32 v[140:141], v[244:245], v[216:217], v[140:141]
    v_pk_fma_f32 v[246:247], v[142:143], v[238:239], v[238:239] op_sel:[0,1,0] op_sel_hi:[1,1,0] neg_lo:[0,0,1] neg_hi:[0,0,1]
    v_pk_fma_f32 v[142:143], v[246:247], v[218:219], v[142:143]
    v_pk_fma_f32 v[248:249], v[144:145], v[238:239], v[238:239] op_sel:[0,1,0] op_sel_hi:[1,1,0] neg_lo:[0,0,1] neg_hi:[0,0,1]
    v_pk_fma_f32 v[144:145], v[248:249], v[220:221], v[144:145]
    v_pk_fma_f32 v[250:251], v[146:147], v[238:239], v[238:239] op_sel:[0,1,0] op_sel_hi:[1,1,0] neg_lo:[0,0,1] neg_hi:[0,0,1]
    v_pk_fma_f32 v[146:147], v[250:251], v[222:223], v[146:147]
    v_cvt_pk_bf16_f32 v184, v140, v141
    v_cvt_pk_bf16_f32 v185, v142, v143
    v_cvt_pk_bf16_f32 v186, v144, v145
    v_cvt_pk_bf16_f32 v187, v146, v147
    buffer_store_dwordx4 v[184:187], v237, s[12:15], s40 offen offset:64
    s_endpgm
KF_NEXT:
    s_add_u32 s30, s29, 0
    s_add_u32 s31, s28, 21504
    s_mov_b32 m0, s30
    s_nop 0
    buffer_load_dwordx4 v2, s[8:11], s31 offen offset:0 lds
    buffer_load_dwordx4 v2, s[8:11], s31 offen offset:1024 lds
    buffer_load_dwordx4 v2, s[8:11], s31 offen offset:2048 lds
    buffer_load_dwordx4 v2, s[8:11], s31 offen offset:3072 lds
    s_add_u32 s30, s30, 4096
    s_add_u32 s31, s31, 4096
    s_mov_b32 m0, s30
    s_nop 0
    buffer_load_dwordx4 v2, s[8:11], s31 offen offset:0 lds
    s_mov_b64 exec, 0xffff
    buffer_load_dwordx4 v2, s[8:11], s31 offen offset:1024 lds
    s_mov_b64 exec, -1
    v_accvgpr_write_b32 a224, v176
    v_accvgpr_write_b32 a225, v177
    v_accvgpr_write_b32 a226, v178
    v_accvgpr_write_b32 a227, v179
    v_accvgpr_write_b32 a228, v180
    v_accvgpr_write_b32 a229, v181
    v_accvgpr_write_b32 a230, v182
    v_accvgpr_write_b32 a231, v183
    v_accvgpr_write_b32 a232, v184
    v_accvgpr_write_b32 a233, v185
    v_accvgpr_write_b32 a234, v186
    v_accvgpr_write_b32 a235, v187
    v_accvgpr_write_b32 a236, v148
    v_accvgpr_write_b32 a237, v149
    v_accvgpr_write_b32 a238, v150
    v_accvgpr_write_b32 a239, v151
    v_accvgpr_write_b32 a240, v152
    v_accvgpr_write_b32 a241, v153
    v_accvgpr_write_b32 a242, v154
    v_accvgpr_write_b32 a243, v155
    v_accvgpr_write_b32 a244, v156
    v_accvgpr_write_b32 a245, v157
    v_accvgpr_write_b32 a246, v158
    v_accvgpr_write_b32 a247, v159
    s_mov_b32 s25, 1
    s_mov_b32 s71, 0
    s_mov_b32 s12, s0
    s_mov_b32 s13, s1
    s_mov_b32 s14, 2359296
    s_mov_b32 s15, 0x20000
    v_lshrrev_b32 v8, 1, v4
    v_and_b32 v9, 1, v4
    v_lshlrev_b32 v7, 5, v8
    v_add_u32 v7, 150528, v7
    s_lshl_b32 s6, s3, 5
    v_lshl_add_u32 v10, v9, 4, v3
    v_add_u32 v15, s6, v10
    v_mul_u32_u24 v237, 1152, v10
    v_lshl_add_u32 v237, v8, 4, v237
    v_mul_u32_u24 v11, 10240, v8
    v_mul_u32_u24 v12, 80, v15
    v_add_u32 v11, v11, v12
    v_mul_u32_u24 v12, 6144, v8
    v_mul_u32_u24 v13, 48, v15
    v_add_u32 v12, v12, v13
    v_add_u32 v12, 20480, v12
    v_mul_u32_u24 v13, 18432, v9
    v_lshl_add_u32 v13, v3, 4, v13
    v_lshl_add_u32 v14, v8, 2, v13
    v_lshl_add_u32 v9, v8, 8, v13
    v_lshl_add_u32 v13, v8, 9, v13
    s_add_u32 s50, s22, 2359296
    s_lshr_b32 s6, s21, 1
    s_lshl_b32 s6, s6, 8
    s_and_b32 s7, s21, 1
    s_lshl_b32 s7, s7, 3
    s_add_u32 s6, s6, s7
    s_add_u32 s6, s6, 16384
    s_add_u32 s38, s50, s6
    s_lshl_b32 s6, s21, 10
    s_add_u32 s50, s50, s6
    s_mov_b32 s52, 0x100001
    s_mov_b32 s53, 0x10000100
    s_mov_b32 s54, 0x200002
    s_mov_b32 s55, 0x20000200
    s_mov_b32 s56, 0x400004
    s_mov_b32 s57, 0x40000400
    s_mov_b32 s58, 0x800008
    s_mov_b32 s59, 0x80000800
    s_lshr_b32 s6, s3, 1
    s_and_b32 s49, s3, 1
    v_lshrrev_b32 v238, 2, v3
    v_and_b32 v239, 3, v3
    v_lshl_add_u32 v240, v4, 3, v238
    s_mul_i32 s35, s6, 6144
    s_lshl_b32 s7, s49, 5
    s_add_u32 s35, s35, s7
    s_add_u32 s35, s35, 20480
    v_mul_u32_u24 v238, 48, v240
    v_lshl_add_u32 v238, v239, 3, v238
    v_add_u32 v238, s35, v238
    s_mul_i32 s35, s6, 10240
    v_mul_u32_u24 v240, 80, v240
    v_lshl_add_u32 v239, v239, 3, v240
    v_add_u32 v239, s35, v239
    v_mul_u32_u24 v240, 768, v4
    v_lshl_add_u32 v240, v3, 2, v240
    s_mul_i32 s39, s21, 7680
    s_add_u32 s39, s39, 14901248
    s_mul_i32 s35, s6, 3840
    s_add_u32 s51, s39, s35
    s_mul_i32 s35, s49, 3072
    s_add_u32 s51, s51, s35
    s_mul_i32 s35, s3, 1920
    s_add_u32 s39, s39, s35
    s_mul_i32 s35, s3, 960
    s_add_u32 s35, s35, 36864
    v_lshlrev_b32 v241, 3, v1
    v_add_u32 v241, s35, v241
    v_lshrrev_b32 v242, 1, v4
    v_mul_u32_u24 v242, 1920, v242
    v_and_b32 v243, 3, v3
    v_mul_u32_u24 v243, 96, v243
    v_add_u32 v242, v242, v243
    v_add_u32 v242, 36864, v242
    v_mov_b32 v243, 151552
    s_mov_b32 s36, 0x00f0000f
    s_mov_b32 s37, 0xf0000f00
    v_cndmask_b32 v242, v243, v242, s[36:37]
    s_mul_i32 s48, s60, 36864
    s_lshl_b32 s4, s63, 5
    s_add_u32 s40, s48, s4
    s_mul_i32 s6, s3, 9216
    s_add_u32 s45, s48, s6
    s_add_u32 s45, s45, 9863168
    s_add_u32 s46, s45, 4096
    s_add_u32 s47, s45, 8192
    v_add_u32 v236, s6, v2
    s_lshl_b32 s26, s60, 10
    s_add_u32 s26, s26, 14712832
    s_lshl_b32 s27, s61, 8
    s_add_u32 s27, s26, s27
    v_add_u32 v5, 107520, v2
    v_lshlrev_b32 v17, 9, v1
    v_add_u32 v17, 18928, v17
    s_waitcnt vmcnt(0)
    s_barrier
    s_nop 2
KF_XP:
    s_mov_b32 exec_hi, 15
    buffer_load_dword v16, v17, s[8:11], s22 offen offset:12 sc1
    s_waitcnt vmcnt(0)
    v_cmp_eq_u32 vcc, -1, v16
    s_mov_b32 exec_hi, -1
    s_sub_u32 s68, s68, 1
    s_cselect_b64 s[36:37], 0, vcc
    s_cselect_b32 s68, 0, s68
    s_cmp_eq_u64 s[36:37], 0
    s_cbranch_scc1 KF_XP_GO
    s_sleep 3
    s_branch KF_XP
KF_XP_GO:
KF_G2:
    s_add_u32 s30, s22, 4096
    buffer_load_dwordx4 v[64:67], v2, s[8:11], s30 offen offset:2048 sc1
    s_add_u32 s31, s22, 22528
    buffer_load_dwordx4 v[68:71], v2, s[8:11], s31 offen offset:2048 sc1
    buffer_load_dwordx4 v[72:75], v2, s[8:11], s30 offen offset:3072 sc1
    buffer_load_dwordx4 v[76:79], v2, s[8:11], s31 offen offset:3072 sc1
    s_add_u32 s30, s22, 8192
    buffer_load_dwordx4 v[80:83], v2, s[8:11], s30 offen offset:0 sc1
    s_add_u32 s31, s22, 26624
    buffer_load_dwordx4 v[84:87], v2, s[8:11], s31 offen offset:0 sc1
    buffer_load_dwordx4 v[88:91], v2, s[8:11], s30 offen offset:1024 sc1
    buffer_load_dwordx4 v[92:95], v2, s[8:11], s31 offen offset:1024 sc1
    buffer_load_dwordx4 v[96:99], v2, s[8:11], s30 offen offset:2048 sc1
    buffer_load_dwordx4 v[100:103], v2, s[8:11], s31 offen offset:2048 sc1
    ds_read_b128 a[0:3], v6 offset:0
    ds_read_b128 a[4:7], v6 offset:1024
    ds_read_b128 a[8:11], v6 offset:2048
    ds_read_b128 a[12:15], v6 offset:3072
    ds_read_b128 a[16:19], v6 offset:4096
    ds_read_b128 a[20:23], v6 offset:5120
    ds_read_b128 a[24:27], v6 offset:6144
    s_waitcnt vmcnt(9)
    v_mfma_f32_16x16x32_bf16 v[244:247], v[64:67], v[64:67], 0
    v_max_u32 v216, v64, v65
    s_waitcnt vmcnt(8)
    v_mfma_f32_16x16x32_bf16 v[248:251], v[68:71], v[68:71], 0
    s_waitcnt lgkmcnt(6)
    v_mfma_f32_16x16x32_bf16 v[160:163], a[0:3], v[64:67], 0
    ds_read_b128 a[28:31], v6 offset:7168
    v_mfma_f32_16x16x32_bf16 v[188:191], a[0:3], v[68:71], 0
    buffer_load_dwordx4 v[104:107], v2, s[8:11], s30 offen offset:3072 sc1
    s_waitcnt lgkmcnt(6)
    v_mfma_f32_16x16x32_bf16 v[164:167], a[4:7], v[64:67], 0
    ds_read_b128 a[32:35], v6 offset:8192
    v_max3_u32 v216, v216, v66, v67
    v_mfma_f32_16x16x32_bf16 v[192:195], a[4:7], v[68:71], 0
    buffer_load_dwordx4 v[108:111], v2, s[8:11], s31 offen offset:3072 sc1
    s_waitcnt lgkmcnt(6)
    v_mfma_f32_16x16x32_bf16 v[168:171], a[8:11], v[64:67], 0
    ds_read_b128 a[36:39], v6 offset:9216
    v_mfma_f32_16x16x32_bf16 v[196:199], a[8:11], v[68:71], 0
    s_waitcnt lgkmcnt(6)
    v_mfma_f32_16x16x32_bf16 v[172:175], a[12:15], v[64:67], 0
    ds_read_b128 a[40:43], v6 offset:10240
    v_max3_u32 v216, v216, v68, v69
    v_mfma_f32_16x16x32_bf16 v[200:203], a[12:15], v[68:71], 0
    s_waitcnt lgkmcnt(6)
    v_mfma_f32_16x16x32_bf16 v[176:179], a[16:19], v[64:67], 0
    ds_read_b128 a[44:47], v6 offset:11264
    v_mfma_f32_16x16x32_bf16 v[204:207], a[16:19], v[68:71], 0
    s_waitcnt lgkmcnt(6)
    v_mfma_f32_16x16x32_bf16 v[180:183], a[20:23], v[64:67], 0
    ds_read_b128 a[48:51], v6 offset:12288
    v_max3_u32 v216, v216, v70, v71
    v_mfma_f32_16x16x32_bf16 v[208:211], a[20:23], v[68:71], 0
    s_waitcnt lgkmcnt(6)
    v_mfma_f32_16x16x32_bf16 v[184:187], a[24:27], v[64:67], 0
    ds_read_b128 a[52:55], v6 offset:13312
    v_mfma_f32_16x16x32_bf16 v[212:215], a[24:27], v[68:71], 0
    s_waitcnt vmcnt(9)
    v_mfma_f32_16x16x32_bf16 v[244:247], v[72:75], v[72:75], v[244:247]
    v_max3_u32 v216, v216, v72, v73
    s_waitcnt vmcnt(8)
    v_mfma_f32_16x16x32_bf16 v[248:251], v[76:79], v[76:79], v[248:251]
    s_waitcnt lgkmcnt(6)
    v_mfma_f32_16x16x32_bf16 v[160:163], a[28:31], v[72:75], v[160:163]
    ds_read_b128 a[0:3], v6 offset:14336
    v_mfma_f32_16x16x32_bf16 v[188:191], a[28:31], v[76:79], v[188:191]
    s_add_u32 s30, s22, 12288
    buffer_load_dwordx4 v[112:115], v2, s[8:11], s30 offen offset:0 sc1
    s_waitcnt lgkmcnt(6)
    v_mfma_f32_16x16x32_bf16 v[164:167], a[32:35], v[72:75], v[164:167]
    ds_read_b128 a[4:7], v6 offset:15360
    v_max3_u32 v216, v216, v74, v75
    v_mfma_f32_16x16x32_bf16 v[192:195], a[32:35], v[76:79], v[192:195]
    s_add_u32 s31, s22, 30720
    buffer_load_dwordx4 v[116:119], v2, s[8:11], s31 offen offset:0 sc1
    s_waitcnt lgkmcnt(6)
    v_mfma_f32_16x16x32_bf16 v[168:171], a[36:39], v[72:75], v[168:171]
    ds_read_b128 a[8:11], v6 offset:16384
    v_mfma_f32_16x16x32_bf16 v[196:199], a[36:39], v[76:79], v[196:199]
    s_waitcnt lgkmcnt(6)
    v_mfma_f32_16x16x32_bf16 v[172:175], a[40:43], v[72:75], v[172:175]
    ds_read_b128 a[12:15], v6 offset:17408
    v_max3_u32 v216, v216, v76, v77
    v_mfma_f32_16x16x32_bf16 v[200:203], a[40:43], v[76:79], v[200:203]
    s_waitcnt lgkmcnt(6)
    v_mfma_f32_16x16x32_bf16 v[176:179], a[44:47], v[72:75], v[176:179]
    ds_read_b128 a[16:19], v6 offset:18432
    v_mfma_f32_16x16x32_bf16 v[204:207], a[44:47], v[76:79], v[204:207]
    s_waitcnt lgkmcnt(6)
    v_mfma_f32_16x16x32_bf16 v[180:183], a[48:51], v[72:75], v[180:183]
    ds_read_b128 a[20:23], v6 offset:19456
    v_max3_u32 v216, v216, v78, v79
    v_mfma_f32_16x16x32_bf16 v[208:211], a[48:51], v[76:79], v[208:211]
    s_waitcnt lgkmcnt(6)
    v_mfma_f32_16x16x32_bf16 v[184:187], a[52:55], v[72:75], v[184:187]
    ds_read_b128 a[24:27], v6 offset:20480
    v_mfma_f32_16x16x32_bf16 v[212:215], a[52:55], v[76:79], v[212:215]
    s_waitcnt vmcnt(9)
    v_mfma_f32_16x16x32_bf16 v[244:247], v[80:83], v[80:83], v[244:247]
    v_max3_u32 v216, v216, v80, v81
    s_waitcnt vmcnt(8)
    v_mfma_f32_16x16x32_bf16 v[248:251], v[84:87], v[84:87], v[248:251]
    s_waitcnt lgkmcnt(6)
    v_mfma_f32_16x16x32_bf16 v[160:163], a[0:3], v[80:83], v[160:163]
    ds_read_b128 a[28:31], v6 offset:21504
    v_mfma_f32_16x16x32_bf16 v[188:191], a[0:3], v[84:87], v[188:191]
    buffer_load_dwordx4 v[120:123], v2, s[8:11], s30 offen offset:1024 sc1
    s_waitcnt lgkmcnt(6)
    v_mfma_f32_16x16x32_bf16 v[164:167], a[4:7], v[80:83], v[164:167]
    ds_read_b128 a[32:35], v6 offset:22528
    v_max3_u32 v216, v216, v82, v83
    v_mfma_f32_16x16x32_bf16 v[192:195], a[4:7], v[84:87], v[192:195]
    buffer_load_dwordx4 v[124:127], v2, s[8:11], s31 offen offset:1024 sc1
    s_waitcnt lgkmcnt(6)
    v_mfma_f32_16x16x32_bf16 v[168:171], a[8:11], v[80:83], v[168:171]
    ds_read_b128 a[36:39], v6 offset:23552
    v_mfma_f32_16x16x32_bf16 v[196:199], a[8:11], v[84:87], v[196:199]
    s_waitcnt lgkmcnt(6)
    v_mfma_f32_16x16x32_bf16 v[172:175], a[12:15], v[80:83], v[172:175]
    ds_read_b128 a[40:43], v6 offset:24576
    v_max3_u32 v216, v216, v84, v85
    v_mfma_f32_16x16x32_bf16 v[200:203], a[12:15], v[84:87], v[200:203]
    s_waitcnt lgkmcnt(6)
    v_mfma_f32_16x16x32_bf16 v[176:179], a[16:19], v[80:83], v[176:179]
    ds_read_b128 a[44:47], v6 offset:25600
    v_mfma_f32_16x16x32_bf16 v[204:207], a[16:19], v[84:87], v[204:207]
    s_waitcnt lgkmcnt(6)
    v_mfma_f32_16x16x32_bf16 v[180:183], a[20:23], v[80:83], v[180:183]
    ds_read_b128 a[48:51], v6 offset:26624
    v_max3_u32 v216, v216, v86, v87
    v_mfma_f32_16x16x32_bf16 v[208:211], a[20:23], v[84:87], v[208:211]
    s_waitcnt lgkmcnt(6)
    v_mfma_f32_16x16x32_bf16 v[184:187], a[24:27], v[80:83], v[184:187]
    ds_read_b128 a[52:55], v6 offset:27648
    v_mfma_f32_16x16x32_bf16 v[212:215], a[24:27], v[84:87], v[212:215]
    s_waitcnt vmcnt(9)
    v_mfma_f32_16x16x32_bf16 v[244:247], v[88:91], v[88:91], v[244:247]
    v_max3_u32 v216, v216, v88, v89
    s_waitcnt vmcnt(8)
    v_mfma_f32_16x16x32_bf16 v[248:251], v[92:95], v[92:95], v[248:251]
    s_waitcnt lgkmcnt(6)
    v_mfma_f32_16x16x32_bf16 v[160:163], a[28:31], v[88:91], v[160:163]
    ds_read_b128 a[0:3], v6 offset:28672
    v_mfma_f32_16x16x32_bf16 v[188:191], a[28:31], v[92:95], v[188:191]
    buffer_load_dwordx4 v[128:131], v2, s[8:11], s30 offen offset:2048 sc1
    s_waitcnt lgkmcnt(6)
    v_mfma_f32_16x16x32_bf16 v[164:167], a[32:35], v[88:91], v[164:167]
    ds_read_b128 a[4:7], v6 offset:29696
    v_max3_u32 v216, v216, v90, v91
    v_mfma_f32_16x16x32_bf16 v[192:195], a[32:35], v[92:95], v[192:195]
    buffer_load_dwordx4 v[132:135], v2, s[8:11], s31 offen offset:2048 sc1
    s_waitcnt lgkmcnt(6)
    v_mfma_f32_16x16x32_bf16 v[168:171], a[36:39], v[88:91], v[168:171]
    ds_read_b128 a[8:11], v6 offset:30720
    v_mfma_f32_16x16x32_bf16 v[196:199], a[36:39], v[92:95], v[196:199]
    s_waitcnt lgkmcnt(6)
    v_mfma_f32_16x16x32_bf16 v[172:175], a[40:43], v[88:91], v[172:175]
    ds_read_b128 a[12:15], v6 offset:31744
    v_max3_u32 v216, v216, v92, v93
    v_mfma_f32_16x16x32_bf16 v[200:203], a[40:43], v[92:95], v[200:203]
    s_waitcnt lgkmcnt(6)
    v_mfma_f32_16x16x32_bf16 v[176:179], a[44:47], v[88:91], v[176:179]
    ds_read_b128 a[16:19], v6 offset:32768
    v_mfma_f32_16x16x32_bf16 v[204:207], a[44:47], v[92:95], v[204:207]
    s_waitcnt lgkmcnt(6)
    v_mfma_f32_16x16x32_bf16 v[180:183], a[48:51], v[88:91], v[180:183]
    ds_read_b128 a[20:23], v6 offset:33792
    v_max3_u32 v216, v216, v94, v95
    v_mfma_f32_16x16x32_bf16 v[208:211], a[48:51], v[92:95], v[208:211]
    s_waitcnt lgkmcnt(6)
    v_mfma_f32_16x16x32_bf16 v[184:187], a[52:55], v[88:91], v[184:187]
    ds_read_b128 a[24:27], v6 offset:34816
    v_mfma_f32_16x16x32_bf16 v[212:215], a[52:55], v[92:95], v[212:215]
    s_waitcnt vmcnt(9)
    v_mfma_f32_16x16x32_bf16 v[244:247], v[96:99], v[96:99], v[244:247]
    v_max3_u32 v216, v216, v96, v97
    s_waitcnt vmcnt(8)
    v_mfma_f32_16x16x32_bf16 v[248:251], v[100:103], v[100:103], v[248:251]
    s_waitcnt lgkmcnt(6)
    v_mfma_f32_16x16x32_bf16 v[160:163], a[0:3], v[96:99], v[160:163]
    ds_read_b128 a[28:31], v6 offset:35840
    v_mfma_f32_16x16x32_bf16 v[188:191], a[0:3], v[100:103], v[188:191]
    buffer_load_dwordx4 v[136:139], v2, s[8:11], s30 offen offset:3072 sc1
    s_waitcnt lgkmcnt(6)
    v_mfma_f32_16x16x32_bf16 v[164:167], a[4:7], v[96:99], v[164:167]
    ds_read_b128 a[32:35], v6 offset:36864
    v_max3_u32 v216, v216, v98, v99
    v_mfma_f32_16x16x32_bf16 v[192:195], a[4:7], v[100:103], v[192:195]
    buffer_load_dwordx4 v[140:143], v2, s[8:11], s31 offen offset:3072 sc1
    s_waitcnt lgkmcnt(6)
    v_mfma_f32_16x16x32_bf16 v[168:171], a[8:11], v[96:99], v[168:171]
    ds_read_b128 a[36:39], v6 offset:37888
    v_mfma_f32_16x16x32_bf16 v[196:199], a[8:11], v[100:103], v[196:199]
    s_waitcnt lgkmcnt(6)
    v_mfma_f32_16x16x32_bf16 v[172:175], a[12:15], v[96:99], v[172:175]
    ds_read_b128 a[40:43], v6 offset:38912
    v_max3_u32 v216, v216, v100, v101
    v_mfma_f32_16x16x32_bf16 v[200:203], a[12:15], v[100:103], v[200:203]
    s_waitcnt lgkmcnt(6)
    v_mfma_f32_16x16x32_bf16 v[176:179], a[16:19], v[96:99], v[176:179]
    ds_read_b128 a[44:47], v6 offset:39936
    v_mfma_f32_16x16x32_bf16 v[204:207], a[16:19], v[100:103], v[204:207]
    s_waitcnt lgkmcnt(6)
    v_mfma_f32_16x16x32_bf16 v[180:183], a[20:23], v[96:99], v[180:183]
    ds_read_b128 a[48:51], v6 offset:40960
    v_max3_u32 v216, v216, v102, v103
    v_mfma_f32_16x16x32_bf16 v[208:211], a[20:23], v[100:103], v[208:211]
    s_waitcnt lgkmcnt(6)
    v_mfma_f32_16x16x32_bf16 v[184:187], a[24:27], v[96:99], v[184:187]
    ds_read_b128 a[52:55], v6 offset:41984
    v_mfma_f32_16x16x32_bf16 v[212:215], a[24:27], v[100:103], v[212:215]
    s_waitcnt vmcnt(9)
    v_mfma_f32_16x16x32_bf16 v[244:247], v[104:107], v[104:107], v[244:247]
    v_max3_u32 v216, v216, v104, v105
    s_waitcnt vmcnt(8)
    v_mfma_f32_16x16x32_bf16 v[248:251], v[108:111], v[108:111], v[248:251]
    s_waitcnt lgkmcnt(6)
    v_mfma_f32_16x16x32_bf16 v[160:163], a[28:31], v[104:107], v[160:163]
    ds_read_b128 a[0:3], v6 offset:43008
    v_mfma_f32_16x16x32_bf16 v[188:191], a[28:31], v[108:111], v[188:191]
    s_add_u32 s30, s22, 16384
    buffer_load_dwordx4 v[144:147], v2, s[8:11], s30 offen offset:0 sc1
    s_waitcnt lgkmcnt(6)
    v_mfma_f32_16x16x32_bf16 v[164:167], a[32:35], v[104:107], v[164:167]
    ds_read_b128 a[4:7], v6 offset:44032
    v_max3_u32 v216, v216, v106, v107
    v_mfma_f32_16x16x32_bf16 v[192:195], a[32:35], v[108:111], v[192:195]
    s_add_u32 s31, s22, 34816
    buffer_load_dwordx4 v[148:151], v2, s[8:11], s31 offen offset:0 sc1
    s_waitcnt lgkmcnt(6)
    v_mfma_f32_16x16x32_bf16 v[168:171], a[36:39], v[104:107], v[168:171]
    ds_read_b128 a[8:11], v6 offset:45056
    v_mfma_f32_16x16x32_bf16 v[196:199], a[36:39], v[108:111], v[196:199]
    s_waitcnt lgkmcnt(6)
    v_mfma_f32_16x16x32_bf16 v[172:175], a[40:43], v[104:107], v[172:175]
    ds_read_b128 a[12:15], v6 offset:46080
    v_max3_u32 v216, v216, v108, v109
    v_mfma_f32_16x16x32_bf16 v[200:203], a[40:43], v[108:111], v[200:203]
    s_waitcnt lgkmcnt(6)
    v_mfma_f32_16x16x32_bf16 v[176:179], a[44:47], v[104:107], v[176:179]
    ds_read_b128 a[16:19], v6 offset:47104
    v_mfma_f32_16x16x32_bf16 v[204:207], a[44:47], v[108:111], v[204:207]
    s_waitcnt lgkmcnt(6)
    v_mfma_f32_16x16x32_bf16 v[180:183], a[48:51], v[104:107], v[180:183]
    ds_read_b128 a[20:23], v6 offset:48128
    v_max3_u32 v216, v216, v110, v111
    v_mfma_f32_16x16x32_bf16 v[208:211], a[48:51], v[108:111], v[208:211]
    s_waitcnt lgkmcnt(6)
    v_mfma_f32_16x16x32_bf16 v[184:187], a[52:55], v[104:107], v[184:187]
    ds_read_b128 a[24:27], v6 offset:49152
    v_mfma_f32_16x16x32_bf16 v[212:215], a[52:55], v[108:111], v[212:215]
    s_waitcnt vmcnt(9)
    v_mfma_f32_16x16x32_bf16 v[244:247], v[112:115], v[112:115], v[244:247]
    v_max3_u32 v216, v216, v112, v113
    s_waitcnt vmcnt(8)
    v_mfma_f32_16x16x32_bf16 v[248:251], v[116:119], v[116:119], v[248:251]
    s_waitcnt lgkmcnt(6)
    v_mfma_f32_16x16x32_bf16 v[160:163], a[0:3], v[112:115], v[160:163]
    ds_read_b128 a[28:31], v6 offset:50176
    v_mfma_f32_16x16x32_bf16 v[188:191], a[0:3], v[116:119], v[188:191]
    buffer_load_dwordx4 v[152:155], v2, s[8:11], s30 offen offset:1024 sc1
    s_waitcnt lgkmcnt(6)
    v_mfma_f32_16x16x32_bf16 v[164:167], a[4:7], v[112:115], v[164:167]
    ds_read_b128 a[32:35], v6 offset:51200
    v_max3_u32 v216, v216, v114, v115
    v_mfma_f32_16x16x32_bf16 v[192:195], a[4:7], v[116:119], v[192:195]
    buffer_load_dwordx4 v[156:159], v2, s[8:11], s31 offen offset:1024 sc1
    s_waitcnt lgkmcnt(6)
    v_mfma_f32_16x16x32_bf16 v[168:171], a[8:11], v[112:115], v[168:171]
    ds_read_b128 a[36:39], v6 offset:52224
    v_mfma_f32_16x16x32_bf16 v[196:199], a[8:11], v[116:119], v[196:199]
    s_waitcnt lgkmcnt(6)
    v_mfma_f32_16x16x32_bf16 v[172:175], a[12:15], v[112:115], v[172:175]
    ds_read_b128 a[40:43], v6 offset:53248
    v_max3_u32 v216, v216, v116, v117
    v_mfma_f32_16x16x32_bf16 v[200:203], a[12:15], v[116:119], v[200:203]
    s_waitcnt lgkmcnt(6)
    v_mfma_f32_16x16x32_bf16 v[176:179], a[16:19], v[112:115], v[176:179]
    ds_read_b128 a[44:47], v6 offset:54272
    v_mfma_f32_16x16x32_bf16 v[204:207], a[16:19], v[116:119], v[204:207]
    s_waitcnt lgkmcnt(6)
    v_mfma_f32_16x16x32_bf16 v[180:183], a[20:23], v[112:115], v[180:183]
    ds_read_b128 a[48:51], v6 offset:55296
    v_max3_u32 v216, v216, v118, v119
    v_mfma_f32_16x16x32_bf16 v[208:211], a[20:23], v[116:119], v[208:211]
    s_waitcnt lgkmcnt(6)
    v_mfma_f32_16x16x32_bf16 v[184:187], a[24:27], v[112:115], v[184:187]
    ds_read_b128 a[52:55], v6 offset:56320
    v_mfma_f32_16x16x32_bf16 v[212:215], a[24:27], v[116:119], v[212:215]
    s_waitcnt vmcnt(9)
    v_mfma_f32_16x16x32_bf16 v[244:247], v[120:123], v[120:123], v[244:247]
    v_max3_u32 v216, v216, v120, v121
    s_waitcnt vmcnt(8)
    v_mfma_f32_16x16x32_bf16 v[248:251], v[124:127], v[124:127], v[248:251]
    s_waitcnt lgkmcnt(6)
    v_mfma_f32_16x16x32_bf16 v[160:163], a[28:31], v[120:123], v[160:163]
    ds_read_b128 a[0:3], v6 offset:57344
    v_mfma_f32_16x16x32_bf16 v[188:191], a[28:31], v[124:127], v[188:191]
    s_add_u32 s30, s22, 0
    buffer_load_dwordx4 v[16:19], v2, s[8:11], s30 offen offset:0 sc1
    s_waitcnt lgkmcnt(6)
    v_mfma_f32_16x16x32_bf16 v[164:167], a[32:35], v[120:123], v[164:167]
    ds_read_b128 a[4:7], v6 offset:58368
    v_max3_u32 v216, v216, v122, v123
    v_mfma_f32_16x16x32_bf16 v[192:195], a[32:35], v[124:127], v[192:195]
    s_add_u32 s31, s22, 18432
    buffer_load_dwordx4 v[20:23], v2, s[8:11], s31 offen offset:0 sc1
    s_waitcnt lgkmcnt(6)
    v_mfma_f32_16x16x32_bf16 v[168:171], a[36:39], v[120:123], v[168:171]
    ds_read_b128 a[8:11], v6 offset:59392
    v_mfma_f32_16x16x32_bf16 v[196:199], a[36:39], v[124:127], v[196:199]
    s_waitcnt lgkmcnt(6)
    v_mfma_f32_16x16x32_bf16 v[172:175], a[40:43], v[120:123], v[172:175]
    ds_read_b128 a[12:15], v6 offset:60416
    v_max3_u32 v216, v216, v124, v125
    v_mfma_f32_16x16x32_bf16 v[200:203], a[40:43], v[124:127], v[200:203]
    s_waitcnt lgkmcnt(6)
    v_mfma_f32_16x16x32_bf16 v[176:179], a[44:47], v[120:123], v[176:179]
    ds_read_b128 a[16:19], v6 offset:61440
    v_mfma_f32_16x16x32_bf16 v[204:207], a[44:47], v[124:127], v[204:207]
    s_waitcnt lgkmcnt(6)
    v_mfma_f32_16x16x32_bf16 v[180:183], a[48:51], v[120:123], v[180:183]
    ds_read_b128 a[20:23], v6 offset:62464
    v_max3_u32 v216, v216, v126, v127
    v_mfma_f32_16x16x32_bf16 v[208:211], a[48:51], v[124:127], v[208:211]
    s_waitcnt lgkmcnt(6)
    v_mfma_f32_16x16x32_bf16 v[184:187], a[52:55], v[120:123], v[184:187]
    ds_read_b128 a[24:27], v6 offset:63488
    v_mfma_f32_16x16x32_bf16 v[212:215], a[52:55], v[124:127], v[212:215]
    s_waitcnt vmcnt(9)
    v_mfma_f32_16x16x32_bf16 v[244:247], v[128:131], v[128:131], v[244:247]
    v_max3_u32 v216, v216, v128, v129
    s_waitcnt vmcnt(8)
    v_mfma_f32_16x16x32_bf16 v[248:251], v[132:135], v[132:135], v[248:251]
    s_waitcnt lgkmcnt(6)
    v_mfma_f32_16x16x32_bf16 v[160:163], a[0:3], v[128:131], v[160:163]
    ds_read_b128 a[28:31], v5 offset:0
    v_mfma_f32_16x16x32_bf16 v[188:191], a[0:3], v[132:135], v[188:191]
    buffer_load_dwordx4 v[24:27], v2, s[8:11], s30 offen offset:1024 sc1
    s_waitcnt lgkmcnt(6)
    v_mfma_f32_16x16x32_bf16 v[164:167], a[4:7], v[128:131], v[164:167]
    ds_read_b128 a[32:35], v5 offset:1024
    v_max3_u32 v216, v216, v130, v131
    v_mfma_f32_16x16x32_bf16 v[192:195], a[4:7], v[132:135], v[192:195]
    buffer_load_dwordx4 v[28:31], v2, s[8:11], s31 offen offset:1024 sc1
    s_waitcnt lgkmcnt(6)
    v_mfma_f32_16x16x32_bf16 v[168:171], a[8:11], v[128:131], v[168:171]
    ds_read_b128 a[36:39], v5 offset:2048
    v_mfma_f32_16x16x32_bf16 v[196:199], a[8:11], v[132:135], v[196:199]
    s_waitcnt lgkmcnt(6)
    v_mfma_f32_16x16x32_bf16 v[172:175], a[12:15], v[128:131], v[172:175]
    ds_read_b128 a[40:43], v5 offset:3072
    v_max3_u32 v216, v216, v132, v133
    v_mfma_f32_16x16x32_bf16 v[200:203], a[12:15], v[132:135], v[200:203]
    s_waitcnt lgkmcnt(6)
    v_mfma_f32_16x16x32_bf16 v[176:179], a[16:19], v[128:131], v[176:179]
    ds_read_b128 a[44:47], v5 offset:4096
    v_mfma_f32_16x16x32_bf16 v[204:207], a[16:19], v[132:135], v[204:207]
    s_waitcnt lgkmcnt(6)
    v_mfma_f32_16x16x32_bf16 v[180:183], a[20:23], v[128:131], v[180:183]
    ds_read_b128 a[48:51], v5 offset:5120
    v_max3_u32 v216, v216, v134, v135
    v_mfma_f32_16x16x32_bf16 v[208:211], a[20:23], v[132:135], v[208:211]
    s_waitcnt lgkmcnt(6)
    v_mfma_f32_16x16x32_bf16 v[184:187], a[24:27], v[128:131], v[184:187]
    ds_read_b128 a[52:55], v5 offset:6144
    v_mfma_f32_16x16x32_bf16 v[212:215], a[24:27], v[132:135], v[212:215]
    s_waitcnt vmcnt(9)
    v_mfma_f32_16x16x32_bf16 v[244:247], v[136:139], v[136:139], v[244:247]
    v_max3_u32 v216, v216, v136, v137
    s_waitcnt vmcnt(8)
    v_mfma_f32_16x16x32_bf16 v[248:251], v[140:143], v[140:143], v[248:251]
    s_waitcnt lgkmcnt(6)
    v_mfma_f32_16x16x32_bf16 v[160:163], a[28:31], v[136:139], v[160:163]
    ds_read_b128 a[0:3], v5 offset:7168
    v_mfma_f32_16x16x32_bf16 v[188:191], a[28:31], v[140:143], v[188:191]
    buffer_load_dwordx4 v[32:35], v2, s[8:11], s30 offen offset:2048 sc1
    s_waitcnt lgkmcnt(6)
    v_mfma_f32_16x16x32_bf16 v[164:167], a[32:35], v[136:139], v[164:167]
    ds_read_b128 a[4:7], v5 offset:8192
    v_max3_u32 v216, v216, v138, v139
    v_mfma_f32_16x16x32_bf16 v[192:195], a[32:35], v[140:143], v[192:195]
    buffer_load_dwordx4 v[36:39], v2, s[8:11], s31 offen offset:2048 sc1
    s_waitcnt lgkmcnt(6)
    v_mfma_f32_16x16x32_bf16 v[168:171], a[36:39], v[136:139], v[168:171]
    ds_read_b128 a[8:11], v5 offset:9216
    v_mfma_f32_16x16x32_bf16 v[196:199], a[36:39], v[140:143], v[196:199]
    s_waitcnt lgkmcnt(6)
    v_mfma_f32_16x16x32_bf16 v[172:175], a[40:43], v[136:139], v[172:175]
    ds_read_b128 a[12:15], v5 offset:10240
    v_max3_u32 v216, v216, v140, v141
    v_mfma_f32_16x16x32_bf16 v[200:203], a[40:43], v[140:143], v[200:203]
    s_waitcnt lgkmcnt(6)
    v_mfma_f32_16x16x32_bf16 v[176:179], a[44:47], v[136:139], v[176:179]
    ds_read_b128 a[16:19], v5 offset:11264
    v_mfma_f32_16x16x32_bf16 v[204:207], a[44:47], v[140:143], v[204:207]
    s_waitcnt lgkmcnt(6)
    v_mfma_f32_16x16x32_bf16 v[180:183], a[48:51], v[136:139], v[180:183]
    ds_read_b128 a[20:23], v5 offset:12288
    v_max3_u32 v216, v216, v142, v143
    v_mfma_f32_16x16x32_bf16 v[208:211], a[48:51], v[140:143], v[208:211]
    s_waitcnt lgkmcnt(6)
    v_mfma_f32_16x16x32_bf16 v[184:187], a[52:55], v[136:139], v[184:187]
    ds_read_b128 a[24:27], v5 offset:13312
    v_mfma_f32_16x16x32_bf16 v[212:215], a[52:55], v[140:143], v[212:215]
    s_waitcnt vmcnt(9)
    v_mfma_f32_16x16x32_bf16 v[244:247], v[144:147], v[144:147], v[244:247]
    v_max3_u32 v216, v216, v144, v145
    s_waitcnt vmcnt(8)
    v_mfma_f32_16x16x32_bf16 v[248:251], v[148:151], v[148:151], v[248:251]
    s_waitcnt lgkmcnt(6)
    v_mfma_f32_16x16x32_bf16 v[160:163], a[0:3], v[144:147], v[160:163]
    ds_read_b128 a[28:31], v5 offset:14336
    v_mfma_f32_16x16x32_bf16 v[188:191], a[0:3], v[148:151], v[188:191]
    buffer_load_dwordx4 v[40:43], v2, s[8:11], s30 offen offset:3072 sc1
    s_waitcnt lgkmcnt(6)
    v_mfma_f32_16x16x32_bf16 v[164:167], a[4:7], v[144:147], v[164:167]
    ds_read_b128 a[32:35], v5 offset:15360
    v_max3_u32 v216, v216, v146, v147
    v_mfma_f32_16x16x32_bf16 v[192:195], a[4:7], v[148:151], v[192:195]
    buffer_load_dwordx4 v[44:47], v2, s[8:11], s31 offen offset:3072 sc1
    s_waitcnt lgkmcnt(6)
    v_mfma_f32_16x16x32_bf16 v[168:171], a[8:11], v[144:147], v[168:171]
    ds_read_b128 a[36:39], v5 offset:16384
    v_mfma_f32_16x16x32_bf16 v[196:199], a[8:11], v[148:151], v[196:199]
    s_waitcnt lgkmcnt(6)
    v_mfma_f32_16x16x32_bf16 v[172:175], a[12:15], v[144:147], v[172:175]
    ds_read_b128 a[40:43], v5 offset:17408
    v_max3_u32 v216, v216, v148, v149
    v_mfma_f32_16x16x32_bf16 v[200:203], a[12:15], v[148:151], v[200:203]
    s_waitcnt lgkmcnt(6)
    v_mfma_f32_16x16x32_bf16 v[176:179], a[16:19], v[144:147], v[176:179]
    ds_read_b128 a[44:47], v5 offset:18432
    v_mfma_f32_16x16x32_bf16 v[204:207], a[16:19], v[148:151], v[204:207]
    s_waitcnt lgkmcnt(6)
    v_mfma_f32_16x16x32_bf16 v[180:183], a[20:23], v[144:147], v[180:183]
    ds_read_b128 a[48:51], v5 offset:19456
    v_max3_u32 v216, v216, v150, v151
    v_mfma_f32_16x16x32_bf16 v[208:211], a[20:23], v[148:151], v[208:211]
    s_waitcnt lgkmcnt(6)
    v_mfma_f32_16x16x32_bf16 v[184:187], a[24:27], v[144:147], v[184:187]
    ds_read_b128 a[52:55], v5 offset:20480
    v_mfma_f32_16x16x32_bf16 v[212:215], a[24:27], v[148:151], v[212:215]
    s_waitcnt vmcnt(9)
    v_mfma_f32_16x16x32_bf16 v[244:247], v[152:155], v[152:155], v[244:247]
    v_max3_u32 v216, v216, v152, v153
    s_waitcnt vmcnt(8)
    v_mfma_f32_16x16x32_bf16 v[248:251], v[156:159], v[156:159], v[248:251]
    s_waitcnt lgkmcnt(6)
    v_mfma_f32_16x16x32_bf16 v[160:163], a[28:31], v[152:155], v[160:163]
    ds_read_b128 a[0:3], v5 offset:21504
    v_mfma_f32_16x16x32_bf16 v[188:191], a[28:31], v[156:159], v[188:191]
    s_add_u32 s30, s22, 4096
    buffer_load_dwordx4 v[48:51], v2, s[8:11], s30 offen offset:0 sc1
    s_waitcnt lgkmcnt(6)
    v_mfma_f32_16x16x32_bf16 v[164:167], a[32:35], v[152:155], v[164:167]
    ds_read_b128 a[4:7], v5 offset:22528
    v_max3_u32 v216, v216, v154, v155
    v_mfma_f32_16x16x32_bf16 v[192:195], a[32:35], v[156:159], v[192:195]
    s_add_u32 s31, s22, 22528
    buffer_load_dwordx4 v[52:55], v2, s[8:11], s31 offen offset:0 sc1
    s_waitcnt lgkmcnt(6)
    v_mfma_f32_16x16x32_bf16 v[168:171], a[36:39], v[152:155], v[168:171]
    ds_read_b128 a[8:11], v5 offset:23552
    v_mfma_f32_16x16x32_bf16 v[196:199], a[36:39], v[156:159], v[196:199]
    s_waitcnt lgkmcnt(6)
    v_mfma_f32_16x16x32_bf16 v[172:175], a[40:43], v[152:155], v[172:175]
    ds_read_b128 a[12:15], v5 offset:24576
    v_max3_u32 v216, v216, v156, v157
    v_mfma_f32_16x16x32_bf16 v[200:203], a[40:43], v[156:159], v[200:203]
    s_waitcnt lgkmcnt(6)
    v_mfma_f32_16x16x32_bf16 v[176:179], a[44:47], v[152:155], v[176:179]
    ds_read_b128 a[16:19], v5 offset:25600
    v_mfma_f32_16x16x32_bf16 v[204:207], a[44:47], v[156:159], v[204:207]
    s_waitcnt lgkmcnt(6)
    v_mfma_f32_16x16x32_bf16 v[180:183], a[48:51], v[152:155], v[180:183]
    ds_read_b128 a[20:23], v5 offset:26624
    v_max3_u32 v216, v216, v158, v159
    v_mfma_f32_16x16x32_bf16 v[208:211], a[48:51], v[156:159], v[208:211]
    s_waitcnt lgkmcnt(6)
    v_mfma_f32_16x16x32_bf16 v[184:187], a[52:55], v[152:155], v[184:187]
    ds_read_b128 a[24:27], v5 offset:27648
    v_mfma_f32_16x16x32_bf16 v[212:215], a[52:55], v[156:159], v[212:215]
    s_waitcnt vmcnt(9)
    v_mfma_f32_16x16x32_bf16 v[244:247], v[16:19], v[16:19], v[244:247]
    v_max3_u32 v216, v216, v16, v17
    s_waitcnt vmcnt(8)
    v_mfma_f32_16x16x32_bf16 v[248:251], v[20:23], v[20:23], v[248:251]
    s_waitcnt lgkmcnt(6)
    v_mfma_f32_16x16x32_bf16 v[160:163], a[0:3], v[16:19], v[160:163]
    ds_read_b128 a[28:31], v5 offset:28672
    v_mfma_f32_16x16x32_bf16 v[188:191], a[0:3], v[20:23], v[188:191]
    buffer_load_dwordx4 v[56:59], v2, s[8:11], s30 offen offset:1024 sc1
    s_waitcnt lgkmcnt(6)
    v_mfma_f32_16x16x32_bf16 v[164:167], a[4:7], v[16:19], v[164:167]
    ds_read_b128 a[32:35], v5 offset:29696
    v_max3_u32 v216, v216, v18, v19
    v_mfma_f32_16x16x32_bf16 v[192:195], a[4:7], v[20:23], v[192:195]
    buffer_load_dwordx4 v[60:63], v2, s[8:11], s31 offen offset:1024 sc1
    s_waitcnt lgkmcnt(6)
    v_mfma_f32_16x16x32_bf16 v[168:171], a[8:11], v[16:19], v[168:171]
    ds_read_b128 a[36:39], v5 offset:30720
    v_mfma_f32_16x16x32_bf16 v[196:199], a[8:11], v[20:23], v[196:199]
    s_waitcnt lgkmcnt(6)
    v_mfma_f32_16x16x32_bf16 v[172:175], a[12:15], v[16:19], v[172:175]
    ds_read_b128 a[40:43], v5 offset:31744
    v_max3_u32 v216, v216, v20, v21
    v_mfma_f32_16x16x32_bf16 v[200:203], a[12:15], v[20:23], v[200:203]
    s_waitcnt lgkmcnt(6)
    v_mfma_f32_16x16x32_bf16 v[176:179], a[16:19], v[16:19], v[176:179]
    ds_read_b128 a[44:47], v5 offset:32768
    v_mfma_f32_16x16x32_bf16 v[204:207], a[16:19], v[20:23], v[204:207]
    s_waitcnt lgkmcnt(6)
    v_mfma_f32_16x16x32_bf16 v[180:183], a[20:23], v[16:19], v[180:183]
    ds_read_b128 a[48:51], v5 offset:33792
    v_max3_u32 v216, v216, v22, v23
    v_mfma_f32_16x16x32_bf16 v[208:211], a[20:23], v[20:23], v[208:211]
    s_waitcnt lgkmcnt(6)
    v_mfma_f32_16x16x32_bf16 v[184:187], a[24:27], v[16:19], v[184:187]
    ds_read_b128 a[52:55], v5 offset:34816
    v_mfma_f32_16x16x32_bf16 v[212:215], a[24:27], v[20:23], v[212:215]
    s_waitcnt vmcnt(9)
    v_mfma_f32_16x16x32_bf16 v[244:247], v[24:27], v[24:27], v[244:247]
    v_max3_u32 v216, v216, v24, v25
    s_waitcnt vmcnt(8)
    v_mfma_f32_16x16x32_bf16 v[248:251], v[28:31], v[28:31], v[248:251]
    s_waitcnt lgkmcnt(6)
    v_mfma_f32_16x16x32_bf16 v[160:163], a[28:31], v[24:27], v[160:163]
    ds_read_b128 a[0:3], v5 offset:35840
    v_mfma_f32_16x16x32_bf16 v[188:191], a[28:31], v[28:31], v[188:191]
    s_waitcnt lgkmcnt(6)
    v_mfma_f32_16x16x32_bf16 v[164:167], a[32:35], v[24:27], v[164:167]
    ds_read_b128 a[4:7], v5 offset:36864
    v_max3_u32 v216, v216, v26, v27
    v_mfma_f32_16x16x32_bf16 v[192:195], a[32:35], v[28:31], v[192:195]
    s_waitcnt lgkmcnt(6)
    v_mfma_f32_16x16x32_bf16 v[168:171], a[36:39], v[24:27], v[168:171]
    ds_read_b128 a[8:11], v5 offset:37888
    v_mfma_f32_16x16x32_bf16 v[196:199], a[36:39], v[28:31], v[196:199]
    s_waitcnt lgkmcnt(6)
    v_mfma_f32_16x16x32_bf16 v[172:175], a[40:43], v[24:27], v[172:175]
    ds_read_b128 a[12:15], v5 offset:38912
    v_max3_u32 v216, v216, v28, v29
    v_mfma_f32_16x16x32_bf16 v[200:203], a[40:43], v[28:31], v[200:203]
    s_waitcnt lgkmcnt(6)
    v_mfma_f32_16x16x32_bf16 v[176:179], a[44:47], v[24:27], v[176:179]
    ds_read_b128 a[16:19], v5 offset:39936
    v_mfma_f32_16x16x32_bf16 v[204:207], a[44:47], v[28:31], v[204:207]
    s_waitcnt lgkmcnt(6)
    v_mfma_f32_16x16x32_bf16 v[180:183], a[48:51], v[24:27], v[180:183]
    ds_read_b128 a[20:23], v5 offset:40960
    v_max3_u32 v216, v216, v30, v31
    v_mfma_f32_16x16x32_bf16 v[208:211], a[48:51], v[28:31], v[208:211]
    s_waitcnt lgkmcnt(6)
    v_mfma_f32_16x16x32_bf16 v[184:187], a[52:55], v[24:27], v[184:187]
    ds_read_b128 a[24:27], v5 offset:41984
    v_mfma_f32_16x16x32_bf16 v[212:215], a[52:55], v[28:31], v[212:215]
    s_waitcnt vmcnt(7)
    v_mfma_f32_16x16x32_bf16 v[244:247], v[32:35], v[32:35], v[244:247]
    v_max3_u32 v216, v216, v32, v33
    s_waitcnt vmcnt(6)
    v_mfma_f32_16x16x32_bf16 v[248:251], v[36:39], v[36:39], v[248:251]
    s_waitcnt lgkmcnt(6)
    v_mfma_f32_16x16x32_bf16 v[160:163], a[0:3], v[32:35], v[160:163]
    ds_read_b128 a[28:31], v2 offset:0
    v_mfma_f32_16x16x32_bf16 v[188:191], a[0:3], v[36:39], v[188:191]
    s_waitcnt lgkmcnt(6)
    v_mfma_f32_16x16x32_bf16 v[164:167], a[4:7], v[32:35], v[164:167]
    ds_read_b128 a[32:35], v2 offset:1024
    v_max3_u32 v216, v216, v34, v35
    v_mfma_f32_16x16x32_bf16 v[192:195], a[4:7], v[36:39], v[192:195]
    s_waitcnt lgkmcnt(6)
    v_mfma_f32_16x16x32_bf16 v[168:171], a[8:11], v[32:35], v[168:171]
    ds_read_b128 a[36:39], v2 offset:2048
    v_mfma_f32_16x16x32_bf16 v[196:199], a[8:11], v[36:39], v[196:199]
    s_waitcnt lgkmcnt(6)
    v_mfma_f32_16x16x32_bf16 v[172:175], a[12:15], v[32:35], v[172:175]
    ds_read_b128 a[40:43], v2 offset:3072
    v_max3_u32 v216, v216, v36, v37
    v_mfma_f32_16x16x32_bf16 v[200:203], a[12:15], v[36:39], v[200:203]
    s_waitcnt lgkmcnt(6)
    v_mfma_f32_16x16x32_bf16 v[176:179], a[16:19], v[32:35], v[176:179]
    ds_read_b128 a[44:47], v2 offset:4096
    v_mfma_f32_16x16x32_bf16 v[204:207], a[16:19], v[36:39], v[204:207]
    s_waitcnt lgkmcnt(6)
    v_mfma_f32_16x16x32_bf16 v[180:183], a[20:23], v[32:35], v[180:183]
    ds_read_b128 a[48:51], v2 offset:5120
    v_max3_u32 v216, v216, v38, v39
    v_mfma_f32_16x16x32_bf16 v[208:211], a[20:23], v[36:39], v[208:211]
    s_waitcnt lgkmcnt(6)
    v_mfma_f32_16x16x32_bf16 v[184:187], a[24:27], v[32:35], v[184:187]
    ds_read_b128 a[52:55], v2 offset:6144
    v_mfma_f32_16x16x32_bf16 v[212:215], a[24:27], v[36:39], v[212:215]
    s_waitcnt vmcnt(5)
    v_mfma_f32_16x16x32_bf16 v[244:247], v[40:43], v[40:43], v[244:247]
    v_max3_u32 v216, v216, v40, v41
    s_waitcnt vmcnt(4)
    v_mfma_f32_16x16x32_bf16 v[248:251], v[44:47], v[44:47], v[248:251]
    s_waitcnt lgkmcnt(6)
    v_mfma_f32_16x16x32_bf16 v[160:163], a[28:31], v[40:43], v[160:163]
    ds_read_b128 a[0:3], v2 offset:7168
    v_mfma_f32_16x16x32_bf16 v[188:191], a[28:31], v[44:47], v[188:191]
    ds_read_b128 a[4:7], v2 offset:8192
    s_waitcnt lgkmcnt(7)
    v_mfma_f32_16x16x32_bf16 v[164:167], a[32:35], v[40:43], v[164:167]
    ds_read_b128 a[8:11], v2 offset:9216
    v_max3_u32 v216, v216, v42, v43
    v_mfma_f32_16x16x32_bf16 v[192:195], a[32:35], v[44:47], v[192:195]
    ds_read_b128 a[12:15], v2 offset:10240
    s_waitcnt lgkmcnt(8)
    v_mfma_f32_16x16x32_bf16 v[168:171], a[36:39], v[40:43], v[168:171]
    ds_read_b128 a[16:19], v2 offset:11264
    v_mfma_f32_16x16x32_bf16 v[196:199], a[36:39], v[44:47], v[196:199]
    ds_read_b128 a[20:23], v2 offset:12288
    s_waitcnt lgkmcnt(9)
    v_mfma_f32_16x16x32_bf16 v[172:175], a[40:43], v[40:43], v[172:175]
    ds_read_b128 a[24:27], v2 offset:13312
    v_max3_u32 v216, v216, v44, v45
    v_mfma_f32_16x16x32_bf16 v[200:203], a[40:43], v[44:47], v[200:203]
    ds_read_b128 v[64:67], v7 offset:0
    s_waitcnt lgkmcnt(10)
    v_mfma_f32_16x16x32_bf16 v[176:179], a[44:47], v[40:43], v[176:179]
    ds_read_b128 v[92:95], v7 offset:16
    v_mfma_f32_16x16x32_bf16 v[204:207], a[44:47], v[44:47], v[204:207]
    ds_read_b128 v[68:71], v7 offset:64
    s_waitcnt lgkmcnt(11)
    v_mfma_f32_16x16x32_bf16 v[180:183], a[48:51], v[40:43], v[180:183]
    ds_read_b128 v[96:99], v7 offset:80
    v_max3_u32 v216, v216, v46, v47
    v_mfma_f32_16x16x32_bf16 v[208:211], a[48:51], v[44:47], v[208:211]
    ds_read_b128 v[72:75], v7 offset:128
    s_waitcnt lgkmcnt(12)
    v_mfma_f32_16x16x32_bf16 v[184:187], a[52:55], v[40:43], v[184:187]
    ds_read_b128 v[100:103], v7 offset:144
    v_mfma_f32_16x16x32_bf16 v[212:215], a[52:55], v[44:47], v[212:215]
    ds_read_b128 v[76:79], v7 offset:192
    ds_read_b128 v[104:107], v7 offset:208
    ds_read_b128 v[80:83], v7 offset:256
    ds_read_b128 v[108:111], v7 offset:272
    ds_read_b128 v[84:87], v7 offset:320
    ds_read_b128 v[112:115], v7 offset:336
    ds_read_b128 v[88:91], v7 offset:384
    ds_read_b128 v[116:119], v7 offset:400
    s_waitcnt vmcnt(3)
    v_mfma_f32_16x16x32_bf16 v[244:247], v[48:51], v[48:51], v[244:247]
    v_max3_u32 v216, v216, v48, v49
    s_waitcnt vmcnt(2)
    v_mfma_f32_16x16x32_bf16 v[248:251], v[52:55], v[52:55], v[248:251]
    v_mfma_f32_16x16x32_bf16 v[160:163], a[0:3], v[48:51], v[160:163]
    ds_read_b128 a[28:31], v2 offset:14336
    v_mfma_f32_16x16x32_bf16 v[188:191], a[0:3], v[52:55], v[188:191]
    v_mfma_f32_16x16x32_bf16 v[164:167], a[4:7], v[48:51], v[164:167]
    ds_read_b128 a[32:35], v2 offset:15360
    v_max3_u32 v216, v216, v50, v51
    v_mfma_f32_16x16x32_bf16 v[192:195], a[4:7], v[52:55], v[192:195]
    v_mfma_f32_16x16x32_bf16 v[168:171], a[8:11], v[48:51], v[168:171]
    ds_read_b128 a[36:39], v2 offset:16384
    v_mfma_f32_16x16x32_bf16 v[196:199], a[8:11], v[52:55], v[196:199]
    v_mfma_f32_16x16x32_bf16 v[172:175], a[12:15], v[48:51], v[172:175]
    ds_read_b128 a[40:43], v2 offset:17408
    v_max3_u32 v216, v216, v52, v53
    v_mfma_f32_16x16x32_bf16 v[200:203], a[12:15], v[52:55], v[200:203]
    v_mfma_f32_16x16x32_bf16 v[176:179], a[16:19], v[48:51], v[176:179]
    ds_read_b128 a[44:47], v2 offset:18432
    v_mfma_f32_16x16x32_bf16 v[204:207], a[16:19], v[52:55], v[204:207]
    v_mfma_f32_16x16x32_bf16 v[180:183], a[20:23], v[48:51], v[180:183]
    ds_read_b128 a[48:51], v2 offset:19456
    v_max3_u32 v216, v216, v54, v55
    v_mfma_f32_16x16x32_bf16 v[208:211], a[20:23], v[52:55], v[208:211]
    v_mfma_f32_16x16x32_bf16 v[184:187], a[24:27], v[48:51], v[184:187]
    ds_read_b128 a[52:55], v2 offset:20480
    v_mfma_f32_16x16x32_bf16 v[212:215], a[24:27], v[52:55], v[212:215]
    s_waitcnt vmcnt(1)
    v_mfma_f32_16x16x32_bf16 v[244:247], v[56:59], v[56:59], v[244:247]
    v_max3_u32 v216, v216, v56, v57
    s_waitcnt vmcnt(0)
    v_mfma_f32_16x16x32_bf16 v[248:251], v[60:63], v[60:63], v[248:251]
    s_waitcnt lgkmcnt(6)
    v_mfma_f32_16x16x32_bf16 v[160:163], a[28:31], v[56:59], v[160:163]
    v_mfma_f32_16x16x32_bf16 v[188:191], a[28:31], v[60:63], v[188:191]
    s_waitcnt lgkmcnt(5)
    v_mfma_f32_16x16x32_bf16 v[164:167], a[32:35], v[56:59], v[164:167]
    v_max3_u32 v216, v216, v58, v59
    v_mfma_f32_16x16x32_bf16 v[192:195], a[32:35], v[60:63], v[192:195]
    s_waitcnt lgkmcnt(4)
    v_mfma_f32_16x16x32_bf16 v[168:171], a[36:39], v[56:59], v[168:171]
    v_mfma_f32_16x16x32_bf16 v[196:199], a[36:39], v[60:63], v[196:199]
    s_waitcnt lgkmcnt(3)
    v_mfma_f32_16x16x32_bf16 v[172:175], a[40:43], v[56:59], v[172:175]
    v_max3_u32 v216, v216, v60, v61
    v_mfma_f32_16x16x32_bf16 v[200:203], a[40:43], v[60:63], v[200:203]
    s_waitcnt lgkmcnt(2)
    v_mfma_f32_16x16x32_bf16 v[176:179], a[44:47], v[56:59], v[176:179]
    v_mfma_f32_16x16x32_bf16 v[204:207], a[44:47], v[60:63], v[204:207]
    s_waitcnt lgkmcnt(1)
    v_mfma_f32_16x16x32_bf16 v[180:183], a[48:51], v[56:59], v[180:183]
    v_max3_u32 v216, v216, v62, v63
    v_mfma_f32_16x16x32_bf16 v[208:211], a[48:51], v[60:63], v[208:211]
    s_waitcnt lgkmcnt(0)
    v_mfma_f32_16x16x32_bf16 v[184:187], a[52:55], v[56:59], v[184:187]
    v_mfma_f32_16x16x32_bf16 v[212:215], a[52:55], v[60:63], v[212:215]
    v_cmp_eq_u32 vcc, -1, v216
    s_cmp_eq_u64 vcc, 0
    s_nop 5
    s_cbranch_scc1 KF_POST
    s_lshr_b32 s68, s68, 1
    s_cmp_eq_u32 s68, 0
    s_cbranch_scc1 KF_POST
    s_waitcnt vmcnt(0) lgkmcnt(0)
    s_branch KF_G2
KF_END:
    s_endpgm

.section .rodata,"a"
.p2align 6
.amdhsa_kernel fused_kernel
  .amdhsa_next_free_vgpr 512
  .amdhsa_next_free_sgpr 76
  .amdhsa_accum_offset 256
  .amdhsa_group_segment_fixed_size 0
  .amdhsa_kernarg_size 104
  .amdhsa_user_sgpr_count 2
  .amdhsa_user_sgpr_kernarg_segment_ptr 1
  .amdhsa_system_sgpr_workgroup_id_x 1
  .amdhsa_float_denorm_mode_32 3
  .amdhsa_float_denorm_mode_16_64 3
.end_amdhsa_kernel
```
